```python
import torch

def _softmax(x, axis=-1):
    return torch.softmax(x, dim=axis)
def _gelu(x):
    return torch.nn.functional.gelu(x, approximate="tanh")
def _silu(x):
    return torch.nn.functional.silu(x)
def _sigmoid(x):
    return torch.sigmoid(x)
def _layernorm(x, axis=-1, eps=1e-5):
    m = x.mean(dim=axis, keepdim=True)
    v = x.var(dim=axis, keepdim=True, unbiased=False)
    return (x - m) / torch.sqrt(v + eps)
def _scatter_add(tgt, idx, src, axis=0):
    return tgt.clone().index_add_(axis, idx, src)
def _segment_sum(src, seg, n):
    out = torch.zeros((n,) + src.shape[1:], dtype=src.dtype)
    return out.index_add_(0, seg, src)
def _pad(x, pw):
    flat = tuple(v for pair in reversed(pw) for v in pair)
    return torch.nn.functional.pad(x, flat)

kernel_name = 'recurrent_scan__ssm_conv_s4d__dense_activation_silu__prompt'

def setup_inputs():

    _w = (lambda a: (lambda t: t.to(torch.bfloat16) if t.is_floating_point() else t)(torch.as_tensor(a)))
    def _A_setup():
        Bsz, L, D, N = 1, 2048, 576, 128
        return {
            "u": _w((lambda *s: torch.randn(*s, dtype=torch.bfloat16) * 0.05)(Bsz, L, D)),
            "log_A_real": _w((lambda *s: torch.randn(*s, dtype=torch.bfloat16) * 6.4)(D, N) * 0.5),
            "A_imag": _w((lambda *s: torch.randn(*s, dtype=torch.bfloat16) * 0.2)(D, N) * 3.14),
            "C_real": _w((lambda *s: torch.randn(*s, dtype=torch.bfloat16) * 0.4)(D, N) / N ** 0.5),
            "C_imag": _w((lambda *s: torch.randn(*s, dtype=torch.bfloat16) * 0.4)(D, N) / N ** 0.5),
            "log_dt": _w((lambda *s: torch.randn(*s, dtype=torch.bfloat16) * 0.2)(D) * 0.5 - 4.0),
            "D_skip": _w((lambda *s: torch.randn(*s, dtype=torch.bfloat16) * 0.2)(D)),
        }
    _A_in = _A_setup()

    def _B_setup():
        B, S, D, F = 1, 2048, 576, 4608
        return {
            "x": _w((lambda *s: torch.randn(*s, dtype=torch.bfloat16) * 0.05)(B, S, D)),
            "w1": _w((lambda *s: torch.randn(*s, dtype=torch.bfloat16) * 0.8)(D, F) * (D ** -0.5)),
            "w2": _w((lambda *s: torch.randn(*s, dtype=torch.bfloat16) * 0.1)(F, D) * (F ** -0.5)),
        }
    _B_in = _B_setup()

    return {
        "A_u": _A_in["u"],
        "A_log_A_real": _A_in["log_A_real"],
        "A_A_imag": _A_in["A_imag"],
        "A_C_real": _A_in["C_real"],
        "A_C_imag": _A_in["C_imag"],
        "A_log_dt": _A_in["log_dt"],
        "A_D_skip": _A_in["D_skip"],
        "B_x": _B_in["x"],
        "B_w1": _B_in["w1"],
        "B_w2": _B_in["w2"],
    }

def reference(A_u, A_log_A_real, A_A_imag, A_C_real, A_C_imag, A_log_dt, A_D_skip, B_x, B_w1, B_w2):
    def _A_ref(u, log_A_real, A_imag, C_real, C_imag, log_dt, D_skip):
        L = u.shape[1]
        dt = torch.exp(log_dt)
        A = -torch.exp(log_A_real) + 1j * A_imag
        C = (C_real + 1j * C_imag) * dt[:, None]
        pos = (lambda x, dt: x.to(dt))(torch.arange(L), log_dt.dtype)
        P = torch.exp((A * dt[:, None])[:, :, None] * pos[None, None, :])
        K = 2.0 * torch.einsum("dn,dnl->dl", C, P).real
        L2 = 2 * L
        u_t = (lambda x, *d: x.permute(*d))(u, 0, 2, 1)
        Kf = (lambda x, *a, **k: torch.fft.rfft(x.float(), *a, **k))(K, L2)
        Uf = (lambda x, *a, **k: torch.fft.rfft(x.float(), *a, **k))(u_t, L2)
        y = (lambda x, *a, **k: torch.fft.irfft(x, *a, **k).to(torch.bfloat16))(Uf * Kf[None, :, :], L2)[:, :, :L]
        y = (lambda x, *d: x.permute(*d))(y, 0, 2, 1)
        return y + u * D_skip[None, None, :]

    def _B_ref(x, w1, w2):
        h = torch.einsum("bsd,df->bsf", x, w1)
        h = _silu(h)
        out = torch.einsum("bsf,fd->bsd", h, w2)
        return out

    x = A_u
    xn = _layernorm(x, axis=-1)
    s = _A_ref(xn, A_log_A_real, A_A_imag, A_C_real, A_C_imag, A_log_dt, A_D_skip)
    g = _silu(_B_ref(xn, B_w1, B_w2))
    return x + s * g
```

```asm
; @launch grid=(256,1,1) block=(256,1,1) lds=162816
.amdgcn_target "amdgcn-amd-amdhsa--gfx950"
.text
.globl recurrent_scan__ssm_conv_s4d__dense_activation_silu__prompt_kernel
.p2align 8
.type recurrent_scan__ssm_conv_s4d__dense_activation_silu__prompt_kernel,@function
recurrent_scan__ssm_conv_s4d__dense_activation_silu__prompt_kernel:
    s_cmp_ge_u32 s2, 256
    s_cbranch_scc1 M_END
    s_load_dwordx2 s[44:45], s[0:1], 0
    s_load_dwordx4 s[48:51], s[0:1], 64
    s_load_dwordx2 s[46:47], s[0:1], 96
    s_load_dwordx8 s[60:67], s[0:1], 8
    s_load_dwordx2 s[68:69], s[0:1], 40
    s_load_dwordx2 s[70:71], s[0:1], 88
    s_load_dwordx2 s[72:73], s[0:1], 48
    s_load_dwordx2 s[74:75], s[0:1], 80
    v_and_b32 v1, 63, v0
    v_lshrrev_b32 v2, 6, v0
    s_and_b32 s36, s2, 7
    s_lshr_b32 s37, s2, 3
    v_readfirstlane_b32 s20, v2
    s_lshr_b32 s22, s36, 2
    s_lshl_b32 s22, s22, 4
    s_lshr_b32 s38, s37, 1
    s_add_u32 s22, s22, s38
    s_and_b32 s21, s36, 3
    s_lshl_b32 s21, s21, 1
    s_and_b32 s37, s37, 1
    s_add_u32 s21, s21, s37
    s_nop 0
    s_cmp_lg_u32 s20, 3
    s_cbranch_scc1 M_NOPFA
    s_getpc_b64 s[96:97]
M_PCA:
    v_lshlrev_b32 v6, 7, v1
    v_mov_b32 v7, s97
    v_min_u32 v4, M_END-M_PCA, v6
    v_add_co_u32 v4, vcc, s96, v4
    v_add_u32 v6, 0x2000, v6
    s_nop 0
    v_addc_co_u32 v5, vcc, 0, v7, vcc
    global_load_dword v39, v[4:5], off
    v_min_u32 v4, M_END-M_PCA, v6
    v_add_co_u32 v4, vcc, s96, v4
    v_add_u32 v6, 0x2000, v6
    s_nop 0
    v_addc_co_u32 v5, vcc, 0, v7, vcc
    global_load_dword v39, v[4:5], off
    v_min_u32 v4, M_END-M_PCA, v6
    v_add_co_u32 v4, vcc, s96, v4
    v_add_u32 v6, 0x2000, v6
    s_nop 0
    v_addc_co_u32 v5, vcc, 0, v7, vcc
    global_load_dword v39, v[4:5], off
    v_min_u32 v4, M_END-M_PCA, v6
    v_add_co_u32 v4, vcc, s96, v4
    v_add_u32 v6, 0x2000, v6
    s_nop 0
    v_addc_co_u32 v5, vcc, 0, v7, vcc
    global_load_dword v39, v[4:5], off
    v_min_u32 v4, M_END-M_PCA, v6
    v_add_co_u32 v4, vcc, s96, v4
    v_add_u32 v6, 0x2000, v6
    s_nop 0
    v_addc_co_u32 v5, vcc, 0, v7, vcc
    global_load_dword v39, v[4:5], off
    v_min_u32 v4, M_END-M_PCA, v6
    v_add_co_u32 v4, vcc, s96, v4
    v_add_u32 v6, 0x2000, v6
    s_nop 0
    v_addc_co_u32 v5, vcc, 0, v7, vcc
    global_load_dword v39, v[4:5], off
    v_min_u32 v4, M_END-M_PCA, v6
    v_add_co_u32 v4, vcc, s96, v4
    v_add_u32 v6, 0x2000, v6
    s_nop 0
    v_addc_co_u32 v5, vcc, 0, v7, vcc
    global_load_dword v39, v[4:5], off
    v_min_u32 v4, M_END-M_PCA, v6
    v_add_co_u32 v4, vcc, s96, v4
    v_add_u32 v6, 0x2000, v6
    s_nop 0
    v_addc_co_u32 v5, vcc, 0, v7, vcc
    global_load_dword v39, v[4:5], off
M_NOPFA:
    v_and_b32 v2, 15, v1
    v_lshrrev_b32 v3, 4, v1
    s_and_b32 s23, s20, 1
    s_lshr_b32 s24, s20, 1
    s_and_b32 s36, s22, 3
    s_lshl_b32 s36, s36, 1
    s_bfe_u32 s37, s22, 0x10003
    s_add_u32 s36, s36, s37
    s_mul_i32 s43, s36, 9
    s_lshr_b32 s43, s43, 2
    s_lshl_b32 s36, s22, 6
    s_lshl_b32 s37, s20, 4
    s_add_u32 s36, s36, s37
    v_add_u32 v40, s36, v2
    v_mul_u32_u24 v51, 1152, v40
    v_lshl_add_u32 v51, v3, 4, v51
    s_add_u32 s36, s43, 0
    s_cmp_ge_u32 s36, 18
    s_cselect_b32 s37, 18, 0
    s_sub_u32 s36, s36, s37
    s_lshl_b32 s78, s36, 6
    s_add_u32 s36, s43, 1
    s_cmp_ge_u32 s36, 18
    s_cselect_b32 s37, 18, 0
    s_sub_u32 s36, s36, s37
    s_lshl_b32 s79, s36, 6
    s_add_u32 s36, s43, 2
    s_cmp_ge_u32 s36, 18
    s_cselect_b32 s37, 18, 0
    s_sub_u32 s36, s36, s37
    s_lshl_b32 s80, s36, 6
    s_add_u32 s36, s43, 3
    s_cmp_ge_u32 s36, 18
    s_cselect_b32 s37, 18, 0
    s_sub_u32 s36, s36, s37
    s_lshl_b32 s81, s36, 6
    s_add_u32 s36, s43, 4
    s_cmp_ge_u32 s36, 18
    s_cselect_b32 s37, 18, 0
    s_sub_u32 s36, s36, s37
    s_lshl_b32 s82, s36, 6
    s_add_u32 s36, s43, 5
    s_cmp_ge_u32 s36, 18
    s_cselect_b32 s37, 18, 0
    s_sub_u32 s36, s36, s37
    s_lshl_b32 s83, s36, 6
    s_add_u32 s36, s43, 6
    s_cmp_ge_u32 s36, 18
    s_cselect_b32 s37, 18, 0
    s_sub_u32 s36, s36, s37
    s_lshl_b32 s84, s36, 6
    s_add_u32 s36, s43, 7
    s_cmp_ge_u32 s36, 18
    s_cselect_b32 s37, 18, 0
    s_sub_u32 s36, s36, s37
    s_lshl_b32 s85, s36, 6
    s_add_u32 s36, s43, 8
    s_cmp_ge_u32 s36, 18
    s_cselect_b32 s37, 18, 0
    s_sub_u32 s36, s36, s37
    s_lshl_b32 s86, s36, 6
    s_add_u32 s36, s43, 9
    s_cmp_ge_u32 s36, 18
    s_cselect_b32 s37, 18, 0
    s_sub_u32 s36, s36, s37
    s_lshl_b32 s87, s36, 6
    s_add_u32 s36, s43, 10
    s_cmp_ge_u32 s36, 18
    s_cselect_b32 s37, 18, 0
    s_sub_u32 s36, s36, s37
    s_lshl_b32 s88, s36, 6
    s_add_u32 s36, s43, 11
    s_cmp_ge_u32 s36, 18
    s_cselect_b32 s37, 18, 0
    s_sub_u32 s36, s36, s37
    s_lshl_b32 s89, s36, 6
    s_add_u32 s36, s43, 12
    s_cmp_ge_u32 s36, 18
    s_cselect_b32 s37, 18, 0
    s_sub_u32 s36, s36, s37
    s_lshl_b32 s90, s36, 6
    s_add_u32 s36, s43, 13
    s_cmp_ge_u32 s36, 18
    s_cselect_b32 s37, 18, 0
    s_sub_u32 s36, s36, s37
    s_lshl_b32 s91, s36, 6
    s_add_u32 s36, s43, 14
    s_cmp_ge_u32 s36, 18
    s_cselect_b32 s37, 18, 0
    s_sub_u32 s36, s36, s37
    s_lshl_b32 s92, s36, 6
    s_add_u32 s36, s43, 15
    s_cmp_ge_u32 s36, 18
    s_cselect_b32 s37, 18, 0
    s_sub_u32 s36, s36, s37
    s_lshl_b32 s93, s36, 6
    s_add_u32 s36, s43, 16
    s_cmp_ge_u32 s36, 18
    s_cselect_b32 s37, 18, 0
    s_sub_u32 s36, s36, s37
    s_lshl_b32 s94, s36, 6
    s_add_u32 s36, s43, 17
    s_cmp_ge_u32 s36, 18
    s_cselect_b32 s37, 18, 0
    s_sub_u32 s36, s36, s37
    s_lshl_b32 s95, s36, 6
    s_lshl_b32 s52, s2, 1
    s_add_u32 s52, s52, s20
    s_mov_b32 s54, 1
    s_cmp_lt_u32 s20, 2
    s_cbranch_scc1 M_ROLE_DONE
    s_add_u32 s52, s2, 512
    s_mov_b32 s54, 0
    s_cmp_eq_u32 s20, 3
    s_cbranch_scc1 M_ROLE_DONE
    s_cmp_lt_u32 s2, 64
    s_cselect_b32 s54, 1, 0
M_ROLE_DONE:
    s_mul_i32 s53, s20, 1536
    s_add_u32 s53, s53, 156672
    s_waitcnt lgkmcnt(0)
    s_cmp_eq_u32 s54, 0
    s_cbranch_scc1 M_NOKGEN
    s_mov_b32 s56, s68
    s_mov_b32 s57, s69
    s_mov_b32 s58, 1152
    s_mov_b32 s59, 0x20000
    s_lshr_b32 s36, s52, 1
    s_lshl_b32 s36, s36, 2
    v_mov_b32 v2, 0
    buffer_load_dword v48, v2, s[56:59], s36 offen
    v_lshlrev_b32 v2, 2, v1
    s_lshl_b32 s36, s52, 8
    s_mov_b32 s56, s60
    s_mov_b32 s57, s61
    s_mov_b32 s58, 147456
    s_mov_b32 s59, 0x20000
    buffer_load_dword v44, v2, s[56:59], s36 offen
    s_mov_b32 s56, s62
    s_mov_b32 s57, s63
    s_mov_b32 s58, 147456
    s_mov_b32 s59, 0x20000
    buffer_load_dword v45, v2, s[56:59], s36 offen
    s_mov_b32 s56, s64
    s_mov_b32 s57, s65
    s_mov_b32 s58, 147456
    s_mov_b32 s59, 0x20000
    buffer_load_dword v46, v2, s[56:59], s36 offen
    s_mov_b32 s56, s66
    s_mov_b32 s57, s67
    s_mov_b32 s58, 147456
    s_mov_b32 s59, 0x20000
    buffer_load_dword v47, v2, s[56:59], s36 offen
    s_mov_b32 s4, s44
    s_mov_b32 s5, s45
    s_mov_b32 s6, 2359296
    s_mov_b32 s7, 0x20000
    v_mov_b32 v42, v51
    s_mov_b32 s56, s70
    s_mov_b32 s57, s71
    s_mov_b32 s58, 256
    s_mov_b32 s59, 0x20000
    s_mov_b32 s8, s48
    s_mov_b32 s9, s49
    s_mov_b32 s10, 5308416
    s_mov_b32 s11, 0x20000
    s_mov_b32 s12, s50
    s_mov_b32 s13, s51
    s_mov_b32 s14, 5308416
    s_mov_b32 s15, 0x20000
    s_mov_b32 s16, s46
    s_mov_b32 s17, s47
    s_mov_b32 s18, 25165824
    s_mov_b32 s19, 0x20000
    s_mov_b32 s48, s72
    s_mov_b32 s49, s73
    s_mov_b32 s50, 1152
    s_mov_b32 s51, 0x20000
    s_mov_b32 s98, s74
    s_mov_b32 s99, s75
    s_mul_i32 s60, s78, 4608
    s_mul_i32 s61, s79, 4608
    s_mul_i32 s62, s80, 4608
    s_mul_i32 s63, s81, 4608
    s_mul_i32 s64, s82, 4608
    s_mul_i32 s65, s83, 4608
    s_mul_i32 s66, s84, 4608
    s_mul_i32 s67, s85, 4608
    s_mul_i32 s68, s86, 4608
    s_mul_i32 s69, s87, 4608
    s_mul_i32 s70, s88, 4608
    s_mul_i32 s71, s89, 4608
    s_mul_i32 s72, s90, 4608
    s_mul_i32 s73, s91, 4608
    s_mul_i32 s74, s92, 4608
    s_mul_i32 s75, s93, 4608
    s_mul_i32 s76, s94, 4608
    s_mul_i32 s77, s95, 4608
    s_lshl_b32 s25, s20, 14
    s_add_u32 s25, s25, 90112
    s_add_u32 s34, s20, s22
    s_add_u32 s35, s34, 4
    s_and_b32 s34, s34, 7
    s_and_b32 s35, s35, 7
    s_mul_i32 s36, s21, 1152
    s_lshl_b32 s37, s34, 7
    s_add_u32 s27, s36, s37
    s_lshl_b32 s37, s35, 7
    s_add_u32 s28, s36, s37
    s_lshl_b32 s37, s23, 6
    s_add_u32 s37, s37, 1024
    s_add_u32 s26, s36, s37
    s_mul_i32 s36, s21, 663552
    s_lshl_b32 s38, s34, 7
    s_add_u32 s32, s36, s38
    s_lshl_b32 s38, s35, 7
    s_add_u32 s33, s36, s38
    s_add_u32 s31, s36, s37
    s_lshl_b32 s40, s34, 16
    s_lshl_b32 s41, s35, 16
    s_lshl_b32 s42, s23, 15
    s_lshl_b32 s36, s24, 14
    s_add_u32 s42, s42, s36
    s_add_u32 s42, s42, 524288
    v_lshrrev_b32 v54, 3, v1
    v_and_b32 v55, 7, v1
    v_lshrrev_b32 v56, 2, v1
    v_and_b32 v57, 3, v1
    v_bfe_u32 v60, v1, 4, 1
    v_lshlrev_b32 v60, 1, v60
    v_xor_b32 v60, v55, v60
    v_mul_u32_u24 v61, 9216, v54
    v_lshl_add_u32 v4, v60, 4, v61
    v_xor_b32 v2, 4, v60
    v_lshl_add_u32 v5, v2, 4, v61
    v_add_u32 v5, 72704, v5
    v_lshl_add_u32 v6, v60, 4, v61
    v_add_u32 v6, 145408, v6
    v_xor_b32 v2, 4, v60
    v_lshl_add_u32 v7, v2, 4, v61
    v_add_u32 v7, 218112, v7
    v_bfe_u32 v60, v1, 5, 1
    v_lshlrev_b32 v60, 1, v60
    v_xor_b32 v60, v57, v60
    v_mul_u32_u24 v61, 9216, v56
    v_lshl_add_u32 v8, v60, 4, v61
    v_add_u32 v9, 146432, v8
    v_bfe_u32 v60, v1, 4, 2
    v_lshlrev_b32 v60, 1, v60
    v_xor_b32 v60, v55, v60
    v_mul_u32_u24 v61, 1152, v54
    v_lshl_add_u32 v16, v60, 4, v61
    v_add_u32 v17, 8192, v16
    v_add_u32 v18, 16384, v16
    v_add_u32 v19, 24576, v16
    v_bfe_u32 v60, v1, 4, 1
    v_lshlrev_b32 v60, 1, v60
    v_xor_b32 v60, v57, v60
    v_mul_u32_u24 v61, 1152, v56
    v_lshl_add_u32 v20, v60, 4, v61
    v_add_u32 v21, 17408, v20
    v_and_b32 v2, 15, v1
    v_lshrrev_b32 v3, 4, v1
    v_lshrrev_b32 v52, 2, v2
    v_and_b32 v53, 3, v2
    v_lshrrev_b32 v54, 1, v53
    v_and_b32 v55, 1, v53
    v_lshlrev_b32 v55, 3, v55
    v_add_u32 v55, s25, v55
    v_and_b32 v56, 1, v3
    v_lshrrev_b32 v57, 1, v52
    v_lshl_add_u32 v58, v3, 3, v52
    v_lshl_or_b32 v59, v56, 1, v57
    v_lshlrev_b32 v59, 1, v59
    v_xor_b32 v59, v54, v59
    v_lshl_add_u32 v59, v59, 4, v55
    v_lshl_add_u32 v10, v58, 7, v59
    v_xor_b32 v11, 32, v10
    v_xor_b32 v12, 64, v10
    v_xor_b32 v13, 96, v10
    v_lshlrev_b32 v59, 1, v56
    v_xor_b32 v59, v54, v59
    v_lshl_add_u32 v59, v59, 4, v55
    v_lshl_add_u32 v14, v58, 6, v59
    v_xor_b32 v15, 32, v14
    v_lshl_add_u32 v58, v3, 2, v52
    v_bfe_u32 v59, v58, 1, 2
    v_lshlrev_b32 v59, 1, v59
    v_xor_b32 v59, v54, v59
    v_lshl_add_u32 v59, v59, 4, v55
    v_lshl_add_u32 v22, v58, 7, v59
    v_xor_b32 v23, 32, v22
    v_xor_b32 v24, 64, v22
    v_xor_b32 v25, 96, v22
    v_lshlrev_b32 v59, 1, v56
    v_xor_b32 v59, v54, v59
    v_lshl_add_u32 v59, v59, 4, v55
    v_lshl_add_u32 v26, v58, 6, v59
    v_xor_b32 v27, 32, v26
    v_lshlrev_b32 v28, 4, v1
    v_add_u32 v29, 0x10000, v28
    s_lshl_b32 s36, s20, 12
    s_add_u32 s36, s36, 73728
    v_add_u32 v31, s36, v28
    s_xor_b32 s37, s20, 2
    s_lshl_b32 s37, s37, 12
    s_add_u32 s37, s37, 73728
    v_add_u32 v32, s37, v28
    s_mul_i32 s36, s22, 576
    s_add_u32 s36, s36, s21
    s_lshl_b32 s36, s36, 10
    s_add_u32 s36, s36, 5242880
    v_add_u32 v33, s36, v28
    v_mov_b32 v51, v42
    s_mul_i32 s55, s20, 28160
    s_mov_b32 m0, s55
    v_and_b32 v50, 31, v1
    v_lshrrev_b32 v51, 5, v1
    v_mul_u32_u24 v52, 528, v50
    v_lshl_add_u32 v52, v51, 4, v52
    v_add_u32 v57, s55, v52
    v_add_u32 v58, 11088, v57
    s_mov_b32 s45, 0x3fb8aa3b
    s_and_b32 s44, s52, 1
    s_lshl_b32 s44, s44, 4
    s_sub_u32 s44, 16, s44
    s_waitcnt vmcnt(2)
    v_lshlrev_b32 v49, s44, v48
    v_lshlrev_b32 v86, 16, v44
    v_lshlrev_b32 v87, 16, v45
    v_mov_b32 v82, 1.0
    v_and_b32 v49, 0xffff0000, v49
    v_mul_f32 v86, s45, v86
    v_mov_b32 v83, 0
    v_and_b32 v118, 0xffff0000, v44
    v_mul_f32 v49, s45, v49
    v_exp_f32 v86, v86
    v_and_b32 v119, 0xffff0000, v45
    v_mul_f32 v118, s45, v118
    v_exp_f32 v49, v49
    v_cvt_pk_bf16_f32 v86, v86, v86
    v_exp_f32 v118, v118
    v_cvt_pk_bf16_f32 v49, v49, v49
    v_lshlrev_b32 v86, 16, v86
    v_cvt_pk_bf16_f32 v118, v118, v118
    v_lshlrev_b32 v49, 16, v49
    v_lshlrev_b32 v118, 16, v118
    v_mul_f32 v64, -v86, v49
    v_mul_f32 v65, v87, v49
    v_mul_f32 v97, v119, v49
    v_mul_f32 v96, -v118, v49
    v_mul_f32 v64, s45, v64
    v_mul_f32 v65, 0x3e22f983, v65
    v_mul_f32 v97, 0x3e22f983, v97
    v_mul_f32 v96, s45, v96
    v_exp_f32 v88, v64
    v_fract_f32 v89, v65
    v_mul_f32 v90, 0x41000000, v64
    v_mul_f32 v91, 0x41000000, v65
    v_mul_f32 v92, 0x43800000, v64
    v_cos_f32 v66, v89
    v_sin_f32 v67, v89
    v_exp_f32 v90, v90
    v_fract_f32 v91, v91
    v_mul_f32 v66, v66, v88
    v_mul_f32 v67, v67, v88
    v_mul_f32 v93, 0x43800000, v65
    v_cos_f32 v72, v91
    v_sin_f32 v73, v91
    v_exp_f32 v92, v92
    v_fract_f32 v93, v93
    v_mul_f32 v72, v72, v90
    v_mul_f32 v73, v73, v90
    v_pk_mul_f32 v[86:87], v[66:67], v[66:67] op_sel:[0,0] op_sel_hi:[1,0]
    v_cos_f32 v76, v93
    v_sin_f32 v77, v93
    v_pk_mul_f32 v[88:89], v[72:73], v[72:73] op_sel:[0,0] op_sel_hi:[1,0]
    v_pk_fma_f32 v[68:69], v[66:67], v[66:67], v[86:87] op_sel:[1,1,0] op_sel_hi:[0,1,1] neg_lo:[1,0,0]
    v_mul_f32 v76, v76, v92
    v_mul_f32 v77, v77, v92
    v_pk_fma_f32 v[74:75], v[72:73], v[72:73], v[88:89] op_sel:[1,1,0] op_sel_hi:[0,1,1] neg_lo:[1,0,0]
    v_pk_mul_f32 v[86:87], v[68:69], v[68:69] op_sel:[0,0] op_sel_hi:[1,0]
    v_mov_b32 v84, v72
    v_mov_b32 v85, v73
    v_exp_f32 v120, v96
    v_pk_fma_f32 v[70:71], v[68:69], v[68:69], v[86:87] op_sel:[1,1,0] op_sel_hi:[0,1,1] neg_lo:[1,0,0]
    v_fract_f32 v121, v97
    v_mul_f32 v122, 0x41000000, v96
    v_mul_f32 v123, 0x41000000, v97
    v_mul_f32 v124, 0x43800000, v96
    v_cos_f32 v98, v121
    v_sin_f32 v99, v121
    v_exp_f32 v122, v122
    v_fract_f32 v123, v123
    v_mul_f32 v98, v98, v120
    v_mul_f32 v99, v99, v120
    v_mul_f32 v125, 0x43800000, v97
    v_cos_f32 v104, v123
    v_sin_f32 v105, v123
    v_exp_f32 v124, v124
    v_fract_f32 v125, v125
    v_mul_f32 v104, v104, v122
    v_mul_f32 v105, v105, v122
    v_pk_mul_f32 v[118:119], v[98:99], v[98:99] op_sel:[0,0] op_sel_hi:[1,0]
    v_cos_f32 v108, v125
    v_sin_f32 v109, v125
    v_pk_mul_f32 v[120:121], v[104:105], v[104:105] op_sel:[0,0] op_sel_hi:[1,0]
    v_pk_fma_f32 v[100:101], v[98:99], v[98:99], v[118:119] op_sel:[1,1,0] op_sel_hi:[0,1,1] neg_lo:[1,0,0]
    v_mul_f32 v108, v108, v124
    v_mul_f32 v109, v109, v124
    v_pk_fma_f32 v[106:107], v[104:105], v[104:105], v[120:121] op_sel:[1,1,0] op_sel_hi:[0,1,1] neg_lo:[1,0,0]
    v_pk_mul_f32 v[118:119], v[100:101], v[100:101] op_sel:[0,0] op_sel_hi:[1,0]
    v_mov_b32 v114, 1.0
    v_mov_b32 v115, 0
    v_mov_b32 v116, v104
    v_pk_fma_f32 v[102:103], v[100:101], v[100:101], v[118:119] op_sel:[1,1,0] op_sel_hi:[0,1,1] neg_lo:[1,0,0]
    v_mov_b32 v117, v105
    s_waitcnt vmcnt(0)
    v_lshlrev_b32 v78, 16, v46
    v_lshlrev_b32 v79, 16, v47
    v_and_b32 v110, 0xffff0000, v46
    v_and_b32 v111, 0xffff0000, v47
    v_mul_f32 v78, v78, v49
    v_mul_f32 v79, v79, v49
    buffer_load_dwordx4 v[184:187], v42, s[4:7], s78 offen
    v_mul_f32 v110, v110, v49
    v_mul_f32 v111, v111, v49
    v_mul_f32 v78, 0xbfb17218, v78
    v_mul_f32 v79, 0xbfb17218, v79
    v_mul_f32 v110, 0xbfb17218, v110
    v_mul_f32 v111, 0xbfb17218, v111
    v_cvt_pk_bf16_f32 v128, v82, -v83
    v_cvt_pk_bf16_f32 v129, v114, -v115
    v_cvt_pk_bf16_f32 v130, v84, -v85
    v_cvt_pk_bf16_f32 v131, v116, -v117
    ds_write_addtid_b32 v128 offset:11088
    v_pk_mul_f32 v[86:87], v[82:83], v[74:75] op_sel:[0,0] op_sel_hi:[1,0]
    v_pk_mul_f32 v[118:119], v[114:115], v[106:107] op_sel:[0,0] op_sel_hi:[1,0]
    v_cvt_pk_bf16_f32 v132, v78, v79
    buffer_load_dwordx4 v[188:191], v42, s[4:7], s79 offen
    ds_write_addtid_b32 v129 offset:11344
    v_pk_fma_f32 v[82:83], v[82:83], v[74:75], v[86:87] op_sel:[1,1,0] op_sel_hi:[0,1,1] neg_lo:[1,0,0]
    v_pk_fma_f32 v[114:115], v[114:115], v[106:107], v[118:119] op_sel:[1,1,0] op_sel_hi:[0,1,1] neg_lo:[1,0,0]
    v_cvt_pk_bf16_f32 v133, v110, v111
    ds_write_addtid_b32 v130 offset:11616
    v_pk_mul_f32 v[90:91], v[78:79], v[76:77] op_sel:[0,0] op_sel_hi:[1,0]
    v_pk_mul_f32 v[122:123], v[110:111], v[108:109] op_sel:[0,0] op_sel_hi:[1,0]
    v_pk_mul_f32 v[88:89], v[84:85], v[74:75] op_sel:[0,0] op_sel_hi:[1,0]
    ds_write_addtid_b32 v131 offset:11872
    v_pk_fma_f32 v[80:81], v[78:79], v[76:77], v[90:91] op_sel:[1,1,0] op_sel_hi:[0,1,1] neg_lo:[1,0,0]
    v_pk_fma_f32 v[112:113], v[110:111], v[108:109], v[122:123] op_sel:[1,1,0] op_sel_hi:[0,1,1] neg_lo:[1,0,0]
    v_pk_mul_f32 v[120:121], v[116:117], v[106:107] op_sel:[0,0] op_sel_hi:[1,0]
    ds_write_addtid_b32 v132 offset:0
    v_pk_fma_f32 v[84:85], v[84:85], v[74:75], v[88:89] op_sel:[1,1,0] op_sel_hi:[0,1,1] neg_lo:[1,0,0]
    buffer_load_dwordx4 v[192:195], v42, s[4:7], s80 offen
    v_cvt_pk_bf16_f32 v134, v82, -v83
    v_pk_fma_f32 v[116:117], v[116:117], v[106:107], v[120:121] op_sel:[1,1,0] op_sel_hi:[0,1,1] neg_lo:[1,0,0]
    ds_write_addtid_b32 v133 offset:256
    v_cvt_pk_bf16_f32 v135, v114, -v115
    v_cvt_pk_bf16_f32 v136, v84, -v85
    v_cvt_pk_bf16_f32 v137, v116, -v117
    ds_write_addtid_b32 v134 offset:12144
    v_pk_mul_f32 v[92:93], v[78:79], v[66:67] op_sel:[0,0] op_sel_hi:[1,0]
    v_pk_mul_f32 v[124:125], v[110:111], v[98:99] op_sel:[0,0] op_sel_hi:[1,0]
    v_pk_mul_f32 v[86:87], v[82:83], v[74:75] op_sel:[0,0] op_sel_hi:[1,0]
    ds_write_addtid_b32 v135 offset:12400
    v_pk_fma_f32 v[78:79], v[78:79], v[66:67], v[92:93] op_sel:[1,1,0] op_sel_hi:[0,1,1] neg_lo:[1,0,0]
    v_pk_fma_f32 v[110:111], v[110:111], v[98:99], v[124:125] op_sel:[1,1,0] op_sel_hi:[0,1,1] neg_lo:[1,0,0]
    v_pk_mul_f32 v[118:119], v[114:115], v[106:107] op_sel:[0,0] op_sel_hi:[1,0]
    buffer_load_dwordx4 v[196:199], v42, s[4:7], s81 offen
    ds_write_addtid_b32 v136 offset:12672
    v_cvt_pk_bf16_f32 v138, v78, v79
    v_cvt_pk_bf16_f32 v139, v110, v111
    v_pk_fma_f32 v[82:83], v[82:83], v[74:75], v[86:87] op_sel:[1,1,0] op_sel_hi:[0,1,1] neg_lo:[1,0,0]
    ds_write_addtid_b32 v137 offset:12928
    v_pk_fma_f32 v[114:115], v[114:115], v[106:107], v[118:119] op_sel:[1,1,0] op_sel_hi:[0,1,1] neg_lo:[1,0,0]
    v_pk_mul_f32 v[88:89], v[84:85], v[74:75] op_sel:[0,0] op_sel_hi:[1,0]
    v_pk_mul_f32 v[120:121], v[116:117], v[106:107] op_sel:[0,0] op_sel_hi:[1,0]
    ds_write_addtid_b32 v138 offset:528
    v_cvt_pk_bf16_f32 v140, v82, -v83
    v_pk_fma_f32 v[84:85], v[84:85], v[74:75], v[88:89] op_sel:[1,1,0] op_sel_hi:[0,1,1] neg_lo:[1,0,0]
    v_pk_fma_f32 v[116:117], v[116:117], v[106:107], v[120:121] op_sel:[1,1,0] op_sel_hi:[0,1,1] neg_lo:[1,0,0]
    ds_write_addtid_b32 v139 offset:784
    v_cvt_pk_bf16_f32 v141, v114, -v115
    buffer_load_dwordx4 v[200:203], v42, s[4:7], s82 offen
    v_pk_mul_f32 v[92:93], v[78:79], v[66:67] op_sel:[0,0] op_sel_hi:[1,0]
    v_pk_mul_f32 v[124:125], v[110:111], v[98:99] op_sel:[0,0] op_sel_hi:[1,0]
    ds_write_addtid_b32 v140 offset:13200
    v_cvt_pk_bf16_f32 v128, v84, -v85
    v_pk_fma_f32 v[78:79], v[78:79], v[66:67], v[92:93] op_sel:[1,1,0] op_sel_hi:[0,1,1] neg_lo:[1,0,0]
    v_pk_fma_f32 v[110:111], v[110:111], v[98:99], v[124:125] op_sel:[1,1,0] op_sel_hi:[0,1,1] neg_lo:[1,0,0]
    ds_write_addtid_b32 v141 offset:13456
    v_cvt_pk_bf16_f32 v129, v116, -v117
    v_cvt_pk_bf16_f32 v142, v78, v79
    v_cvt_pk_bf16_f32 v143, v110, v111
    v_pk_mul_f32 v[86:87], v[82:83], v[74:75] op_sel:[0,0] op_sel_hi:[1,0]
    v_pk_mul_f32 v[118:119], v[114:115], v[106:107] op_sel:[0,0] op_sel_hi:[1,0]
    ds_write_addtid_b32 v142 offset:1056
    v_pk_mul_f32 v[88:89], v[84:85], v[74:75] op_sel:[0,0] op_sel_hi:[1,0]
    buffer_load_dwordx4 v[204:207], v42, s[4:7], s83 offen
    v_pk_fma_f32 v[82:83], v[82:83], v[74:75], v[86:87] op_sel:[1,1,0] op_sel_hi:[0,1,1] neg_lo:[1,0,0]
    v_pk_fma_f32 v[114:115], v[114:115], v[106:107], v[118:119] op_sel:[1,1,0] op_sel_hi:[0,1,1] neg_lo:[1,0,0]
    ds_write_addtid_b32 v143 offset:1312
    v_pk_mul_f32 v[120:121], v[116:117], v[106:107] op_sel:[0,0] op_sel_hi:[1,0]
    v_pk_fma_f32 v[84:85], v[84:85], v[74:75], v[88:89] op_sel:[1,1,0] op_sel_hi:[0,1,1] neg_lo:[1,0,0]
    v_pk_mul_f32 v[92:93], v[78:79], v[66:67] op_sel:[0,0] op_sel_hi:[1,0]
    ds_write_addtid_b32 v128 offset:13728
    v_pk_fma_f32 v[116:117], v[116:117], v[106:107], v[120:121] op_sel:[1,1,0] op_sel_hi:[0,1,1] neg_lo:[1,0,0]
    v_pk_mul_f32 v[124:125], v[110:111], v[98:99] op_sel:[0,0] op_sel_hi:[1,0]
    v_pk_fma_f32 v[78:79], v[78:79], v[66:67], v[92:93] op_sel:[1,1,0] op_sel_hi:[0,1,1] neg_lo:[1,0,0]
    ds_write_addtid_b32 v129 offset:13984
    v_cvt_pk_bf16_f32 v132, v82, -v83
    v_pk_fma_f32 v[110:111], v[110:111], v[98:99], v[124:125] op_sel:[1,1,0] op_sel_hi:[0,1,1] neg_lo:[1,0,0]
    v_cvt_pk_bf16_f32 v130, v78, v79
    buffer_load_dwordx4 v[208:211], v42, s[4:7], s84 offen
    v_cvt_pk_bf16_f32 v133, v114, -v115
    v_cvt_pk_bf16_f32 v134, v84, -v85
    v_cvt_pk_bf16_f32 v131, v110, v111
    ds_write_addtid_b32 v130 offset:1584
    v_cvt_pk_bf16_f32 v135, v116, -v117
    v_pk_mul_f32 v[86:87], v[82:83], v[74:75] op_sel:[0,0] op_sel_hi:[1,0]
    v_pk_mul_f32 v[118:119], v[114:115], v[106:107] op_sel:[0,0] op_sel_hi:[1,0]
    ds_write_addtid_b32 v131 offset:1840
    v_pk_mul_f32 v[92:93], v[78:79], v[66:67] op_sel:[0,0] op_sel_hi:[1,0]
    v_pk_fma_f32 v[82:83], v[82:83], v[74:75], v[86:87] op_sel:[1,1,0] op_sel_hi:[0,1,1] neg_lo:[1,0,0]
    v_pk_fma_f32 v[114:115], v[114:115], v[106:107], v[118:119] op_sel:[1,1,0] op_sel_hi:[0,1,1] neg_lo:[1,0,0]
    ds_write_addtid_b32 v132 offset:14256
    v_pk_mul_f32 v[124:125], v[110:111], v[98:99] op_sel:[0,0] op_sel_hi:[1,0]
    v_pk_fma_f32 v[78:79], v[78:79], v[66:67], v[92:93] op_sel:[1,1,0] op_sel_hi:[0,1,1] neg_lo:[1,0,0]
    buffer_load_dwordx4 v[212:215], v42, s[4:7], s85 offen
    v_pk_mul_f32 v[88:89], v[84:85], v[74:75] op_sel:[0,0] op_sel_hi:[1,0]
    ds_write_addtid_b32 v133 offset:14512
    v_pk_fma_f32 v[110:111], v[110:111], v[98:99], v[124:125] op_sel:[1,1,0] op_sel_hi:[0,1,1] neg_lo:[1,0,0]
    v_cvt_pk_bf16_f32 v136, v78, v79
    v_pk_mul_f32 v[120:121], v[116:117], v[106:107] op_sel:[0,0] op_sel_hi:[1,0]
    ds_write_addtid_b32 v134 offset:14784
    v_cvt_pk_bf16_f32 v137, v110, v111
    v_pk_fma_f32 v[84:85], v[84:85], v[74:75], v[88:89] op_sel:[1,1,0] op_sel_hi:[0,1,1] neg_lo:[1,0,0]
    v_pk_fma_f32 v[116:117], v[116:117], v[106:107], v[120:121] op_sel:[1,1,0] op_sel_hi:[0,1,1] neg_lo:[1,0,0]
    ds_write_addtid_b32 v135 offset:15040
    v_cvt_pk_bf16_f32 v138, v82, -v83
    v_cvt_pk_bf16_f32 v139, v114, -v115
    v_cvt_pk_bf16_f32 v140, v84, -v85
    ds_write_addtid_b32 v136 offset:2112
    buffer_load_dwordx4 v[216:219], v42, s[4:7], s86 offen
    v_cvt_pk_bf16_f32 v141, v116, -v117
    v_pk_mul_f32 v[92:93], v[78:79], v[66:67] op_sel:[0,0] op_sel_hi:[1,0]
    v_pk_mul_f32 v[124:125], v[110:111], v[98:99] op_sel:[0,0] op_sel_hi:[1,0]
    ds_write_addtid_b32 v137 offset:2368
    v_pk_mul_f32 v[86:87], v[82:83], v[74:75] op_sel:[0,0] op_sel_hi:[1,0]
    v_pk_fma_f32 v[78:79], v[78:79], v[66:67], v[92:93] op_sel:[1,1,0] op_sel_hi:[0,1,1] neg_lo:[1,0,0]
    v_pk_fma_f32 v[110:111], v[110:111], v[98:99], v[124:125] op_sel:[1,1,0] op_sel_hi:[0,1,1] neg_lo:[1,0,0]
    ds_write_addtid_b32 v138 offset:15312
    v_pk_mul_f32 v[118:119], v[114:115], v[106:107] op_sel:[0,0] op_sel_hi:[1,0]
    v_cvt_pk_bf16_f32 v142, v78, v79
    v_cvt_pk_bf16_f32 v143, v110, v111
    ds_write_addtid_b32 v139 offset:15568
    v_pk_fma_f32 v[82:83], v[82:83], v[74:75], v[86:87] op_sel:[1,1,0] op_sel_hi:[0,1,1] neg_lo:[1,0,0]
    v_pk_fma_f32 v[114:115], v[114:115], v[106:107], v[118:119] op_sel:[1,1,0] op_sel_hi:[0,1,1] neg_lo:[1,0,0]
    buffer_load_dwordx4 v[220:223], v42, s[4:7], s87 offen
    v_pk_mul_f32 v[88:89], v[84:85], v[74:75] op_sel:[0,0] op_sel_hi:[1,0]
    ds_write_addtid_b32 v140 offset:15840
    v_pk_mul_f32 v[120:121], v[116:117], v[106:107] op_sel:[0,0] op_sel_hi:[1,0]
    v_cvt_pk_bf16_f32 v128, v82, -v83
    v_pk_fma_f32 v[84:85], v[84:85], v[74:75], v[88:89] op_sel:[1,1,0] op_sel_hi:[0,1,1] neg_lo:[1,0,0]
    ds_write_addtid_b32 v141 offset:16096
    v_pk_fma_f32 v[116:117], v[116:117], v[106:107], v[120:121] op_sel:[1,1,0] op_sel_hi:[0,1,1] neg_lo:[1,0,0]
    v_cvt_pk_bf16_f32 v129, v114, -v115
    v_pk_mul_f32 v[92:93], v[78:79], v[66:67] op_sel:[0,0] op_sel_hi:[1,0]
    ds_write_addtid_b32 v142 offset:2640
    v_pk_mul_f32 v[124:125], v[110:111], v[98:99] op_sel:[0,0] op_sel_hi:[1,0]
    v_cvt_pk_bf16_f32 v132, v84, -v85
    v_pk_fma_f32 v[78:79], v[78:79], v[66:67], v[92:93] op_sel:[1,1,0] op_sel_hi:[0,1,1] neg_lo:[1,0,0]
    ds_write_addtid_b32 v143 offset:2896
    buffer_load_dwordx4 v[224:227], v42, s[4:7], s88 offen
    v_pk_fma_f32 v[110:111], v[110:111], v[98:99], v[124:125] op_sel:[1,1,0] op_sel_hi:[0,1,1] neg_lo:[1,0,0]
    v_cvt_pk_bf16_f32 v133, v116, -v117
    v_cvt_pk_bf16_f32 v130, v78, v79
    ds_write_addtid_b32 v128 offset:16368
    v_cvt_pk_bf16_f32 v131, v110, v111
    v_pk_mul_f32 v[86:87], v[82:83], v[74:75] op_sel:[0,0] op_sel_hi:[1,0]
    v_pk_mul_f32 v[118:119], v[114:115], v[106:107] op_sel:[0,0] op_sel_hi:[1,0]
    ds_write_addtid_b32 v129 offset:16624
    v_pk_mul_f32 v[88:89], v[84:85], v[74:75] op_sel:[0,0] op_sel_hi:[1,0]
    v_pk_fma_f32 v[82:83], v[82:83], v[74:75], v[86:87] op_sel:[1,1,0] op_sel_hi:[0,1,1] neg_lo:[1,0,0]
    v_pk_fma_f32 v[114:115], v[114:115], v[106:107], v[118:119] op_sel:[1,1,0] op_sel_hi:[0,1,1] neg_lo:[1,0,0]
    ds_write_addtid_b32 v130 offset:3168
    v_pk_mul_f32 v[120:121], v[116:117], v[106:107] op_sel:[0,0] op_sel_hi:[1,0]
    v_pk_fma_f32 v[84:85], v[84:85], v[74:75], v[88:89] op_sel:[1,1,0] op_sel_hi:[0,1,1] neg_lo:[1,0,0]
    buffer_load_dwordx4 v[228:231], v42, s[4:7], s89 offen
    v_pk_mul_f32 v[92:93], v[78:79], v[66:67] op_sel:[0,0] op_sel_hi:[1,0]
    ds_write_addtid_b32 v131 offset:3424
    v_pk_fma_f32 v[116:117], v[116:117], v[106:107], v[120:121] op_sel:[1,1,0] op_sel_hi:[0,1,1] neg_lo:[1,0,0]
    v_pk_mul_f32 v[124:125], v[110:111], v[98:99] op_sel:[0,0] op_sel_hi:[1,0]
    v_pk_fma_f32 v[78:79], v[78:79], v[66:67], v[92:93] op_sel:[1,1,0] op_sel_hi:[0,1,1] neg_lo:[1,0,0]
    ds_write_addtid_b32 v132 offset:16896
    v_cvt_pk_bf16_f32 v136, v82, -v83
    v_pk_fma_f32 v[110:111], v[110:111], v[98:99], v[124:125] op_sel:[1,1,0] op_sel_hi:[0,1,1] neg_lo:[1,0,0]
    v_cvt_pk_bf16_f32 v134, v78, v79
    ds_write_addtid_b32 v133 offset:17152
    v_cvt_pk_bf16_f32 v137, v114, -v115
    v_cvt_pk_bf16_f32 v135, v110, v111
    v_cvt_pk_bf16_f32 v138, v84, -v85
    ds_write_addtid_b32 v134 offset:3696
    buffer_load_dwordx4 v[232:235], v42, s[4:7], s90 offen
    v_cvt_pk_bf16_f32 v139, v116, -v117
    v_pk_mul_f32 v[86:87], v[82:83], v[74:75] op_sel:[0,0] op_sel_hi:[1,0]
    v_pk_mul_f32 v[118:119], v[114:115], v[106:107] op_sel:[0,0] op_sel_hi:[1,0]
    ds_write_addtid_b32 v135 offset:3952
    v_cvt_pk_bf16_f32 v140, v80, v81
    v_pk_fma_f32 v[82:83], v[82:83], v[74:75], v[86:87] op_sel:[1,1,0] op_sel_hi:[0,1,1] neg_lo:[1,0,0]
    v_pk_fma_f32 v[114:115], v[114:115], v[106:107], v[118:119] op_sel:[1,1,0] op_sel_hi:[0,1,1] neg_lo:[1,0,0]
    ds_write_addtid_b32 v136 offset:17424
    v_cvt_pk_bf16_f32 v141, v112, v113
    v_pk_mul_f32 v[92:93], v[80:81], v[68:69] op_sel:[0,0] op_sel_hi:[1,0]
    v_pk_mul_f32 v[124:125], v[112:113], v[100:101] op_sel:[0,0] op_sel_hi:[1,0]
    ds_write_addtid_b32 v137 offset:17680
    v_pk_mul_f32 v[88:89], v[84:85], v[74:75] op_sel:[0,0] op_sel_hi:[1,0]
    v_pk_fma_f32 v[78:79], v[80:81], v[68:69], v[92:93] op_sel:[1,1,0] op_sel_hi:[0,1,1] neg_lo:[1,0,0]
    buffer_load_dwordx4 v[236:239], v42, s[4:7], s91 offen
    v_pk_fma_f32 v[110:111], v[112:113], v[100:101], v[124:125] op_sel:[1,1,0] op_sel_hi:[0,1,1] neg_lo:[1,0,0]
    ds_write_addtid_b32 v138 offset:17952
    v_pk_mul_f32 v[120:121], v[116:117], v[106:107] op_sel:[0,0] op_sel_hi:[1,0]
    v_pk_fma_f32 v[84:85], v[84:85], v[74:75], v[88:89] op_sel:[1,1,0] op_sel_hi:[0,1,1] neg_lo:[1,0,0]
    v_cvt_pk_bf16_f32 v142, v82, -v83
    ds_write_addtid_b32 v139 offset:18208
    v_pk_fma_f32 v[116:117], v[116:117], v[106:107], v[120:121] op_sel:[1,1,0] op_sel_hi:[0,1,1] neg_lo:[1,0,0]
    v_cvt_pk_bf16_f32 v143, v114, -v115
    v_cvt_pk_bf16_f32 v128, v84, -v85
    ds_write_addtid_b32 v140 offset:4224
    v_cvt_pk_bf16_f32 v129, v116, -v117
    v_cvt_pk_bf16_f32 v130, v78, v79
    v_cvt_pk_bf16_f32 v131, v110, v111
    ds_write_addtid_b32 v141 offset:4480
    buffer_load_dwordx4 v[240:243], v42, s[4:7], s92 offen
    v_pk_mul_f32 v[90:91], v[80:81], v[76:77] op_sel:[0,0] op_sel_hi:[1,0]
    v_pk_mul_f32 v[122:123], v[112:113], v[108:109] op_sel:[0,0] op_sel_hi:[1,0]
    v_pk_mul_f32 v[86:87], v[82:83], v[74:75] op_sel:[0,0] op_sel_hi:[1,0]
    ds_write_addtid_b32 v142 offset:18480
    v_pk_fma_f32 v[80:81], v[80:81], v[76:77], v[90:91] op_sel:[1,1,0] op_sel_hi:[0,1,1] neg_lo:[1,0,0]
    v_pk_fma_f32 v[112:113], v[112:113], v[108:109], v[122:123] op_sel:[1,1,0] op_sel_hi:[0,1,1] neg_lo:[1,0,0]
    v_pk_mul_f32 v[118:119], v[114:115], v[106:107] op_sel:[0,0] op_sel_hi:[1,0]
    ds_write_addtid_b32 v143 offset:18736
    v_pk_fma_f32 v[82:83], v[82:83], v[74:75], v[86:87] op_sel:[1,1,0] op_sel_hi:[0,1,1] neg_lo:[1,0,0]
    v_pk_mul_f32 v[88:89], v[84:85], v[74:75] op_sel:[0,0] op_sel_hi:[1,0]
    v_pk_fma_f32 v[114:115], v[114:115], v[106:107], v[118:119] op_sel:[1,1,0] op_sel_hi:[0,1,1] neg_lo:[1,0,0]
    ds_write_addtid_b32 v128 offset:19008
    v_pk_mul_f32 v[120:121], v[116:117], v[106:107] op_sel:[0,0] op_sel_hi:[1,0]
    v_pk_fma_f32 v[84:85], v[84:85], v[74:75], v[88:89] op_sel:[1,1,0] op_sel_hi:[0,1,1] neg_lo:[1,0,0]
    buffer_load_dwordx4 v[244:247], v42, s[4:7], s93 offen
    v_cvt_pk_bf16_f32 v132, v82, -v83
    ds_write_addtid_b32 v129 offset:19264
    v_pk_fma_f32 v[116:117], v[116:117], v[106:107], v[120:121] op_sel:[1,1,0] op_sel_hi:[0,1,1] neg_lo:[1,0,0]
    v_cvt_pk_bf16_f32 v133, v114, -v115
    v_pk_mul_f32 v[92:93], v[78:79], v[68:69] op_sel:[0,0] op_sel_hi:[1,0]
    ds_write_addtid_b32 v130 offset:4752
    v_pk_mul_f32 v[124:125], v[110:111], v[100:101] op_sel:[0,0] op_sel_hi:[1,0]
    v_cvt_pk_bf16_f32 v136, v84, -v85
    v_pk_fma_f32 v[78:79], v[78:79], v[68:69], v[92:93] op_sel:[1,1,0] op_sel_hi:[0,1,1] neg_lo:[1,0,0]
    ds_write_addtid_b32 v131 offset:5008
    v_pk_fma_f32 v[110:111], v[110:111], v[100:101], v[124:125] op_sel:[1,1,0] op_sel_hi:[0,1,1] neg_lo:[1,0,0]
    v_cvt_pk_bf16_f32 v137, v116, -v117
    v_cvt_pk_bf16_f32 v134, v78, v79
    ds_write_addtid_b32 v132 offset:19536
    buffer_load_dwordx4 v[248:251], v42, s[4:7], s94 offen
    v_cvt_pk_bf16_f32 v135, v110, v111
    v_pk_mul_f32 v[86:87], v[82:83], v[74:75] op_sel:[0,0] op_sel_hi:[1,0]
    v_pk_mul_f32 v[118:119], v[114:115], v[106:107] op_sel:[0,0] op_sel_hi:[1,0]
    ds_write_addtid_b32 v133 offset:19792
    v_pk_mul_f32 v[88:89], v[84:85], v[74:75] op_sel:[0,0] op_sel_hi:[1,0]
    v_pk_fma_f32 v[82:83], v[82:83], v[74:75], v[86:87] op_sel:[1,1,0] op_sel_hi:[0,1,1] neg_lo:[1,0,0]
    v_pk_fma_f32 v[114:115], v[114:115], v[106:107], v[118:119] op_sel:[1,1,0] op_sel_hi:[0,1,1] neg_lo:[1,0,0]
    ds_write_addtid_b32 v134 offset:5280
    v_pk_mul_f32 v[120:121], v[116:117], v[106:107] op_sel:[0,0] op_sel_hi:[1,0]
    v_pk_fma_f32 v[84:85], v[84:85], v[74:75], v[88:89] op_sel:[1,1,0] op_sel_hi:[0,1,1] neg_lo:[1,0,0]
    v_pk_mul_f32 v[92:93], v[78:79], v[68:69] op_sel:[0,0] op_sel_hi:[1,0]
    ds_write_addtid_b32 v135 offset:5536
    v_pk_fma_f32 v[116:117], v[116:117], v[106:107], v[120:121] op_sel:[1,1,0] op_sel_hi:[0,1,1] neg_lo:[1,0,0]
    v_pk_mul_f32 v[124:125], v[110:111], v[100:101] op_sel:[0,0] op_sel_hi:[1,0]
    buffer_load_dwordx4 v[252:255], v42, s[4:7], s95 offen
    v_pk_fma_f32 v[78:79], v[78:79], v[68:69], v[92:93] op_sel:[1,1,0] op_sel_hi:[0,1,1] neg_lo:[1,0,0]
    ds_write_addtid_b32 v136 offset:20064
    v_cvt_pk_bf16_f32 v140, v82, -v83
    v_pk_fma_f32 v[110:111], v[110:111], v[100:101], v[124:125] op_sel:[1,1,0] op_sel_hi:[0,1,1] neg_lo:[1,0,0]
    v_cvt_pk_bf16_f32 v138, v78, v79
    ds_write_addtid_b32 v137 offset:20320
    v_cvt_pk_bf16_f32 v141, v114, -v115
    v_cvt_pk_bf16_f32 v139, v110, v111
    v_cvt_pk_bf16_f32 v142, v84, -v85
    ds_write_addtid_b32 v138 offset:5808
    v_cvt_pk_bf16_f32 v143, v116, -v117
    v_pk_mul_f32 v[86:87], v[82:83], v[74:75] op_sel:[0,0] op_sel_hi:[1,0]
    v_pk_mul_f32 v[118:119], v[114:115], v[106:107] op_sel:[0,0] op_sel_hi:[1,0]
    ds_write_addtid_b32 v139 offset:6064
    v_cvt_pk_bf16_f32 v128, v80, v81
    v_pk_fma_f32 v[82:83], v[82:83], v[74:75], v[86:87] op_sel:[1,1,0] op_sel_hi:[0,1,1] neg_lo:[1,0,0]
    v_pk_fma_f32 v[114:115], v[114:115], v[106:107], v[118:119] op_sel:[1,1,0] op_sel_hi:[0,1,1] neg_lo:[1,0,0]
    ds_write_addtid_b32 v140 offset:20592
    v_cvt_pk_bf16_f32 v129, v112, v113
    v_pk_mul_f32 v[92:93], v[80:81], v[70:71] op_sel:[0,0] op_sel_hi:[1,0]
    v_pk_mul_f32 v[124:125], v[112:113], v[102:103] op_sel:[0,0] op_sel_hi:[1,0]
    ds_write_addtid_b32 v141 offset:20848
    v_pk_mul_f32 v[88:89], v[84:85], v[74:75] op_sel:[0,0] op_sel_hi:[1,0]
    v_pk_fma_f32 v[78:79], v[80:81], v[70:71], v[92:93] op_sel:[1,1,0] op_sel_hi:[0,1,1] neg_lo:[1,0,0]
    v_pk_fma_f32 v[110:111], v[112:113], v[102:103], v[124:125] op_sel:[1,1,0] op_sel_hi:[0,1,1] neg_lo:[1,0,0]
    ds_write_addtid_b32 v142 offset:21120
    v_pk_mul_f32 v[120:121], v[116:117], v[106:107] op_sel:[0,0] op_sel_hi:[1,0]
    v_pk_fma_f32 v[84:85], v[84:85], v[74:75], v[88:89] op_sel:[1,1,0] op_sel_hi:[0,1,1] neg_lo:[1,0,0]
    v_cvt_pk_bf16_f32 v130, v82, -v83
    ds_write_addtid_b32 v143 offset:21376
    v_pk_fma_f32 v[116:117], v[116:117], v[106:107], v[120:121] op_sel:[1,1,0] op_sel_hi:[0,1,1] neg_lo:[1,0,0]
    v_cvt_pk_bf16_f32 v131, v114, -v115
    v_cvt_pk_bf16_f32 v132, v84, -v85
    ds_write_addtid_b32 v128 offset:6336
    v_cvt_pk_bf16_f32 v133, v116, -v117
    v_cvt_pk_bf16_f32 v134, v78, v79
    v_cvt_pk_bf16_f32 v135, v110, v111
    ds_write_addtid_b32 v129 offset:6592
    v_pk_mul_f32 v[90:91], v[80:81], v[76:77] op_sel:[0,0] op_sel_hi:[1,0]
    v_pk_mul_f32 v[122:123], v[112:113], v[108:109] op_sel:[0,0] op_sel_hi:[1,0]
    v_pk_mul_f32 v[86:87], v[82:83], v[74:75] op_sel:[0,0] op_sel_hi:[1,0]
    ds_write_addtid_b32 v130 offset:21648
    v_pk_fma_f32 v[80:81], v[80:81], v[76:77], v[90:91] op_sel:[1,1,0] op_sel_hi:[0,1,1] neg_lo:[1,0,0]
    v_pk_fma_f32 v[112:113], v[112:113], v[108:109], v[122:123] op_sel:[1,1,0] op_sel_hi:[0,1,1] neg_lo:[1,0,0]
    v_pk_mul_f32 v[118:119], v[114:115], v[106:107] op_sel:[0,0] op_sel_hi:[1,0]
    ds_write_addtid_b32 v131 offset:21904
    v_pk_fma_f32 v[82:83], v[82:83], v[74:75], v[86:87] op_sel:[1,1,0] op_sel_hi:[0,1,1] neg_lo:[1,0,0]
    v_pk_mul_f32 v[88:89], v[84:85], v[74:75] op_sel:[0,0] op_sel_hi:[1,0]
    v_pk_fma_f32 v[114:115], v[114:115], v[106:107], v[118:119] op_sel:[1,1,0] op_sel_hi:[0,1,1] neg_lo:[1,0,0]
    ds_write_addtid_b32 v132 offset:22176
    v_pk_mul_f32 v[120:121], v[116:117], v[106:107] op_sel:[0,0] op_sel_hi:[1,0]
    v_pk_fma_f32 v[84:85], v[84:85], v[74:75], v[88:89] op_sel:[1,1,0] op_sel_hi:[0,1,1] neg_lo:[1,0,0]
    v_cvt_pk_bf16_f32 v136, v82, -v83
    ds_write_addtid_b32 v133 offset:22432
    v_pk_fma_f32 v[116:117], v[116:117], v[106:107], v[120:121] op_sel:[1,1,0] op_sel_hi:[0,1,1] neg_lo:[1,0,0]
    v_cvt_pk_bf16_f32 v137, v114, -v115
    v_cvt_pk_bf16_f32 v138, v80, v81
    ds_write_addtid_b32 v134 offset:6864
    v_cvt_pk_bf16_f32 v139, v112, v113
    v_pk_mul_f32 v[92:93], v[80:81], v[70:71] op_sel:[0,0] op_sel_hi:[1,0]
    v_pk_mul_f32 v[124:125], v[112:113], v[102:103] op_sel:[0,0] op_sel_hi:[1,0]
    ds_write_addtid_b32 v135 offset:7120
    v_cvt_pk_bf16_f32 v140, v84, -v85
    v_pk_fma_f32 v[78:79], v[80:81], v[70:71], v[92:93] op_sel:[1,1,0] op_sel_hi:[0,1,1] neg_lo:[1,0,0]
    v_pk_fma_f32 v[110:111], v[112:113], v[102:103], v[124:125] op_sel:[1,1,0] op_sel_hi:[0,1,1] neg_lo:[1,0,0]
    ds_write_addtid_b32 v136 offset:22704
    v_cvt_pk_bf16_f32 v141, v116, -v117
    v_pk_mul_f32 v[86:87], v[82:83], v[74:75] op_sel:[0,0] op_sel_hi:[1,0]
    v_pk_mul_f32 v[118:119], v[114:115], v[106:107] op_sel:[0,0] op_sel_hi:[1,0]
    ds_write_addtid_b32 v137 offset:22960
    v_pk_mul_f32 v[88:89], v[84:85], v[74:75] op_sel:[0,0] op_sel_hi:[1,0]
    v_pk_fma_f32 v[82:83], v[82:83], v[74:75], v[86:87] op_sel:[1,1,0] op_sel_hi:[0,1,1] neg_lo:[1,0,0]
    v_pk_fma_f32 v[114:115], v[114:115], v[106:107], v[118:119] op_sel:[1,1,0] op_sel_hi:[0,1,1] neg_lo:[1,0,0]
    ds_write_addtid_b32 v138 offset:7392
    v_pk_mul_f32 v[120:121], v[116:117], v[106:107] op_sel:[0,0] op_sel_hi:[1,0]
    v_pk_fma_f32 v[84:85], v[84:85], v[74:75], v[88:89] op_sel:[1,1,0] op_sel_hi:[0,1,1] neg_lo:[1,0,0]
    v_cvt_pk_bf16_f32 v142, v78, v79
    ds_write_addtid_b32 v139 offset:7648
    v_pk_fma_f32 v[116:117], v[116:117], v[106:107], v[120:121] op_sel:[1,1,0] op_sel_hi:[0,1,1] neg_lo:[1,0,0]
    v_cvt_pk_bf16_f32 v143, v110, v111
    v_pk_mul_f32 v[90:91], v[80:81], v[76:77] op_sel:[0,0] op_sel_hi:[1,0]
    ds_write_addtid_b32 v140 offset:23232
    v_pk_mul_f32 v[122:123], v[112:113], v[108:109] op_sel:[0,0] op_sel_hi:[1,0]
    v_cvt_pk_bf16_f32 v128, v82, -v83
    v_pk_fma_f32 v[80:81], v[80:81], v[76:77], v[90:91] op_sel:[1,1,0] op_sel_hi:[0,1,1] neg_lo:[1,0,0]
    ds_write_addtid_b32 v141 offset:23488
    v_pk_fma_f32 v[112:113], v[112:113], v[108:109], v[122:123] op_sel:[1,1,0] op_sel_hi:[0,1,1] neg_lo:[1,0,0]
    v_cvt_pk_bf16_f32 v129, v114, -v115
    v_cvt_pk_bf16_f32 v130, v84, -v85
    ds_write_addtid_b32 v142 offset:7920
    v_cvt_pk_bf16_f32 v131, v116, -v117
    v_pk_mul_f32 v[86:87], v[82:83], v[74:75] op_sel:[0,0] op_sel_hi:[1,0]
    v_pk_mul_f32 v[118:119], v[114:115], v[106:107] op_sel:[0,0] op_sel_hi:[1,0]
    ds_write_addtid_b32 v143 offset:8176
    v_cvt_pk_bf16_f32 v132, v80, v81
    v_pk_fma_f32 v[82:83], v[82:83], v[74:75], v[86:87] op_sel:[1,1,0] op_sel_hi:[0,1,1] neg_lo:[1,0,0]
    v_pk_fma_f32 v[114:115], v[114:115], v[106:107], v[118:119] op_sel:[1,1,0] op_sel_hi:[0,1,1] neg_lo:[1,0,0]
    ds_write_addtid_b32 v128 offset:23760
    v_cvt_pk_bf16_f32 v133, v112, v113
    v_pk_mul_f32 v[90:91], v[80:81], v[76:77] op_sel:[0,0] op_sel_hi:[1,0]
    v_pk_mul_f32 v[122:123], v[112:113], v[108:109] op_sel:[0,0] op_sel_hi:[1,0]
    ds_write_addtid_b32 v129 offset:24016
    v_pk_mul_f32 v[88:89], v[84:85], v[74:75] op_sel:[0,0] op_sel_hi:[1,0]
    v_pk_fma_f32 v[80:81], v[80:81], v[76:77], v[90:91] op_sel:[1,1,0] op_sel_hi:[0,1,1] neg_lo:[1,0,0]
    v_pk_fma_f32 v[112:113], v[112:113], v[108:109], v[122:123] op_sel:[1,1,0] op_sel_hi:[0,1,1] neg_lo:[1,0,0]
    ds_write_addtid_b32 v130 offset:24288
    v_pk_mul_f32 v[120:121], v[116:117], v[106:107] op_sel:[0,0] op_sel_hi:[1,0]
    v_pk_fma_f32 v[84:85], v[84:85], v[74:75], v[88:89] op_sel:[1,1,0] op_sel_hi:[0,1,1] neg_lo:[1,0,0]
    v_cvt_pk_bf16_f32 v134, v82, -v83
    ds_write_addtid_b32 v131 offset:24544
    v_pk_fma_f32 v[116:117], v[116:117], v[106:107], v[120:121] op_sel:[1,1,0] op_sel_hi:[0,1,1] neg_lo:[1,0,0]
    v_cvt_pk_bf16_f32 v135, v114, -v115
    v_cvt_pk_bf16_f32 v136, v84, -v85
    ds_write_addtid_b32 v132 offset:8448
    v_cvt_pk_bf16_f32 v137, v116, -v117
    v_cvt_pk_bf16_f32 v138, v80, v81
    v_cvt_pk_bf16_f32 v139, v112, v113
    ds_write_addtid_b32 v133 offset:8704
    v_pk_mul_f32 v[90:91], v[80:81], v[76:77] op_sel:[0,0] op_sel_hi:[1,0]
    v_pk_mul_f32 v[122:123], v[112:113], v[108:109] op_sel:[0,0] op_sel_hi:[1,0]
    v_pk_mul_f32 v[86:87], v[82:83], v[74:75] op_sel:[0,0] op_sel_hi:[1,0]
    ds_write_addtid_b32 v134 offset:24816
    v_pk_fma_f32 v[80:81], v[80:81], v[76:77], v[90:91] op_sel:[1,1,0] op_sel_hi:[0,1,1] neg_lo:[1,0,0]
    v_pk_fma_f32 v[112:113], v[112:113], v[108:109], v[122:123] op_sel:[1,1,0] op_sel_hi:[0,1,1] neg_lo:[1,0,0]
    v_pk_mul_f32 v[118:119], v[114:115], v[106:107] op_sel:[0,0] op_sel_hi:[1,0]
    ds_write_addtid_b32 v135 offset:25072
    v_pk_fma_f32 v[82:83], v[82:83], v[74:75], v[86:87] op_sel:[1,1,0] op_sel_hi:[0,1,1] neg_lo:[1,0,0]
    v_pk_mul_f32 v[88:89], v[84:85], v[74:75] op_sel:[0,0] op_sel_hi:[1,0]
    v_pk_fma_f32 v[114:115], v[114:115], v[106:107], v[118:119] op_sel:[1,1,0] op_sel_hi:[0,1,1] neg_lo:[1,0,0]
    ds_write_addtid_b32 v136 offset:25344
    v_pk_mul_f32 v[120:121], v[116:117], v[106:107] op_sel:[0,0] op_sel_hi:[1,0]
    v_pk_fma_f32 v[84:85], v[84:85], v[74:75], v[88:89] op_sel:[1,1,0] op_sel_hi:[0,1,1] neg_lo:[1,0,0]
    v_cvt_pk_bf16_f32 v140, v82, -v83
    ds_write_addtid_b32 v137 offset:25600
    v_pk_fma_f32 v[116:117], v[116:117], v[106:107], v[120:121] op_sel:[1,1,0] op_sel_hi:[0,1,1] neg_lo:[1,0,0]
    v_cvt_pk_bf16_f32 v141, v114, -v115
    v_cvt_pk_bf16_f32 v142, v80, v81
    ds_write_addtid_b32 v138 offset:8976
    v_cvt_pk_bf16_f32 v143, v112, v113
    v_pk_mul_f32 v[90:91], v[80:81], v[76:77] op_sel:[0,0] op_sel_hi:[1,0]
    v_pk_mul_f32 v[122:123], v[112:113], v[108:109] op_sel:[0,0] op_sel_hi:[1,0]
    ds_write_addtid_b32 v139 offset:9232
    v_cvt_pk_bf16_f32 v128, v84, -v85
    v_pk_fma_f32 v[80:81], v[80:81], v[76:77], v[90:91] op_sel:[1,1,0] op_sel_hi:[0,1,1] neg_lo:[1,0,0]
    v_pk_fma_f32 v[112:113], v[112:113], v[108:109], v[122:123] op_sel:[1,1,0] op_sel_hi:[0,1,1] neg_lo:[1,0,0]
    ds_write_addtid_b32 v140 offset:25872
    v_cvt_pk_bf16_f32 v129, v116, -v117
    v_pk_mul_f32 v[86:87], v[82:83], v[74:75] op_sel:[0,0] op_sel_hi:[1,0]
    v_pk_mul_f32 v[118:119], v[114:115], v[106:107] op_sel:[0,0] op_sel_hi:[1,0]
    ds_write_addtid_b32 v141 offset:26128
    v_pk_mul_f32 v[88:89], v[84:85], v[74:75] op_sel:[0,0] op_sel_hi:[1,0]
    v_pk_fma_f32 v[82:83], v[82:83], v[74:75], v[86:87] op_sel:[1,1,0] op_sel_hi:[0,1,1] neg_lo:[1,0,0]
    v_pk_fma_f32 v[114:115], v[114:115], v[106:107], v[118:119] op_sel:[1,1,0] op_sel_hi:[0,1,1] neg_lo:[1,0,0]
    ds_write_addtid_b32 v142 offset:9504
    v_pk_mul_f32 v[120:121], v[116:117], v[106:107] op_sel:[0,0] op_sel_hi:[1,0]
    v_pk_fma_f32 v[84:85], v[84:85], v[74:75], v[88:89] op_sel:[1,1,0] op_sel_hi:[0,1,1] neg_lo:[1,0,0]
    v_cvt_pk_bf16_f32 v130, v80, v81
    ds_write_addtid_b32 v143 offset:9760
    v_pk_fma_f32 v[116:117], v[116:117], v[106:107], v[120:121] op_sel:[1,1,0] op_sel_hi:[0,1,1] neg_lo:[1,0,0]
    v_cvt_pk_bf16_f32 v131, v112, v113
    v_pk_mul_f32 v[90:91], v[80:81], v[76:77] op_sel:[0,0] op_sel_hi:[1,0]
    ds_write_addtid_b32 v128 offset:26400
    v_pk_mul_f32 v[122:123], v[112:113], v[108:109] op_sel:[0,0] op_sel_hi:[1,0]
    v_cvt_pk_bf16_f32 v132, v82, -v83
    v_pk_fma_f32 v[80:81], v[80:81], v[76:77], v[90:91] op_sel:[1,1,0] op_sel_hi:[0,1,1] neg_lo:[1,0,0]
    ds_write_addtid_b32 v129 offset:26656
    v_pk_fma_f32 v[112:113], v[112:113], v[108:109], v[122:123] op_sel:[1,1,0] op_sel_hi:[0,1,1] neg_lo:[1,0,0]
    v_cvt_pk_bf16_f32 v133, v114, -v115
    v_cvt_pk_bf16_f32 v134, v84, -v85
    ds_write_addtid_b32 v130 offset:10032
    v_cvt_pk_bf16_f32 v135, v116, -v117
    v_cvt_pk_bf16_f32 v136, v80, v81
    v_cvt_pk_bf16_f32 v137, v112, v113
    ds_write_addtid_b32 v131 offset:10288
    ds_write_addtid_b32 v132 offset:26928
    ds_write_addtid_b32 v133 offset:27184
    ds_write_addtid_b32 v134 offset:27456
    ds_write_addtid_b32 v135 offset:27712
    ds_write_addtid_b32 v136 offset:10560
    ds_write_addtid_b32 v137 offset:10816
    s_waitcnt lgkmcnt(0)
    ds_read_b128 v[64:67], v57 offset:0
    ds_read_b128 v[68:71], v58 offset:0
    ds_read_b128 v[72:75], v57 offset:32
    ds_read_b128 v[76:79], v58 offset:32
    ds_read_b128 v[80:83], v57 offset:64
    ds_read_b128 v[84:87], v58 offset:64
    ds_read_b128 v[88:91], v57 offset:96
    ds_read_b128 v[92:95], v58 offset:96
    ds_read_b128 v[96:99], v57 offset:128
    ds_read_b128 v[100:103], v58 offset:128
    ds_read_b128 v[104:107], v57 offset:160
    ds_read_b128 v[108:111], v58 offset:160
    ds_read_b128 v[112:115], v57 offset:192
    ds_read_b128 v[116:119], v58 offset:192
    s_waitcnt lgkmcnt(12)
    v_mfma_f32_32x32x16_bf16 v[160:175], v[64:67], v[68:71], 0
    ds_read_b128 v[64:67], v57 offset:224
    ds_read_b128 v[68:71], v58 offset:224
    s_waitcnt lgkmcnt(12)
    v_mfma_f32_32x32x16_bf16 v[160:175], v[72:75], v[76:79], v[160:175]
    ds_read_b128 v[72:75], v57 offset:256
    ds_read_b128 v[76:79], v58 offset:256
    s_waitcnt lgkmcnt(12)
    v_mfma_f32_32x32x16_bf16 v[160:175], v[80:83], v[84:87], v[160:175]
    ds_read_b128 v[80:83], v57 offset:288
    ds_read_b128 v[84:87], v58 offset:288
    s_waitcnt lgkmcnt(12)
    v_mfma_f32_32x32x16_bf16 v[160:175], v[88:91], v[92:95], v[160:175]
    ds_read_b128 v[88:91], v57 offset:320
    ds_read_b128 v[92:95], v58 offset:320
    s_waitcnt lgkmcnt(12)
    v_mfma_f32_32x32x16_bf16 v[160:175], v[96:99], v[100:103], v[160:175]
    ds_read_b128 v[96:99], v57 offset:352
    ds_read_b128 v[100:103], v58 offset:352
    s_waitcnt lgkmcnt(12)
    v_mfma_f32_32x32x16_bf16 v[160:175], v[104:107], v[108:111], v[160:175]
    ds_read_b128 v[104:107], v57 offset:384
    ds_read_b128 v[108:111], v58 offset:384
    s_waitcnt lgkmcnt(12)
    v_mfma_f32_32x32x16_bf16 v[160:175], v[112:115], v[116:119], v[160:175]
    ds_read_b128 v[112:115], v57 offset:416
    ds_read_b128 v[116:119], v58 offset:416
    s_waitcnt lgkmcnt(12)
    v_mfma_f32_32x32x16_bf16 v[160:175], v[64:67], v[68:71], v[160:175]
    ds_read_b128 v[64:67], v57 offset:448
    ds_read_b128 v[68:71], v58 offset:448
    s_waitcnt lgkmcnt(12)
    v_mfma_f32_32x32x16_bf16 v[160:175], v[72:75], v[76:79], v[160:175]
    ds_read_b128 v[72:75], v57 offset:480
    ds_read_b128 v[76:79], v58 offset:480
    s_waitcnt lgkmcnt(12)
    v_mfma_f32_32x32x16_bf16 v[160:175], v[80:83], v[84:87], v[160:175]
    s_waitcnt lgkmcnt(10)
    v_mfma_f32_32x32x16_bf16 v[160:175], v[88:91], v[92:95], v[160:175]
    s_waitcnt lgkmcnt(8)
    v_mfma_f32_32x32x16_bf16 v[160:175], v[96:99], v[100:103], v[160:175]
    s_waitcnt lgkmcnt(6)
    v_mfma_f32_32x32x16_bf16 v[160:175], v[104:107], v[108:111], v[160:175]
    s_waitcnt lgkmcnt(4)
    v_mfma_f32_32x32x16_bf16 v[160:175], v[112:115], v[116:119], v[160:175]
    s_waitcnt lgkmcnt(2)
    v_mfma_f32_32x32x16_bf16 v[160:175], v[64:67], v[68:71], v[160:175]
    s_waitcnt lgkmcnt(0)
    v_mfma_f32_32x32x16_bf16 v[160:175], v[72:75], v[76:79], v[160:175]
    v_and_b32 v50, 31, v1
    v_lshrrev_b32 v51, 5, v1
    v_lshlrev_b32 v59, 4, v50
    v_lshl_add_u32 v59, v51, 3, v59
    v_cmp_eq_u32 vcc, 0, v51
    v_lshlrev_b32 v52, 3, v50
    v_lshlrev_b32 v53, 2, v50
    v_add_u32 v54, 512, v52
    v_add_u32 v55, 768, v53
    v_cndmask_b32 v60, v55, v54, vcc
    v_add_u32 v54, 516, v52
    v_add_u32 v55, 896, v53
    v_cndmask_b32 v61, v55, v54, vcc
    v_lshlrev_b32 v52, 1, v50
    v_lshl_add_u32 v62, v51, 8, v52
    v_add_u32 v62, 1024, v62
    v_add_u32 v59, s53, v59
    v_add_u32 v60, s53, v60
    v_add_u32 v61, s53, v61
    v_add_u32 v62, s53, v62
    s_nop 7
    v_cvt_pk_bf16_f32 v128, v160, v161
    v_cvt_pk_bf16_f32 v129, v162, v163
    v_cvt_pk_bf16_f32 v130, v164, v165
    v_cvt_pk_bf16_f32 v131, v166, v167
    v_cvt_pk_bf16_f32 v132, v168, v169
    v_cvt_pk_bf16_f32 v133, v170, v171
    ds_write_b64 v59, v[128:129]
    ds_write_b32 v60, v130
    ds_write_b32 v61, v131
    ds_write_b16 v62, v132
    ds_write_b16_d16_hi v62, v132 offset:64
    ds_write_b16 v62, v133 offset:128
    ds_write_b16_d16_hi v62, v133 offset:192
    s_mul_i32 s78, s78, 576
    s_mul_i32 s79, s79, 576
    s_mul_i32 s80, s80, 576
    s_mul_i32 s81, s81, 576
    s_mul_i32 s82, s82, 576
    s_mul_i32 s83, s83, 576
    s_mul_i32 s84, s84, 576
    s_mul_i32 s85, s85, 576
    s_mul_i32 s86, s86, 576
    s_mul_i32 s87, s87, 576
    s_mul_i32 s88, s88, 576
    s_mul_i32 s89, s89, 576
    s_mul_i32 s90, s90, 576
    s_mul_i32 s91, s91, 576
    s_mul_i32 s92, s92, 576
    s_mul_i32 s93, s93, 576
    s_mul_i32 s94, s94, 576
    s_mul_i32 s95, s95, 576
    s_waitcnt lgkmcnt(0)
    s_barrier
    s_mov_b32 s44, 0
    s_branch M_LN
M_NOKGEN:
    s_mov_b32 s4, s44
    s_mov_b32 s5, s45
    s_mov_b32 s6, 2359296
    s_mov_b32 s7, 0x20000
    buffer_load_dwordx4 v[184:187], v51, s[4:7], s78 offen
    buffer_load_dwordx4 v[188:191], v51, s[4:7], s79 offen
    buffer_load_dwordx4 v[192:195], v51, s[4:7], s80 offen
    buffer_load_dwordx4 v[196:199], v51, s[4:7], s81 offen
    buffer_load_dwordx4 v[200:203], v51, s[4:7], s82 offen
    buffer_load_dwordx4 v[204:207], v51, s[4:7], s83 offen
    buffer_load_dwordx4 v[208:211], v51, s[4:7], s84 offen
    buffer_load_dwordx4 v[212:215], v51, s[4:7], s85 offen
    buffer_load_dwordx4 v[216:219], v51, s[4:7], s86 offen
    buffer_load_dwordx4 v[220:223], v51, s[4:7], s87 offen
    buffer_load_dwordx4 v[224:227], v51, s[4:7], s88 offen
    buffer_load_dwordx4 v[228:231], v51, s[4:7], s89 offen
    buffer_load_dwordx4 v[232:235], v51, s[4:7], s90 offen
    buffer_load_dwordx4 v[236:239], v51, s[4:7], s91 offen
    buffer_load_dwordx4 v[240:243], v51, s[4:7], s92 offen
    buffer_load_dwordx4 v[244:247], v51, s[4:7], s93 offen
    buffer_load_dwordx4 v[248:251], v51, s[4:7], s94 offen
    buffer_load_dwordx4 v[252:255], v51, s[4:7], s95 offen
    s_mov_b32 s56, s70
    s_mov_b32 s57, s71
    s_mov_b32 s58, 256
    s_mov_b32 s59, 0x20000
    s_mov_b32 s8, s48
    s_mov_b32 s9, s49
    s_mov_b32 s10, 5308416
    s_mov_b32 s11, 0x20000
    s_mov_b32 s12, s50
    s_mov_b32 s13, s51
    s_mov_b32 s14, 5308416
    s_mov_b32 s15, 0x20000
    s_mov_b32 s16, s46
    s_mov_b32 s17, s47
    s_mov_b32 s18, 25165824
    s_mov_b32 s19, 0x20000
    s_mov_b32 s48, s72
    s_mov_b32 s49, s73
    s_mov_b32 s50, 1152
    s_mov_b32 s51, 0x20000
    s_mov_b32 s98, s74
    s_mov_b32 s99, s75
    s_mul_i32 s60, s78, 4608
    s_mul_i32 s61, s79, 4608
    s_mul_i32 s62, s80, 4608
    s_mul_i32 s63, s81, 4608
    s_mul_i32 s64, s82, 4608
    s_mul_i32 s65, s83, 4608
    s_mul_i32 s66, s84, 4608
    s_mul_i32 s67, s85, 4608
    s_mul_i32 s68, s86, 4608
    s_mul_i32 s69, s87, 4608
    s_mul_i32 s70, s88, 4608
    s_mul_i32 s71, s89, 4608
    s_mul_i32 s72, s90, 4608
    s_mul_i32 s73, s91, 4608
    s_mul_i32 s74, s92, 4608
    s_mul_i32 s75, s93, 4608
    s_mul_i32 s76, s94, 4608
    s_mul_i32 s77, s95, 4608
    s_lshl_b32 s25, s20, 14
    s_add_u32 s25, s25, 90112
    s_add_u32 s34, s20, s22
    s_add_u32 s35, s34, 4
    s_and_b32 s34, s34, 7
    s_and_b32 s35, s35, 7
    s_mul_i32 s36, s21, 1152
    s_lshl_b32 s37, s34, 7
    s_add_u32 s27, s36, s37
    s_lshl_b32 s37, s35, 7
    s_add_u32 s28, s36, s37
    s_lshl_b32 s37, s23, 6
    s_add_u32 s37, s37, 1024
    s_add_u32 s26, s36, s37
    s_mul_i32 s36, s21, 663552
    s_lshl_b32 s38, s34, 7
    s_add_u32 s32, s36, s38
    s_lshl_b32 s38, s35, 7
    s_add_u32 s33, s36, s38
    s_add_u32 s31, s36, s37
    s_lshl_b32 s40, s34, 16
    s_lshl_b32 s41, s35, 16
    s_lshl_b32 s42, s23, 15
    s_lshl_b32 s36, s24, 14
    s_add_u32 s42, s42, s36
    s_add_u32 s42, s42, 524288
    v_lshrrev_b32 v54, 3, v1
    v_and_b32 v55, 7, v1
    v_lshrrev_b32 v56, 2, v1
    v_and_b32 v57, 3, v1
    v_bfe_u32 v60, v1, 4, 1
    v_lshlrev_b32 v60, 1, v60
    v_xor_b32 v60, v55, v60
    v_mul_u32_u24 v61, 9216, v54
    v_lshl_add_u32 v4, v60, 4, v61
    v_xor_b32 v2, 4, v60
    v_lshl_add_u32 v5, v2, 4, v61
    v_add_u32 v5, 72704, v5
    v_lshl_add_u32 v6, v60, 4, v61
    v_add_u32 v6, 145408, v6
    v_xor_b32 v2, 4, v60
    v_lshl_add_u32 v7, v2, 4, v61
    v_add_u32 v7, 218112, v7
    v_bfe_u32 v60, v1, 5, 1
    v_lshlrev_b32 v60, 1, v60
    v_xor_b32 v60, v57, v60
    v_mul_u32_u24 v61, 9216, v56
    v_lshl_add_u32 v8, v60, 4, v61
    v_add_u32 v9, 146432, v8
    v_bfe_u32 v60, v1, 4, 2
    v_lshlrev_b32 v60, 1, v60
    v_xor_b32 v60, v55, v60
    v_mul_u32_u24 v61, 1152, v54
    v_lshl_add_u32 v16, v60, 4, v61
    v_add_u32 v17, 8192, v16
    v_add_u32 v18, 16384, v16
    v_add_u32 v19, 24576, v16
    v_bfe_u32 v60, v1, 4, 1
    v_lshlrev_b32 v60, 1, v60
    v_xor_b32 v60, v57, v60
    v_mul_u32_u24 v61, 1152, v56
    v_lshl_add_u32 v20, v60, 4, v61
    v_add_u32 v21, 17408, v20
    v_and_b32 v2, 15, v1
    v_lshrrev_b32 v3, 4, v1
    v_lshrrev_b32 v52, 2, v2
    v_and_b32 v53, 3, v2
    v_lshrrev_b32 v54, 1, v53
    v_and_b32 v55, 1, v53
    v_lshlrev_b32 v55, 3, v55
    v_add_u32 v55, s25, v55
    v_and_b32 v56, 1, v3
    v_lshrrev_b32 v57, 1, v52
    v_lshl_add_u32 v58, v3, 3, v52
    v_lshl_or_b32 v59, v56, 1, v57
    v_lshlrev_b32 v59, 1, v59
    v_xor_b32 v59, v54, v59
    v_lshl_add_u32 v59, v59, 4, v55
    v_lshl_add_u32 v10, v58, 7, v59
    v_xor_b32 v11, 32, v10
    v_xor_b32 v12, 64, v10
    v_xor_b32 v13, 96, v10
    v_lshlrev_b32 v59, 1, v56
    v_xor_b32 v59, v54, v59
    v_lshl_add_u32 v59, v59, 4, v55
    v_lshl_add_u32 v14, v58, 6, v59
    v_xor_b32 v15, 32, v14
    v_lshl_add_u32 v58, v3, 2, v52
    v_bfe_u32 v59, v58, 1, 2
    v_lshlrev_b32 v59, 1, v59
    v_xor_b32 v59, v54, v59
    v_lshl_add_u32 v59, v59, 4, v55
    v_lshl_add_u32 v22, v58, 7, v59
    v_xor_b32 v23, 32, v22
    v_xor_b32 v24, 64, v22
    v_xor_b32 v25, 96, v22
    v_lshlrev_b32 v59, 1, v56
    v_xor_b32 v59, v54, v59
    v_lshl_add_u32 v59, v59, 4, v55
    v_lshl_add_u32 v26, v58, 6, v59
    v_xor_b32 v27, 32, v26
    v_lshlrev_b32 v28, 4, v1
    v_add_u32 v29, 0x10000, v28
    s_lshl_b32 s36, s20, 12
    s_add_u32 s36, s36, 73728
    v_add_u32 v31, s36, v28
    s_xor_b32 s37, s20, 2
    s_lshl_b32 s37, s37, 12
    s_add_u32 s37, s37, 73728
    v_add_u32 v32, s37, v28
    s_mul_i32 s36, s22, 576
    s_add_u32 s36, s36, s21
    s_lshl_b32 s36, s36, 10
    s_add_u32 s36, s36, 5242880
    v_add_u32 v33, s36, v28
    s_mul_i32 s78, s78, 576
    s_mul_i32 s79, s79, 576
    s_mul_i32 s80, s80, 576
    s_mul_i32 s81, s81, 576
    s_mul_i32 s82, s82, 576
    s_mul_i32 s83, s83, 576
    s_mul_i32 s84, s84, 576
    s_mul_i32 s85, s85, 576
    s_mul_i32 s86, s86, 576
    s_mul_i32 s87, s87, 576
    s_mul_i32 s88, s88, 576
    s_mul_i32 s89, s89, 576
    s_mul_i32 s90, s90, 576
    s_mul_i32 s91, s91, 576
    s_mul_i32 s92, s92, 576
    s_mul_i32 s93, s93, 576
    s_mul_i32 s94, s94, 576
    s_mul_i32 s95, s95, 576
    s_mov_b32 s44, 1
M_LN:
    v_mov_b32 v44, 0x3f803f80
    v_mov_b32 v45, 0x3f803f80
    v_mov_b32 v46, 0x3f803f80
    v_mov_b32 v47, 0x3f803f80
    s_nop 1
    s_waitcnt vmcnt(17)
    v_mfma_f32_16x16x32_bf16 v[48:51], v[44:47], v[184:187], 0
    s_waitcnt vmcnt(16)
    v_mfma_f32_16x16x32_bf16 v[48:51], v[44:47], v[188:191], v[48:51]
    s_waitcnt vmcnt(15)
    v_mfma_f32_16x16x32_bf16 v[48:51], v[44:47], v[192:195], v[48:51]
    s_waitcnt vmcnt(14)
    v_mfma_f32_16x16x32_bf16 v[48:51], v[44:47], v[196:199], v[48:51]
    s_waitcnt vmcnt(13)
    v_mfma_f32_16x16x32_bf16 v[48:51], v[44:47], v[200:203], v[48:51]
    s_waitcnt vmcnt(12)
    v_mfma_f32_16x16x32_bf16 v[48:51], v[44:47], v[204:207], v[48:51]
    s_waitcnt vmcnt(11)
    v_mfma_f32_16x16x32_bf16 v[48:51], v[44:47], v[208:211], v[48:51]
    s_waitcnt vmcnt(10)
    v_mfma_f32_16x16x32_bf16 v[48:51], v[44:47], v[212:215], v[48:51]
    s_waitcnt vmcnt(9)
    v_mfma_f32_16x16x32_bf16 v[48:51], v[44:47], v[216:219], v[48:51]
    s_waitcnt vmcnt(8)
    v_mfma_f32_16x16x32_bf16 v[48:51], v[44:47], v[220:223], v[48:51]
    s_waitcnt vmcnt(7)
    v_mfma_f32_16x16x32_bf16 v[48:51], v[44:47], v[224:227], v[48:51]
    s_waitcnt vmcnt(6)
    v_mfma_f32_16x16x32_bf16 v[48:51], v[44:47], v[228:231], v[48:51]
    s_waitcnt vmcnt(5)
    v_mfma_f32_16x16x32_bf16 v[48:51], v[44:47], v[232:235], v[48:51]
    s_waitcnt vmcnt(4)
    v_mfma_f32_16x16x32_bf16 v[48:51], v[44:47], v[236:239], v[48:51]
    s_waitcnt vmcnt(3)
    v_mfma_f32_16x16x32_bf16 v[48:51], v[44:47], v[240:243], v[48:51]
    s_waitcnt vmcnt(2)
    v_mfma_f32_16x16x32_bf16 v[48:51], v[44:47], v[244:247], v[48:51]
    s_waitcnt vmcnt(1)
    v_mfma_f32_16x16x32_bf16 v[48:51], v[44:47], v[248:251], v[48:51]
    s_waitcnt vmcnt(0)
    v_mfma_f32_16x16x32_bf16 v[48:51], v[44:47], v[252:255], v[48:51]
    s_nop 7
    v_mul_f32 v34, 0x3ae38e39, v48
    v_cvt_pk_bf16_f32 v35, v34, v34
    v_lshlrev_b32 v36, 16, v35
    v_mov_b32 v37, v36
    v_sub_f32 v34, v34, v36
    v_sub_f32 v37, 0, v36
    s_mov_b32 s46, 0x00003f80
    s_mov_b32 s47, 0x3f800000
    v_dot2_f32_bf16 v44, v184, s46, v37
    v_dot2_f32_bf16 v45, v184, s47, v37
    v_dot2_f32_bf16 v46, v185, s46, v37
    v_dot2_f32_bf16 v47, v185, s47, v37
    s_add_u32 m0, s25, 0
    s_add_u32 s30, s27, s60
    v_dot2_f32_bf16 v48, v186, s46, v37
    v_dot2_f32_bf16 v49, v186, s47, v37
    v_dot2_f32_bf16 v50, v187, s46, v37
    v_dot2_f32_bf16 v51, v187, s47, v37
    v_dot2_f32_bf16 v52, v188, s46, v37
    v_dot2_f32_bf16 v53, v188, s47, v37
    buffer_load_dwordx4 v4, s[8:11], s30 offen lds
    v_dot2_f32_bf16 v54, v189, s46, v37
    v_dot2_f32_bf16 v55, v189, s47, v37
    v_dot2_f32_bf16 v56, v190, s46, v37
    v_dot2_f32_bf16 v57, v190, s47, v37
    v_dot2_f32_bf16 v58, v191, s46, v37
    v_dot2_f32_bf16 v59, v191, s47, v37
    buffer_load_dwordx4 v5, s[8:11], s30 offen offset:1024 lds
    v_dot2_f32_bf16 v60, v192, s46, v37
    v_dot2_f32_bf16 v61, v192, s47, v37
    v_dot2_f32_bf16 v62, v193, s46, v37
    v_dot2_f32_bf16 v63, v193, s47, v37
    v_dot2_f32_bf16 v64, v194, s46, v37
    v_dot2_f32_bf16 v65, v194, s47, v37
    buffer_load_dwordx4 v6, s[8:11], s30 offen offset:2048 lds
    v_dot2_f32_bf16 v66, v195, s46, v37
    v_dot2_f32_bf16 v67, v195, s47, v37
    v_dot2_f32_bf16 v68, v196, s46, v37
    v_dot2_f32_bf16 v69, v196, s47, v37
    v_dot2_f32_bf16 v70, v197, s46, v37
    v_dot2_f32_bf16 v71, v197, s47, v37
    buffer_load_dwordx4 v7, s[8:11], s30 offen offset:3072 lds
    v_dot2_f32_bf16 v72, v198, s46, v37
    v_dot2_f32_bf16 v73, v198, s47, v37
    v_dot2_f32_bf16 v74, v199, s46, v37
    v_dot2_f32_bf16 v75, v199, s47, v37
    v_dot2_f32_bf16 v76, v200, s46, v37
    v_dot2_f32_bf16 v77, v200, s47, v37
    s_add_u32 m0, s25, 4096
    s_add_u32 s30, s27, s61
    v_dot2_f32_bf16 v78, v201, s46, v37
    v_dot2_f32_bf16 v79, v201, s47, v37
    v_dot2_f32_bf16 v80, v202, s46, v37
    v_dot2_f32_bf16 v81, v202, s47, v37
    v_dot2_f32_bf16 v82, v203, s46, v37
    v_dot2_f32_bf16 v83, v203, s47, v37
    buffer_load_dwordx4 v4, s[8:11], s30 offen lds
    v_dot2_f32_bf16 v84, v204, s46, v37
    v_dot2_f32_bf16 v85, v204, s47, v37
    v_dot2_f32_bf16 v86, v205, s46, v37
    v_dot2_f32_bf16 v87, v205, s47, v37
    v_dot2_f32_bf16 v88, v206, s46, v37
    v_dot2_f32_bf16 v89, v206, s47, v37
    buffer_load_dwordx4 v5, s[8:11], s30 offen offset:1024 lds
    v_dot2_f32_bf16 v90, v207, s46, v37
    v_dot2_f32_bf16 v91, v207, s47, v37
    v_dot2_f32_bf16 v92, v208, s46, v37
    v_dot2_f32_bf16 v93, v208, s47, v37
    v_dot2_f32_bf16 v94, v209, s46, v37
    v_dot2_f32_bf16 v95, v209, s47, v37
    buffer_load_dwordx4 v6, s[8:11], s30 offen offset:2048 lds
    v_dot2_f32_bf16 v96, v210, s46, v37
    v_dot2_f32_bf16 v97, v210, s47, v37
    v_dot2_f32_bf16 v98, v211, s46, v37
    v_dot2_f32_bf16 v99, v211, s47, v37
    v_dot2_f32_bf16 v100, v212, s46, v37
    v_dot2_f32_bf16 v101, v212, s47, v37
    buffer_load_dwordx4 v7, s[8:11], s30 offen offset:3072 lds
    v_dot2_f32_bf16 v102, v213, s46, v37
    v_dot2_f32_bf16 v103, v213, s47, v37
    v_dot2_f32_bf16 v104, v214, s46, v37
    v_dot2_f32_bf16 v105, v214, s47, v37
    v_dot2_f32_bf16 v106, v215, s46, v37
    v_dot2_f32_bf16 v107, v215, s47, v37
    s_add_u32 m0, s25, 8192
    s_add_u32 s30, s27, s62
    v_dot2_f32_bf16 v108, v216, s46, v37
    v_dot2_f32_bf16 v109, v216, s47, v37
    v_dot2_f32_bf16 v110, v217, s46, v37
    v_dot2_f32_bf16 v111, v217, s47, v37
    v_dot2_f32_bf16 v112, v218, s46, v37
    v_dot2_f32_bf16 v113, v218, s47, v37
    buffer_load_dwordx4 v4, s[8:11], s30 offen lds
    v_dot2_f32_bf16 v114, v219, s46, v37
    v_dot2_f32_bf16 v115, v219, s47, v37
    v_dot2_f32_bf16 v116, v220, s46, v37
    v_dot2_f32_bf16 v117, v220, s47, v37
    v_dot2_f32_bf16 v118, v221, s46, v37
    v_dot2_f32_bf16 v119, v221, s47, v37
    buffer_load_dwordx4 v5, s[8:11], s30 offen offset:1024 lds
    v_dot2_f32_bf16 v120, v222, s46, v37
    v_dot2_f32_bf16 v121, v222, s47, v37
    v_dot2_f32_bf16 v122, v223, s46, v37
    v_dot2_f32_bf16 v123, v223, s47, v37
    v_dot2_f32_bf16 v124, v224, s46, v37
    v_dot2_f32_bf16 v125, v224, s47, v37
    buffer_load_dwordx4 v6, s[8:11], s30 offen offset:2048 lds
    v_dot2_f32_bf16 v126, v225, s46, v37
    v_dot2_f32_bf16 v127, v225, s47, v37
    v_dot2_f32_bf16 v128, v226, s46, v37
    v_dot2_f32_bf16 v129, v226, s47, v37
    v_dot2_f32_bf16 v130, v227, s46, v37
    v_dot2_f32_bf16 v131, v227, s47, v37
    buffer_load_dwordx4 v7, s[8:11], s30 offen offset:3072 lds
    v_dot2_f32_bf16 v132, v228, s46, v37
    v_dot2_f32_bf16 v133, v228, s47, v37
    v_dot2_f32_bf16 v134, v229, s46, v37
    v_dot2_f32_bf16 v135, v229, s47, v37
    v_dot2_f32_bf16 v136, v230, s46, v37
    v_dot2_f32_bf16 v137, v230, s47, v37
    s_add_u32 m0, s25, 12288
    s_add_u32 s30, s27, s63
    v_dot2_f32_bf16 v138, v231, s46, v37
    v_dot2_f32_bf16 v139, v231, s47, v37
    v_dot2_f32_bf16 v140, v232, s46, v37
    v_dot2_f32_bf16 v141, v232, s47, v37
    v_dot2_f32_bf16 v142, v233, s46, v37
    v_dot2_f32_bf16 v143, v233, s47, v37
    buffer_load_dwordx4 v4, s[8:11], s30 offen lds
    v_dot2_f32_bf16 v144, v234, s46, v37
    v_dot2_f32_bf16 v145, v234, s47, v37
    v_dot2_f32_bf16 v146, v235, s46, v37
    v_dot2_f32_bf16 v147, v235, s47, v37
    v_dot2_f32_bf16 v148, v236, s46, v37
    v_dot2_f32_bf16 v149, v236, s47, v37
    buffer_load_dwordx4 v5, s[8:11], s30 offen offset:1024 lds
    v_dot2_f32_bf16 v150, v237, s46, v37
    v_dot2_f32_bf16 v151, v237, s47, v37
    v_dot2_f32_bf16 v152, v238, s46, v37
    v_dot2_f32_bf16 v153, v238, s47, v37
    v_dot2_f32_bf16 v154, v239, s46, v37
    v_dot2_f32_bf16 v155, v239, s47, v37
    buffer_load_dwordx4 v6, s[8:11], s30 offen offset:2048 lds
    v_dot2_f32_bf16 v156, v240, s46, v37
    v_dot2_f32_bf16 v157, v240, s47, v37
    v_dot2_f32_bf16 v158, v241, s46, v37
    v_dot2_f32_bf16 v159, v241, s47, v37
    v_dot2_f32_bf16 v160, v242, s46, v37
    v_dot2_f32_bf16 v161, v242, s47, v37
    buffer_load_dwordx4 v7, s[8:11], s30 offen offset:3072 lds
    v_dot2_f32_bf16 v162, v243, s46, v37
    v_dot2_f32_bf16 v163, v243, s47, v37
    v_dot2_f32_bf16 v164, v244, s46, v37
    v_dot2_f32_bf16 v165, v244, s47, v37
    v_dot2_f32_bf16 v166, v245, s46, v37
    v_dot2_f32_bf16 v167, v245, s47, v37
    v_dot2_f32_bf16 v168, v246, s46, v37
    v_dot2_f32_bf16 v169, v246, s47, v37
    v_dot2_f32_bf16 v170, v247, s46, v37
    v_dot2_f32_bf16 v171, v247, s47, v37
    v_dot2_f32_bf16 v172, v248, s46, v37
    v_dot2_f32_bf16 v173, v248, s47, v37
    v_dot2_f32_bf16 v174, v249, s46, v37
    v_dot2_f32_bf16 v175, v249, s47, v37
    v_dot2_f32_bf16 v176, v250, s46, v37
    v_dot2_f32_bf16 v177, v250, s47, v37
    v_dot2_f32_bf16 v178, v251, s46, v37
    v_dot2_f32_bf16 v179, v251, s47, v37
    v_dot2_f32_bf16 v180, v252, s46, v37
    v_dot2_f32_bf16 v181, v252, s47, v37
    v_dot2_f32_bf16 v182, v253, s46, v37
    v_dot2_f32_bf16 v183, v253, s47, v37
    v_dot2_f32_bf16 v184, v254, s46, v37
    v_dot2_f32_bf16 v185, v254, s47, v37
    v_dot2_f32_bf16 v186, v255, s46, v37
    v_dot2_f32_bf16 v187, v255, s47, v37
    v_pk_mul_f32 v[38:39], v[44:45], v[44:45]
    v_pk_mul_f32 v[2:3], v[46:47], v[46:47]
    v_pk_fma_f32 v[38:39], v[48:49], v[48:49], v[38:39]
    v_pk_fma_f32 v[2:3], v[50:51], v[50:51], v[2:3]
    v_pk_fma_f32 v[38:39], v[52:53], v[52:53], v[38:39]
    v_pk_fma_f32 v[2:3], v[54:55], v[54:55], v[2:3]
    v_pk_fma_f32 v[38:39], v[56:57], v[56:57], v[38:39]
    v_pk_fma_f32 v[2:3], v[58:59], v[58:59], v[2:3]
    v_pk_fma_f32 v[38:39], v[60:61], v[60:61], v[38:39]
    v_pk_fma_f32 v[2:3], v[62:63], v[62:63], v[2:3]
    v_pk_fma_f32 v[38:39], v[64:65], v[64:65], v[38:39]
    v_pk_fma_f32 v[2:3], v[66:67], v[66:67], v[2:3]
    v_pk_fma_f32 v[38:39], v[68:69], v[68:69], v[38:39]
    v_pk_fma_f32 v[2:3], v[70:71], v[70:71], v[2:3]
    v_pk_fma_f32 v[38:39], v[72:73], v[72:73], v[38:39]
    v_pk_fma_f32 v[2:3], v[74:75], v[74:75], v[2:3]
    v_pk_fma_f32 v[38:39], v[76:77], v[76:77], v[38:39]
    v_pk_fma_f32 v[2:3], v[78:79], v[78:79], v[2:3]
    v_pk_fma_f32 v[38:39], v[80:81], v[80:81], v[38:39]
    v_pk_fma_f32 v[2:3], v[82:83], v[82:83], v[2:3]
    v_pk_fma_f32 v[38:39], v[84:85], v[84:85], v[38:39]
    v_pk_fma_f32 v[2:3], v[86:87], v[86:87], v[2:3]
    v_pk_fma_f32 v[38:39], v[88:89], v[88:89], v[38:39]
    v_pk_fma_f32 v[2:3], v[90:91], v[90:91], v[2:3]
    v_pk_fma_f32 v[38:39], v[92:93], v[92:93], v[38:39]
    v_pk_fma_f32 v[2:3], v[94:95], v[94:95], v[2:3]
    v_pk_fma_f32 v[38:39], v[96:97], v[96:97], v[38:39]
    v_pk_fma_f32 v[2:3], v[98:99], v[98:99], v[2:3]
    v_pk_fma_f32 v[38:39], v[100:101], v[100:101], v[38:39]
    v_pk_fma_f32 v[2:3], v[102:103], v[102:103], v[2:3]
    v_pk_fma_f32 v[38:39], v[104:105], v[104:105], v[38:39]
    v_pk_fma_f32 v[2:3], v[106:107], v[106:107], v[2:3]
    v_pk_fma_f32 v[38:39], v[108:109], v[108:109], v[38:39]
    v_pk_fma_f32 v[2:3], v[110:111], v[110:111], v[2:3]
    v_pk_fma_f32 v[38:39], v[112:113], v[112:113], v[38:39]
    v_pk_fma_f32 v[2:3], v[114:115], v[114:115], v[2:3]
    v_pk_fma_f32 v[38:39], v[116:117], v[116:117], v[38:39]
    v_pk_fma_f32 v[2:3], v[118:119], v[118:119], v[2:3]
    v_pk_fma_f32 v[38:39], v[120:121], v[120:121], v[38:39]
    v_pk_fma_f32 v[2:3], v[122:123], v[122:123], v[2:3]
    v_pk_fma_f32 v[38:39], v[124:125], v[124:125], v[38:39]
    v_pk_fma_f32 v[2:3], v[126:127], v[126:127], v[2:3]
    v_pk_fma_f32 v[38:39], v[128:129], v[128:129], v[38:39]
    v_pk_fma_f32 v[2:3], v[130:131], v[130:131], v[2:3]
    v_pk_fma_f32 v[38:39], v[132:133], v[132:133], v[38:39]
    v_pk_fma_f32 v[2:3], v[134:135], v[134:135], v[2:3]
    v_pk_fma_f32 v[38:39], v[136:137], v[136:137], v[38:39]
    v_pk_fma_f32 v[2:3], v[138:139], v[138:139], v[2:3]
    v_pk_fma_f32 v[38:39], v[140:141], v[140:141], v[38:39]
    v_pk_fma_f32 v[2:3], v[142:143], v[142:143], v[2:3]
    v_pk_fma_f32 v[38:39], v[144:145], v[144:145], v[38:39]
    v_pk_fma_f32 v[2:3], v[146:147], v[146:147], v[2:3]
    v_pk_fma_f32 v[38:39], v[148:149], v[148:149], v[38:39]
    v_pk_fma_f32 v[2:3], v[150:151], v[150:151], v[2:3]
    v_pk_fma_f32 v[38:39], v[152:153], v[152:153], v[38:39]
    v_pk_fma_f32 v[2:3], v[154:155], v[154:155], v[2:3]
    v_pk_fma_f32 v[38:39], v[156:157], v[156:157], v[38:39]
    v_pk_fma_f32 v[2:3], v[158:159], v[158:159], v[2:3]
    v_pk_fma_f32 v[38:39], v[160:161], v[160:161], v[38:39]
    v_pk_fma_f32 v[2:3], v[162:163], v[162:163], v[2:3]
    v_pk_fma_f32 v[38:39], v[164:165], v[164:165], v[38:39]
    v_pk_fma_f32 v[2:3], v[166:167], v[166:167], v[2:3]
    v_pk_fma_f32 v[38:39], v[168:169], v[168:169], v[38:39]
    v_pk_fma_f32 v[2:3], v[170:171], v[170:171], v[2:3]
    v_pk_fma_f32 v[38:39], v[172:173], v[172:173], v[38:39]
    v_pk_fma_f32 v[2:3], v[174:175], v[174:175], v[2:3]
    v_pk_fma_f32 v[38:39], v[176:177], v[176:177], v[38:39]
    v_pk_fma_f32 v[2:3], v[178:179], v[178:179], v[2:3]
    v_pk_fma_f32 v[38:39], v[180:181], v[180:181], v[38:39]
    v_pk_fma_f32 v[2:3], v[182:183], v[182:183], v[2:3]
    v_pk_fma_f32 v[38:39], v[184:185], v[184:185], v[38:39]
    v_pk_fma_f32 v[2:3], v[186:187], v[186:187], v[2:3]
    v_pk_add_f32 v[38:39], v[38:39], v[2:3]
    v_add_f32 v38, v38, v39
    v_mov_b32 v39, v38
    s_nop 1
    v_permlane32_swap_b32 v38, v39
    v_add_f32 v38, v38, v39
    v_mov_b32 v39, v38
    s_nop 1
    v_permlane16_swap_b32 v38, v39
    v_add_f32 v38, v38, v39
    v_mul_f32 v38, 0x3ae38e39, v38
    v_fma_f32 v38, -v34, v34, v38
    v_cvt_pk_bf16_f32 v38, v38, v38
    v_lshlrev_b32 v38, 16, v38
    v_add_f32 v38, 0x3727c5ac, v38
    v_cvt_pk_bf16_f32 v38, v38, v38
    v_lshlrev_b32 v38, 16, v38
    v_sqrt_f32 v38, v38
    s_nop 0
    v_cvt_pk_bf16_f32 v38, v38, v38
    v_lshlrev_b32 v38, 16, v38
    v_rcp_f32 v38, v38
    s_nop 0
    v_mov_b32 v2, v36
    v_mov_b32 v3, v38
    v_mul_f32 v38, 0xbfb8aa3b, v38
    v_mov_b32 v39, v38
    v_and_b32 v41, 63, v40
    v_lshlrev_b32 v41, 3, v41
    v_add_u32 v41, 155648, v41
    ds_write_b64 v41, v[2:3]
    v_mov_b32 v2, 0
    v_mov_b32 v3, 156160
    ds_write_b32 v3, v2
    s_cmp_eq_u32 s44, 0
    s_cbranch_scc1 M_TABFREE
    s_barrier
M_TABFREE:
    s_lshl_b32 s36, s20, 10
    v_add_u32 v41, s36, v28
    v_add_u32 v42, 0x10000, v41
    v_pk_mul_f32 v[44:45], v[44:45], v[38:39]
    v_pk_mul_f32 v[46:47], v[46:47], v[38:39]
    v_pk_mul_f32 v[48:49], v[48:49], v[38:39]
    v_pk_mul_f32 v[50:51], v[50:51], v[38:39]
    v_cvt_pk_bf16_f32 v44, v44, v45
    v_cvt_pk_bf16_f32 v45, v46, v47
    v_cvt_pk_bf16_f32 v46, v48, v49
    v_cvt_pk_bf16_f32 v47, v50, v51
    ds_write_b128 v41, v[44:47] offset:0
    v_pk_mul_f32 v[52:53], v[52:53], v[38:39]
    v_pk_mul_f32 v[54:55], v[54:55], v[38:39]
    v_pk_mul_f32 v[56:57], v[56:57], v[38:39]
    v_pk_mul_f32 v[58:59], v[58:59], v[38:39]
    v_cvt_pk_bf16_f32 v52, v52, v53
    v_cvt_pk_bf16_f32 v53, v54, v55
    v_cvt_pk_bf16_f32 v54, v56, v57
    v_cvt_pk_bf16_f32 v55, v58, v59
    ds_write_b128 v41, v[52:55] offset:4096
    v_pk_mul_f32 v[60:61], v[60:61], v[38:39]
    v_pk_mul_f32 v[62:63], v[62:63], v[38:39]
    v_pk_mul_f32 v[64:65], v[64:65], v[38:39]
    v_pk_mul_f32 v[66:67], v[66:67], v[38:39]
    v_cvt_pk_bf16_f32 v60, v60, v61
    v_cvt_pk_bf16_f32 v61, v62, v63
    v_cvt_pk_bf16_f32 v62, v64, v65
    v_cvt_pk_bf16_f32 v63, v66, v67
    ds_write_b128 v41, v[60:63] offset:8192
    v_pk_mul_f32 v[68:69], v[68:69], v[38:39]
    v_pk_mul_f32 v[70:71], v[70:71], v[38:39]
    v_pk_mul_f32 v[72:73], v[72:73], v[38:39]
    v_pk_mul_f32 v[74:75], v[74:75], v[38:39]
    v_cvt_pk_bf16_f32 v68, v68, v69
    v_cvt_pk_bf16_f32 v69, v70, v71
    v_cvt_pk_bf16_f32 v70, v72, v73
    v_cvt_pk_bf16_f32 v71, v74, v75
    ds_write_b128 v41, v[68:71] offset:12288
    v_pk_mul_f32 v[76:77], v[76:77], v[38:39]
    v_pk_mul_f32 v[78:79], v[78:79], v[38:39]
    v_pk_mul_f32 v[80:81], v[80:81], v[38:39]
    v_pk_mul_f32 v[82:83], v[82:83], v[38:39]
    v_cvt_pk_bf16_f32 v76, v76, v77
    v_cvt_pk_bf16_f32 v77, v78, v79
    v_cvt_pk_bf16_f32 v78, v80, v81
    v_cvt_pk_bf16_f32 v79, v82, v83
    ds_write_b128 v41, v[76:79] offset:16384
    v_pk_mul_f32 v[84:85], v[84:85], v[38:39]
    v_pk_mul_f32 v[86:87], v[86:87], v[38:39]
    v_pk_mul_f32 v[88:89], v[88:89], v[38:39]
    v_pk_mul_f32 v[90:91], v[90:91], v[38:39]
    v_cvt_pk_bf16_f32 v84, v84, v85
    v_cvt_pk_bf16_f32 v85, v86, v87
    v_cvt_pk_bf16_f32 v86, v88, v89
    v_cvt_pk_bf16_f32 v87, v90, v91
    ds_write_b128 v41, v[84:87] offset:20480
    v_pk_mul_f32 v[92:93], v[92:93], v[38:39]
    v_pk_mul_f32 v[94:95], v[94:95], v[38:39]
    v_pk_mul_f32 v[96:97], v[96:97], v[38:39]
    v_pk_mul_f32 v[98:99], v[98:99], v[38:39]
    v_cvt_pk_bf16_f32 v92, v92, v93
    v_cvt_pk_bf16_f32 v93, v94, v95
    v_cvt_pk_bf16_f32 v94, v96, v97
    v_cvt_pk_bf16_f32 v95, v98, v99
    ds_write_b128 v41, v[92:95] offset:24576
    v_pk_mul_f32 v[100:101], v[100:101], v[38:39]
    v_pk_mul_f32 v[102:103], v[102:103], v[38:39]
    v_pk_mul_f32 v[104:105], v[104:105], v[38:39]
    v_pk_mul_f32 v[106:107], v[106:107], v[38:39]
    v_cvt_pk_bf16_f32 v100, v100, v101
    v_cvt_pk_bf16_f32 v101, v102, v103
    v_cvt_pk_bf16_f32 v102, v104, v105
    v_cvt_pk_bf16_f32 v103, v106, v107
    ds_write_b128 v41, v[100:103] offset:28672
    v_pk_mul_f32 v[108:109], v[108:109], v[38:39]
    v_pk_mul_f32 v[110:111], v[110:111], v[38:39]
    v_pk_mul_f32 v[112:113], v[112:113], v[38:39]
    v_pk_mul_f32 v[114:115], v[114:115], v[38:39]
    v_cvt_pk_bf16_f32 v108, v108, v109
    v_cvt_pk_bf16_f32 v109, v110, v111
    v_cvt_pk_bf16_f32 v110, v112, v113
    v_cvt_pk_bf16_f32 v111, v114, v115
    ds_write_b128 v41, v[108:111] offset:32768
    v_pk_mul_f32 v[116:117], v[116:117], v[38:39]
    v_pk_mul_f32 v[118:119], v[118:119], v[38:39]
    v_pk_mul_f32 v[120:121], v[120:121], v[38:39]
    v_pk_mul_f32 v[122:123], v[122:123], v[38:39]
    v_cvt_pk_bf16_f32 v116, v116, v117
    v_cvt_pk_bf16_f32 v117, v118, v119
    v_cvt_pk_bf16_f32 v118, v120, v121
    v_cvt_pk_bf16_f32 v119, v122, v123
    ds_write_b128 v41, v[116:119] offset:36864
    v_pk_mul_f32 v[124:125], v[124:125], v[38:39]
    v_pk_mul_f32 v[126:127], v[126:127], v[38:39]
    v_pk_mul_f32 v[128:129], v[128:129], v[38:39]
    v_pk_mul_f32 v[130:131], v[130:131], v[38:39]
    v_cvt_pk_bf16_f32 v124, v124, v125
    v_cvt_pk_bf16_f32 v125, v126, v127
    v_cvt_pk_bf16_f32 v126, v128, v129
    v_cvt_pk_bf16_f32 v127, v130, v131
    ds_write_b128 v41, v[124:127] offset:40960
    v_pk_mul_f32 v[132:133], v[132:133], v[38:39]
    v_pk_mul_f32 v[134:135], v[134:135], v[38:39]
    v_pk_mul_f32 v[136:137], v[136:137], v[38:39]
    v_pk_mul_f32 v[138:139], v[138:139], v[38:39]
    v_cvt_pk_bf16_f32 v132, v132, v133
    v_cvt_pk_bf16_f32 v133, v134, v135
    v_cvt_pk_bf16_f32 v134, v136, v137
    v_cvt_pk_bf16_f32 v135, v138, v139
    ds_write_b128 v41, v[132:135] offset:45056
    v_pk_mul_f32 v[140:141], v[140:141], v[38:39]
    v_pk_mul_f32 v[142:143], v[142:143], v[38:39]
    v_pk_mul_f32 v[144:145], v[144:145], v[38:39]
    v_pk_mul_f32 v[146:147], v[146:147], v[38:39]
    v_cvt_pk_bf16_f32 v140, v140, v141
    v_cvt_pk_bf16_f32 v141, v142, v143
    v_cvt_pk_bf16_f32 v142, v144, v145
    v_cvt_pk_bf16_f32 v143, v146, v147
    ds_write_b128 v41, v[140:143] offset:49152
    v_pk_mul_f32 v[148:149], v[148:149], v[38:39]
    v_pk_mul_f32 v[150:151], v[150:151], v[38:39]
    v_pk_mul_f32 v[152:153], v[152:153], v[38:39]
    v_pk_mul_f32 v[154:155], v[154:155], v[38:39]
    v_cvt_pk_bf16_f32 v148, v148, v149
    v_cvt_pk_bf16_f32 v149, v150, v151
    v_cvt_pk_bf16_f32 v150, v152, v153
    v_cvt_pk_bf16_f32 v151, v154, v155
    ds_write_b128 v41, v[148:151] offset:53248
    v_pk_mul_f32 v[156:157], v[156:157], v[38:39]
    v_pk_mul_f32 v[158:159], v[158:159], v[38:39]
    v_pk_mul_f32 v[160:161], v[160:161], v[38:39]
    v_pk_mul_f32 v[162:163], v[162:163], v[38:39]
    v_cvt_pk_bf16_f32 v156, v156, v157
    v_cvt_pk_bf16_f32 v157, v158, v159
    v_cvt_pk_bf16_f32 v158, v160, v161
    v_cvt_pk_bf16_f32 v159, v162, v163
    ds_write_b128 v41, v[156:159] offset:57344
    v_pk_mul_f32 v[164:165], v[164:165], v[38:39]
    v_pk_mul_f32 v[166:167], v[166:167], v[38:39]
    v_pk_mul_f32 v[168:169], v[168:169], v[38:39]
    v_pk_mul_f32 v[170:171], v[170:171], v[38:39]
    v_cvt_pk_bf16_f32 v164, v164, v165
    v_cvt_pk_bf16_f32 v165, v166, v167
    v_cvt_pk_bf16_f32 v166, v168, v169
    v_cvt_pk_bf16_f32 v167, v170, v171
    ds_write_b128 v41, v[164:167] offset:61440
    v_pk_mul_f32 v[172:173], v[172:173], v[38:39]
    v_pk_mul_f32 v[174:175], v[174:175], v[38:39]
    v_pk_mul_f32 v[176:177], v[176:177], v[38:39]
    v_pk_mul_f32 v[178:179], v[178:179], v[38:39]
    v_cvt_pk_bf16_f32 v172, v172, v173
    v_cvt_pk_bf16_f32 v173, v174, v175
    v_cvt_pk_bf16_f32 v174, v176, v177
    v_cvt_pk_bf16_f32 v175, v178, v179
    ds_write_b128 v42, v[172:175] offset:0
    v_pk_mul_f32 v[180:181], v[180:181], v[38:39]
    v_pk_mul_f32 v[182:183], v[182:183], v[38:39]
    v_pk_mul_f32 v[184:185], v[184:185], v[38:39]
    v_pk_mul_f32 v[186:187], v[186:187], v[38:39]
    v_cvt_pk_bf16_f32 v180, v180, v181
    v_cvt_pk_bf16_f32 v181, v182, v183
    v_cvt_pk_bf16_f32 v182, v184, v185
    v_cvt_pk_bf16_f32 v183, v186, v187
    ds_write_b128 v42, v[180:183] offset:4096
    v_mov_b32 v40, 0
    s_lshl_b32 s36, s22, 3
    s_add_u32 s37, s36, s34
    s_lshl_b32 s37, s37, 3
    s_add_u32 s37, s37, s21
    s_lshl_b32 s37, s37, 2
    s_add_u32 s3, s37, 2379776
    s_add_u32 s37, s36, s35
    s_lshl_b32 s37, s37, 3
    s_add_u32 s37, s37, s21
    s_lshl_b32 s37, s37, 2
    s_add_u32 s100, s37, 2379776
    s_lshl_b32 s37, s22, 2
    s_add_u32 s37, s37, s20
    s_lshl_b32 s37, s37, 3
    s_add_u32 s37, s37, s21
    s_lshl_b32 s37, s37, 2
    s_add_u32 s101, s37, 2392064
    s_mov_b64 exec, 1
    buffer_store_dword v40, v40, s[16:19], s3 offen sc1
    buffer_store_dword v40, v40, s[16:19], s100 offen sc1
    buffer_store_dword v40, v40, s[16:19], s101 offen sc1
    s_mov_b64 exec, -1
    v_mov_b32 v44, -1
    v_mov_b32 v45, -1
    v_mov_b32 v46, -1
    v_mov_b32 v47, -1
    v_lshrrev_b32 v48, 3, v1
    v_and_b32 v49, 7, v1
    s_lshl_b32 s36, s21, 6
    s_lshl_b32 s37, s20, 4
    s_add_u32 s36, s36, s37
    v_add_u32 v48, s36, v48
    v_lshlrev_b32 v48, 12, v48
    v_lshl_add_u32 v48, v49, 4, v48
    s_lshl_b32 s38, s22, 7
    s_add_u32 s38, s38, 2424832
    s_add_u32 s37, s38, 32768
    buffer_store_dwordx4 v[44:47], v48, s[16:19], s38 offen sc1
    buffer_store_dwordx4 v[44:47], v48, s[16:19], s37 offen sc1
    s_cmp_lg_u32 s20, 3
    s_cbranch_scc1 M_NOCLR
    v_lshrrev_b32 v48, 1, v1
    v_and_b32 v49, 1, v1
    s_and_b32 s36, s21, 1
    s_lshl_b32 s36, s36, 5
    s_add_u32 s36, s36, 512
    v_add_u32 v48, s36, v48
    v_lshlrev_b32 v48, 12, v48
    v_lshl_add_u32 v48, v49, 4, v48
    s_lshr_b32 s36, s21, 1
    s_lshl_b32 s36, s36, 5
    s_add_u32 s36, s36, s38
    buffer_store_dwordx4 v[44:47], v48, s[16:19], s36 offen sc1
M_NOCLR:
    s_waitcnt lgkmcnt(0)
    s_barrier
    v_and_b32 v2, 15, v1
    v_lshrrev_b32 v3, 4, v1
    v_lshrrev_b32 v52, 2, v2
    v_and_b32 v53, 3, v2
    v_lshrrev_b32 v54, 1, v3
    v_lshlrev_b32 v54, 10, v54
    v_lshrrev_b32 v55, 1, v53
    v_lshl_add_u32 v54, v55, 8, v54
    v_and_b32 v55, 1, v3
    v_lshl_add_u32 v55, v55, 3, v52
    v_lshl_add_u32 v54, v55, 4, v54
    v_and_b32 v55, 1, v53
    v_lshl_add_u32 v54, v55, 3, v54
    v_lshlrev_b32 v55, 12, v2
    v_lshl_add_u32 v55, v3, 4, v55
    s_lshl_b32 s36, s22, 7
    v_add_u32 v55, s36, v55
    s_lshl_b32 s37, s20, 3
    s_add_u32 s37, s37, s21
    s_lshr_b32 s38, s37, 1
    s_add_u32 s38, s38, 18
    s_sub_u32 s38, s38, s43
    s_cmp_ge_u32 s38, 18
    s_cselect_b32 s36, 18, 0
    s_sub_u32 s38, s38, s36
    s_lshl_b32 s38, s38, 12
    s_and_b32 s36, s37, 1
    s_lshl_b32 s36, s36, 9
    s_add_u32 s38, s38, s36
    v_add_u32 v56, s38, v54
    ds_read_b64_tr_b16 v[34:35], v56 offset:0
    ds_read_b64_tr_b16 v[36:37], v56 offset:64
    ds_read_b64_tr_b16 v[38:39], v56 offset:2048
    ds_read_b64_tr_b16 v[40:41], v56 offset:2112
    s_lshl_b32 s38, s37, 16
    s_waitcnt lgkmcnt(0)
    s_mov_b32 s29, s38
    s_cmp_lg_u32 s20, 3
    s_cbranch_scc1 M_NOUT2
    s_cmp_ge_u32 s21, 4
    s_cbranch_scc1 M_NOUT2
    s_add_u32 s37, s21, 32
    s_lshr_b32 s38, s37, 1
    s_add_u32 s38, s38, 18
    s_sub_u32 s38, s38, s43
    s_cmp_ge_u32 s38, 18
    s_cselect_b32 s36, 18, 0
    s_sub_u32 s38, s38, s36
    s_lshl_b32 s38, s38, 12
    s_and_b32 s36, s37, 1
    s_lshl_b32 s36, s36, 9
    s_add_u32 s38, s38, s36
    v_add_u32 v56, s38, v54
    ds_read_b64_tr_b16 v[42:43], v56 offset:0
    ds_read_b64_tr_b16 v[44:45], v56 offset:64
    ds_read_b64_tr_b16 v[46:47], v56 offset:2048
    ds_read_b64_tr_b16 v[48:49], v56 offset:2112
    s_lshl_b32 s38, s37, 16
    s_waitcnt lgkmcnt(0)
    buffer_store_dwordx4 v[42:45], v55, s[16:19], s38 offen offset:0 sc1
    buffer_store_dwordx4 v[46:49], v55, s[16:19], s38 offen offset:64 sc1
M_NOUT2:
    s_mov_b32 s39, 0xbfb8aa3b
    buffer_store_dwordx4 v[34:37], v55, s[16:19], s29 offen offset:0 sc1
    buffer_store_dwordx4 v[38:41], v55, s[16:19], s29 offen offset:64 sc1
    ds_read_b128 a[0:3], v28 offset:0
    ds_read_b128 a[4:7], v28 offset:1024
    ds_read_b128 a[8:11], v28 offset:2048
    ds_read_b128 a[12:15], v28 offset:3072
    s_waitcnt vmcnt(19)
    ds_read_b64_tr_b16 v[64:65], v10 offset:0
    ds_read_b64_tr_b16 v[66:67], v10 offset:512
    ds_read_b64_tr_b16 v[68:69], v11 offset:0
    ds_read_b64_tr_b16 v[70:71], v11 offset:512
    ds_read_b64_tr_b16 v[72:73], v12 offset:0
    ds_read_b64_tr_b16 v[74:75], v12 offset:512
    ds_read_b64_tr_b16 v[76:77], v13 offset:0
    ds_read_b64_tr_b16 v[78:79], v13 offset:512
    s_waitcnt vmcnt(15) lgkmcnt(0)
    v_mfma_f32_16x16x32_bf16 v[96:99], v[64:67], a[0:3], 0
    ds_read_b64_tr_b16 v[80:81], v10 offset:4096
    v_mfma_f32_16x16x32_bf16 v[100:103], v[64:67], a[4:7], 0
    ds_read_b64_tr_b16 v[82:83], v10 offset:4608
    v_mfma_f32_16x16x32_bf16 v[104:107], v[64:67], a[8:11], 0
    ds_read_b64_tr_b16 v[84:85], v11 offset:4096
    v_mfma_f32_16x16x32_bf16 v[108:111], v[64:67], a[12:15], 0
    ds_read_b64_tr_b16 v[86:87], v11 offset:4608
    v_mfma_f32_16x16x32_bf16 v[112:115], v[68:71], a[0:3], 0
    ds_read_b64_tr_b16 v[88:89], v12 offset:4096
    v_mfma_f32_16x16x32_bf16 v[116:119], v[68:71], a[4:7], 0
    ds_read_b64_tr_b16 v[90:91], v12 offset:4608
    v_mfma_f32_16x16x32_bf16 v[120:123], v[68:71], a[8:11], 0
    ds_read_b64_tr_b16 v[92:93], v13 offset:4096
    v_mfma_f32_16x16x32_bf16 v[124:127], v[68:71], a[12:15], 0
    ds_read_b64_tr_b16 v[94:95], v13 offset:4608
    s_add_u32 m0, s25, 0
    s_add_u32 s30, s27, s64
    v_mfma_f32_16x16x32_bf16 v[128:131], v[72:75], a[0:3], 0
    ds_read_b128 a[16:19], v28 offset:4096
    buffer_load_dwordx4 v4, s[8:11], s30 offen lds
    v_mfma_f32_16x16x32_bf16 v[132:135], v[72:75], a[4:7], 0
    ds_read_b128 a[20:23], v28 offset:5120
    v_mfma_f32_16x16x32_bf16 v[136:139], v[72:75], a[8:11], 0
    ds_read_b128 a[24:27], v28 offset:6144
    buffer_load_dwordx4 v5, s[8:11], s30 offen offset:1024 lds
    v_mfma_f32_16x16x32_bf16 v[140:143], v[72:75], a[12:15], 0
    ds_read_b128 a[28:31], v28 offset:7168
    buffer_load_dwordx4 v6, s[8:11], s30 offen offset:2048 lds
    v_mfma_f32_16x16x32_bf16 v[144:147], v[76:79], a[0:3], 0
    v_mfma_f32_16x16x32_bf16 v[148:151], v[76:79], a[4:7], 0
    buffer_load_dwordx4 v7, s[8:11], s30 offen offset:3072 lds
    v_mfma_f32_16x16x32_bf16 v[152:155], v[76:79], a[8:11], 0
    v_mfma_f32_16x16x32_bf16 v[156:159], v[76:79], a[12:15], 0
    s_waitcnt vmcnt(15) lgkmcnt(0)
    v_mfma_f32_16x16x32_bf16 v[96:99], v[80:83], a[16:19], v[96:99]
    ds_read_b64_tr_b16 v[64:65], v10 offset:8192
    v_mfma_f32_16x16x32_bf16 v[100:103], v[80:83], a[20:23], v[100:103]
    ds_read_b64_tr_b16 v[66:67], v10 offset:8704
    v_mfma_f32_16x16x32_bf16 v[104:107], v[80:83], a[24:27], v[104:107]
    ds_read_b64_tr_b16 v[68:69], v11 offset:8192
    v_mfma_f32_16x16x32_bf16 v[108:111], v[80:83], a[28:31], v[108:111]
    ds_read_b64_tr_b16 v[70:71], v11 offset:8704
    v_mfma_f32_16x16x32_bf16 v[112:115], v[84:87], a[16:19], v[112:115]
    ds_read_b64_tr_b16 v[72:73], v12 offset:8192
    v_mfma_f32_16x16x32_bf16 v[116:119], v[84:87], a[20:23], v[116:119]
    ds_read_b64_tr_b16 v[74:75], v12 offset:8704
    v_mfma_f32_16x16x32_bf16 v[120:123], v[84:87], a[24:27], v[120:123]
    ds_read_b64_tr_b16 v[76:77], v13 offset:8192
    v_mfma_f32_16x16x32_bf16 v[124:127], v[84:87], a[28:31], v[124:127]
    ds_read_b64_tr_b16 v[78:79], v13 offset:8704
    s_add_u32 m0, s25, 4096
    s_add_u32 s30, s27, s65
    v_mfma_f32_16x16x32_bf16 v[128:131], v[88:91], a[16:19], v[128:131]
    ds_read_b128 a[32:35], v28 offset:8192
    buffer_load_dwordx4 v4, s[8:11], s30 offen lds
    v_mfma_f32_16x16x32_bf16 v[132:135], v[88:91], a[20:23], v[132:135]
    ds_read_b128 a[36:39], v28 offset:9216
    v_mfma_f32_16x16x32_bf16 v[136:139], v[88:91], a[24:27], v[136:139]
    ds_read_b128 a[40:43], v28 offset:10240
    buffer_load_dwordx4 v5, s[8:11], s30 offen offset:1024 lds
    v_mfma_f32_16x16x32_bf16 v[140:143], v[88:91], a[28:31], v[140:143]
    ds_read_b128 a[44:47], v28 offset:11264
    buffer_load_dwordx4 v6, s[8:11], s30 offen offset:2048 lds
    v_mfma_f32_16x16x32_bf16 v[144:147], v[92:95], a[16:19], v[144:147]
    v_mfma_f32_16x16x32_bf16 v[148:151], v[92:95], a[20:23], v[148:151]
    buffer_load_dwordx4 v7, s[8:11], s30 offen offset:3072 lds
    v_mfma_f32_16x16x32_bf16 v[152:155], v[92:95], a[24:27], v[152:155]
    v_mfma_f32_16x16x32_bf16 v[156:159], v[92:95], a[28:31], v[156:159]
    s_waitcnt vmcnt(15) lgkmcnt(0)
    v_mfma_f32_16x16x32_bf16 v[96:99], v[64:67], a[32:35], v[96:99]
    ds_read_b64_tr_b16 v[80:81], v10 offset:12288
    v_mfma_f32_16x16x32_bf16 v[100:103], v[64:67], a[36:39], v[100:103]
    ds_read_b64_tr_b16 v[82:83], v10 offset:12800
    v_mfma_f32_16x16x32_bf16 v[104:107], v[64:67], a[40:43], v[104:107]
    ds_read_b64_tr_b16 v[84:85], v11 offset:12288
    v_mfma_f32_16x16x32_bf16 v[108:111], v[64:67], a[44:47], v[108:111]
    ds_read_b64_tr_b16 v[86:87], v11 offset:12800
    v_mfma_f32_16x16x32_bf16 v[112:115], v[68:71], a[32:35], v[112:115]
    ds_read_b64_tr_b16 v[88:89], v12 offset:12288
    v_mfma_f32_16x16x32_bf16 v[116:119], v[68:71], a[36:39], v[116:119]
    ds_read_b64_tr_b16 v[90:91], v12 offset:12800
    v_mfma_f32_16x16x32_bf16 v[120:123], v[68:71], a[40:43], v[120:123]
    ds_read_b64_tr_b16 v[92:93], v13 offset:12288
    v_mfma_f32_16x16x32_bf16 v[124:127], v[68:71], a[44:47], v[124:127]
    ds_read_b64_tr_b16 v[94:95], v13 offset:12800
    s_add_u32 m0, s25, 8192
    s_add_u32 s30, s27, s66
    v_mfma_f32_16x16x32_bf16 v[128:131], v[72:75], a[32:35], v[128:131]
    ds_read_b128 a[48:51], v28 offset:12288
    buffer_load_dwordx4 v4, s[8:11], s30 offen lds
    v_mfma_f32_16x16x32_bf16 v[132:135], v[72:75], a[36:39], v[132:135]
    ds_read_b128 a[52:55], v28 offset:13312
    v_mfma_f32_16x16x32_bf16 v[136:139], v[72:75], a[40:43], v[136:139]
    ds_read_b128 a[56:59], v28 offset:14336
    buffer_load_dwordx4 v5, s[8:11], s30 offen offset:1024 lds
    v_mfma_f32_16x16x32_bf16 v[140:143], v[72:75], a[44:47], v[140:143]
    ds_read_b128 a[60:63], v28 offset:15360
    buffer_load_dwordx4 v6, s[8:11], s30 offen offset:2048 lds
    v_mfma_f32_16x16x32_bf16 v[144:147], v[76:79], a[32:35], v[144:147]
    v_mfma_f32_16x16x32_bf16 v[148:151], v[76:79], a[36:39], v[148:151]
    buffer_load_dwordx4 v7, s[8:11], s30 offen offset:3072 lds
    v_mfma_f32_16x16x32_bf16 v[152:155], v[76:79], a[40:43], v[152:155]
    v_mfma_f32_16x16x32_bf16 v[156:159], v[76:79], a[44:47], v[156:159]
    s_waitcnt vmcnt(8) lgkmcnt(0)
    v_mfma_f32_16x16x32_bf16 v[96:99], v[80:83], a[48:51], v[96:99]
    ds_read_b64_tr_b16 v[64:65], v10 offset:0
    v_mfma_f32_16x16x32_bf16 v[100:103], v[80:83], a[52:55], v[100:103]
    ds_read_b64_tr_b16 v[66:67], v10 offset:512
    v_mfma_f32_16x16x32_bf16 v[104:107], v[80:83], a[56:59], v[104:107]
    ds_read_b64_tr_b16 v[68:69], v11 offset:0
    v_mfma_f32_16x16x32_bf16 v[108:111], v[80:83], a[60:63], v[108:111]
    ds_read_b64_tr_b16 v[70:71], v11 offset:512
    v_mfma_f32_16x16x32_bf16 v[112:115], v[84:87], a[48:51], v[112:115]
    ds_read_b64_tr_b16 v[72:73], v12 offset:0
    v_mfma_f32_16x16x32_bf16 v[116:119], v[84:87], a[52:55], v[116:119]
    ds_read_b64_tr_b16 v[74:75], v12 offset:512
    v_mfma_f32_16x16x32_bf16 v[120:123], v[84:87], a[56:59], v[120:123]
    ds_read_b64_tr_b16 v[76:77], v13 offset:0
    v_mfma_f32_16x16x32_bf16 v[124:127], v[84:87], a[60:63], v[124:127]
    ds_read_b64_tr_b16 v[78:79], v13 offset:512
    s_add_u32 m0, s25, 12288
    s_add_u32 s30, s27, s67
    v_mfma_f32_16x16x32_bf16 v[128:131], v[88:91], a[48:51], v[128:131]
    ds_read_b128 a[64:67], v28 offset:16384
    buffer_load_dwordx4 v4, s[8:11], s30 offen lds
    v_mfma_f32_16x16x32_bf16 v[132:135], v[88:91], a[52:55], v[132:135]
    ds_read_b128 a[68:71], v28 offset:17408
    v_mfma_f32_16x16x32_bf16 v[136:139], v[88:91], a[56:59], v[136:139]
    ds_read_b128 a[72:75], v28 offset:18432
    buffer_load_dwordx4 v5, s[8:11], s30 offen offset:1024 lds
    v_mfma_f32_16x16x32_bf16 v[140:143], v[88:91], a[60:63], v[140:143]
    ds_read_b128 a[76:79], v28 offset:19456
    buffer_load_dwordx4 v6, s[8:11], s30 offen offset:2048 lds
    v_mfma_f32_16x16x32_bf16 v[144:147], v[92:95], a[48:51], v[144:147]
    v_mfma_f32_16x16x32_bf16 v[148:151], v[92:95], a[52:55], v[148:151]
    buffer_load_dwordx4 v7, s[8:11], s30 offen offset:3072 lds
    v_mfma_f32_16x16x32_bf16 v[152:155], v[92:95], a[56:59], v[152:155]
    v_mfma_f32_16x16x32_bf16 v[156:159], v[92:95], a[60:63], v[156:159]
    s_waitcnt vmcnt(8) lgkmcnt(0)
    v_mfma_f32_16x16x32_bf16 v[96:99], v[64:67], a[64:67], v[96:99]
    ds_read_b64_tr_b16 v[80:81], v10 offset:4096
    v_mfma_f32_16x16x32_bf16 v[100:103], v[64:67], a[68:71], v[100:103]
    ds_read_b64_tr_b16 v[82:83], v10 offset:4608
    v_mfma_f32_16x16x32_bf16 v[104:107], v[64:67], a[72:75], v[104:107]
    ds_read_b64_tr_b16 v[84:85], v11 offset:4096
    v_mfma_f32_16x16x32_bf16 v[108:111], v[64:67], a[76:79], v[108:111]
    ds_read_b64_tr_b16 v[86:87], v11 offset:4608
    v_mfma_f32_16x16x32_bf16 v[112:115], v[68:71], a[64:67], v[112:115]
    ds_read_b64_tr_b16 v[88:89], v12 offset:4096
    v_mfma_f32_16x16x32_bf16 v[116:119], v[68:71], a[68:71], v[116:119]
    ds_read_b64_tr_b16 v[90:91], v12 offset:4608
    v_mfma_f32_16x16x32_bf16 v[120:123], v[68:71], a[72:75], v[120:123]
    ds_read_b64_tr_b16 v[92:93], v13 offset:4096
    v_mfma_f32_16x16x32_bf16 v[124:127], v[68:71], a[76:79], v[124:127]
    ds_read_b64_tr_b16 v[94:95], v13 offset:4608
    s_add_u32 m0, s25, 0
    s_add_u32 s30, s27, s68
    v_mfma_f32_16x16x32_bf16 v[128:131], v[72:75], a[64:67], v[128:131]
    ds_read_b128 a[80:83], v28 offset:20480
    buffer_load_dwordx4 v4, s[8:11], s30 offen lds
    v_mfma_f32_16x16x32_bf16 v[132:135], v[72:75], a[68:71], v[132:135]
    ds_read_b128 a[84:87], v28 offset:21504
    v_mfma_f32_16x16x32_bf16 v[136:139], v[72:75], a[72:75], v[136:139]
    ds_read_b128 a[88:91], v28 offset:22528
    buffer_load_dwordx4 v5, s[8:11], s30 offen offset:1024 lds
    v_mfma_f32_16x16x32_bf16 v[140:143], v[72:75], a[76:79], v[140:143]
    ds_read_b128 a[92:95], v28 offset:23552
    buffer_load_dwordx4 v6, s[8:11], s30 offen offset:2048 lds
    v_mfma_f32_16x16x32_bf16 v[144:147], v[76:79], a[64:67], v[144:147]
    v_mfma_f32_16x16x32_bf16 v[148:151], v[76:79], a[68:71], v[148:151]
    buffer_load_dwordx4 v7, s[8:11], s30 offen offset:3072 lds
    v_mfma_f32_16x16x32_bf16 v[152:155], v[76:79], a[72:75], v[152:155]
    v_mfma_f32_16x16x32_bf16 v[156:159], v[76:79], a[76:79], v[156:159]
    s_waitcnt vmcnt(8) lgkmcnt(0)
    v_mfma_f32_16x16x32_bf16 v[96:99], v[80:83], a[80:83], v[96:99]
    ds_read_b64_tr_b16 v[64:65], v10 offset:8192
    v_mfma_f32_16x16x32_bf16 v[100:103], v[80:83], a[84:87], v[100:103]
    ds_read_b64_tr_b16 v[66:67], v10 offset:8704
    v_mfma_f32_16x16x32_bf16 v[104:107], v[80:83], a[88:91], v[104:107]
    ds_read_b64_tr_b16 v[68:69], v11 offset:8192
    v_mfma_f32_16x16x32_bf16 v[108:111], v[80:83], a[92:95], v[108:111]
    ds_read_b64_tr_b16 v[70:71], v11 offset:8704
    v_mfma_f32_16x16x32_bf16 v[112:115], v[84:87], a[80:83], v[112:115]
    ds_read_b64_tr_b16 v[72:73], v12 offset:8192
    v_mfma_f32_16x16x32_bf16 v[116:119], v[84:87], a[84:87], v[116:119]
    ds_read_b64_tr_b16 v[74:75], v12 offset:8704
    v_mfma_f32_16x16x32_bf16 v[120:123], v[84:87], a[88:91], v[120:123]
    ds_read_b64_tr_b16 v[76:77], v13 offset:8192
    v_mfma_f32_16x16x32_bf16 v[124:127], v[84:87], a[92:95], v[124:127]
    ds_read_b64_tr_b16 v[78:79], v13 offset:8704
    s_add_u32 m0, s25, 4096
    s_add_u32 s30, s27, s69
    v_mfma_f32_16x16x32_bf16 v[128:131], v[88:91], a[80:83], v[128:131]
    ds_read_b128 a[96:99], v28 offset:24576
    buffer_load_dwordx4 v4, s[8:11], s30 offen lds
    v_mfma_f32_16x16x32_bf16 v[132:135], v[88:91], a[84:87], v[132:135]
    ds_read_b128 a[100:103], v28 offset:25600
    v_mfma_f32_16x16x32_bf16 v[136:139], v[88:91], a[88:91], v[136:139]
    ds_read_b128 a[104:107], v28 offset:26624
    buffer_load_dwordx4 v5, s[8:11], s30 offen offset:1024 lds
    v_mfma_f32_16x16x32_bf16 v[140:143], v[88:91], a[92:95], v[140:143]
    ds_read_b128 a[108:111], v28 offset:27648
    buffer_load_dwordx4 v6, s[8:11], s30 offen offset:2048 lds
    v_mfma_f32_16x16x32_bf16 v[144:147], v[92:95], a[80:83], v[144:147]
    v_mfma_f32_16x16x32_bf16 v[148:151], v[92:95], a[84:87], v[148:151]
    buffer_load_dwordx4 v7, s[8:11], s30 offen offset:3072 lds
    v_mfma_f32_16x16x32_bf16 v[152:155], v[92:95], a[88:91], v[152:155]
    v_mfma_f32_16x16x32_bf16 v[156:159], v[92:95], a[92:95], v[156:159]
    s_waitcnt vmcnt(8) lgkmcnt(0)
    v_mfma_f32_16x16x32_bf16 v[96:99], v[64:67], a[96:99], v[96:99]
    ds_read_b64_tr_b16 v[80:81], v10 offset:12288
    v_mfma_f32_16x16x32_bf16 v[100:103], v[64:67], a[100:103], v[100:103]
    ds_read_b64_tr_b16 v[82:83], v10 offset:12800
    v_mfma_f32_16x16x32_bf16 v[104:107], v[64:67], a[104:107], v[104:107]
    ds_read_b64_tr_b16 v[84:85], v11 offset:12288
    v_mfma_f32_16x16x32_bf16 v[108:111], v[64:67], a[108:111], v[108:111]
    ds_read_b64_tr_b16 v[86:87], v11 offset:12800
    v_mfma_f32_16x16x32_bf16 v[112:115], v[68:71], a[96:99], v[112:115]
    ds_read_b64_tr_b16 v[88:89], v12 offset:12288
    v_mfma_f32_16x16x32_bf16 v[116:119], v[68:71], a[100:103], v[116:119]
    ds_read_b64_tr_b16 v[90:91], v12 offset:12800
    v_mfma_f32_16x16x32_bf16 v[120:123], v[68:71], a[104:107], v[120:123]
    ds_read_b64_tr_b16 v[92:93], v13 offset:12288
    v_mfma_f32_16x16x32_bf16 v[124:127], v[68:71], a[108:111], v[124:127]
    ds_read_b64_tr_b16 v[94:95], v13 offset:12800
    s_add_u32 m0, s25, 8192
    s_add_u32 s30, s27, s70
    v_mfma_f32_16x16x32_bf16 v[128:131], v[72:75], a[96:99], v[128:131]
    ds_read_b128 a[112:115], v28 offset:28672
    buffer_load_dwordx4 v4, s[8:11], s30 offen lds
    v_mfma_f32_16x16x32_bf16 v[132:135], v[72:75], a[100:103], v[132:135]
    ds_read_b128 a[116:119], v28 offset:29696
    v_mfma_f32_16x16x32_bf16 v[136:139], v[72:75], a[104:107], v[136:139]
    ds_read_b128 a[120:123], v28 offset:30720
    buffer_load_dwordx4 v5, s[8:11], s30 offen offset:1024 lds
    v_mfma_f32_16x16x32_bf16 v[140:143], v[72:75], a[108:111], v[140:143]
    ds_read_b128 a[124:127], v28 offset:31744
    buffer_load_dwordx4 v6, s[8:11], s30 offen offset:2048 lds
    v_mfma_f32_16x16x32_bf16 v[144:147], v[76:79], a[96:99], v[144:147]
    v_mfma_f32_16x16x32_bf16 v[148:151], v[76:79], a[100:103], v[148:151]
    buffer_load_dwordx4 v7, s[8:11], s30 offen offset:3072 lds
    v_mfma_f32_16x16x32_bf16 v[152:155], v[76:79], a[104:107], v[152:155]
    v_mfma_f32_16x16x32_bf16 v[156:159], v[76:79], a[108:111], v[156:159]
    s_waitcnt vmcnt(8) lgkmcnt(0)
    v_mfma_f32_16x16x32_bf16 v[96:99], v[80:83], a[112:115], v[96:99]
    ds_read_b64_tr_b16 v[64:65], v10 offset:0
    v_mfma_f32_16x16x32_bf16 v[100:103], v[80:83], a[116:119], v[100:103]
    ds_read_b64_tr_b16 v[66:67], v10 offset:512
    v_mfma_f32_16x16x32_bf16 v[104:107], v[80:83], a[120:123], v[104:107]
    ds_read_b64_tr_b16 v[68:69], v11 offset:0
    v_mfma_f32_16x16x32_bf16 v[108:111], v[80:83], a[124:127], v[108:111]
    ds_read_b64_tr_b16 v[70:71], v11 offset:512
    v_mfma_f32_16x16x32_bf16 v[112:115], v[84:87], a[112:115], v[112:115]
    ds_read_b64_tr_b16 v[72:73], v12 offset:0
    v_mfma_f32_16x16x32_bf16 v[116:119], v[84:87], a[116:119], v[116:119]
    ds_read_b64_tr_b16 v[74:75], v12 offset:512
    v_mfma_f32_16x16x32_bf16 v[120:123], v[84:87], a[120:123], v[120:123]
    ds_read_b64_tr_b16 v[76:77], v13 offset:0
    v_mfma_f32_16x16x32_bf16 v[124:127], v[84:87], a[124:127], v[124:127]
    ds_read_b64_tr_b16 v[78:79], v13 offset:512
    s_add_u32 m0, s25, 12288
    s_add_u32 s30, s27, s71
    v_mfma_f32_16x16x32_bf16 v[128:131], v[88:91], a[112:115], v[128:131]
    ds_read_b128 a[128:131], v28 offset:32768
    buffer_load_dwordx4 v4, s[8:11], s30 offen lds
    v_mfma_f32_16x16x32_bf16 v[132:135], v[88:91], a[116:119], v[132:135]
    ds_read_b128 a[132:135], v28 offset:33792
    v_mfma_f32_16x16x32_bf16 v[136:139], v[88:91], a[120:123], v[136:139]
    ds_read_b128 a[136:139], v28 offset:34816
    buffer_load_dwordx4 v5, s[8:11], s30 offen offset:1024 lds
    v_mfma_f32_16x16x32_bf16 v[140:143], v[88:91], a[124:127], v[140:143]
    ds_read_b128 a[140:143], v28 offset:35840
    buffer_load_dwordx4 v6, s[8:11], s30 offen offset:2048 lds
    v_mfma_f32_16x16x32_bf16 v[144:147], v[92:95], a[112:115], v[144:147]
    v_mfma_f32_16x16x32_bf16 v[148:151], v[92:95], a[116:119], v[148:151]
    buffer_load_dwordx4 v7, s[8:11], s30 offen offset:3072 lds
    v_mfma_f32_16x16x32_bf16 v[152:155], v[92:95], a[120:123], v[152:155]
    v_mfma_f32_16x16x32_bf16 v[156:159], v[92:95], a[124:127], v[156:159]
    s_waitcnt vmcnt(8) lgkmcnt(0)
    v_mfma_f32_16x16x32_bf16 v[96:99], v[64:67], a[128:131], v[96:99]
    ds_read_b64_tr_b16 v[80:81], v10 offset:4096
    v_mfma_f32_16x16x32_bf16 v[100:103], v[64:67], a[132:135], v[100:103]
    ds_read_b64_tr_b16 v[82:83], v10 offset:4608
    v_mfma_f32_16x16x32_bf16 v[104:107], v[64:67], a[136:139], v[104:107]
    ds_read_b64_tr_b16 v[84:85], v11 offset:4096
    v_mfma_f32_16x16x32_bf16 v[108:111], v[64:67], a[140:143], v[108:111]
    ds_read_b64_tr_b16 v[86:87], v11 offset:4608
    v_mfma_f32_16x16x32_bf16 v[112:115], v[68:71], a[128:131], v[112:115]
    ds_read_b64_tr_b16 v[88:89], v12 offset:4096
    v_mfma_f32_16x16x32_bf16 v[116:119], v[68:71], a[132:135], v[116:119]
    ds_read_b64_tr_b16 v[90:91], v12 offset:4608
    v_mfma_f32_16x16x32_bf16 v[120:123], v[68:71], a[136:139], v[120:123]
    ds_read_b64_tr_b16 v[92:93], v13 offset:4096
    v_mfma_f32_16x16x32_bf16 v[124:127], v[68:71], a[140:143], v[124:127]
    ds_read_b64_tr_b16 v[94:95], v13 offset:4608
    s_add_u32 m0, s25, 0
    s_add_u32 s30, s27, s72
    v_mfma_f32_16x16x32_bf16 v[128:131], v[72:75], a[128:131], v[128:131]
    ds_read_b128 a[144:147], v28 offset:36864
    buffer_load_dwordx4 v4, s[8:11], s30 offen lds
    v_mfma_f32_16x16x32_bf16 v[132:135], v[72:75], a[132:135], v[132:135]
    ds_read_b128 a[148:151], v28 offset:37888
    v_mfma_f32_16x16x32_bf16 v[136:139], v[72:75], a[136:139], v[136:139]
    ds_read_b128 a[152:155], v28 offset:38912
    buffer_load_dwordx4 v5, s[8:11], s30 offen offset:1024 lds
    v_mfma_f32_16x16x32_bf16 v[140:143], v[72:75], a[140:143], v[140:143]
    ds_read_b128 a[156:159], v28 offset:39936
    buffer_load_dwordx4 v6, s[8:11], s30 offen offset:2048 lds
    v_mfma_f32_16x16x32_bf16 v[144:147], v[76:79], a[128:131], v[144:147]
    v_mfma_f32_16x16x32_bf16 v[148:151], v[76:79], a[132:135], v[148:151]
    buffer_load_dwordx4 v7, s[8:11], s30 offen offset:3072 lds
    v_mfma_f32_16x16x32_bf16 v[152:155], v[76:79], a[136:139], v[152:155]
    v_mfma_f32_16x16x32_bf16 v[156:159], v[76:79], a[140:143], v[156:159]
    s_waitcnt vmcnt(8) lgkmcnt(0)
    v_mfma_f32_16x16x32_bf16 v[96:99], v[80:83], a[144:147], v[96:99]
    ds_read_b64_tr_b16 v[64:65], v10 offset:8192
    v_mfma_f32_16x16x32_bf16 v[100:103], v[80:83], a[148:151], v[100:103]
    ds_read_b64_tr_b16 v[66:67], v10 offset:8704
    v_mfma_f32_16x16x32_bf16 v[104:107], v[80:83], a[152:155], v[104:107]
    ds_read_b64_tr_b16 v[68:69], v11 offset:8192
    v_mfma_f32_16x16x32_bf16 v[108:111], v[80:83], a[156:159], v[108:111]
    ds_read_b64_tr_b16 v[70:71], v11 offset:8704
    v_mfma_f32_16x16x32_bf16 v[112:115], v[84:87], a[144:147], v[112:115]
    ds_read_b64_tr_b16 v[72:73], v12 offset:8192
    v_mfma_f32_16x16x32_bf16 v[116:119], v[84:87], a[148:151], v[116:119]
    ds_read_b64_tr_b16 v[74:75], v12 offset:8704
    v_mfma_f32_16x16x32_bf16 v[120:123], v[84:87], a[152:155], v[120:123]
    ds_read_b64_tr_b16 v[76:77], v13 offset:8192
    v_mfma_f32_16x16x32_bf16 v[124:127], v[84:87], a[156:159], v[124:127]
    ds_read_b64_tr_b16 v[78:79], v13 offset:8704
    s_add_u32 m0, s25, 4096
    s_add_u32 s30, s27, s73
    v_mfma_f32_16x16x32_bf16 v[128:131], v[88:91], a[144:147], v[128:131]
    ds_read_b128 a[160:163], v28 offset:40960
    buffer_load_dwordx4 v4, s[8:11], s30 offen lds
    v_mfma_f32_16x16x32_bf16 v[132:135], v[88:91], a[148:151], v[132:135]
    ds_read_b128 a[164:167], v28 offset:41984
    v_mfma_f32_16x16x32_bf16 v[136:139], v[88:91], a[152:155], v[136:139]
    ds_read_b128 a[168:171], v28 offset:43008
    buffer_load_dwordx4 v5, s[8:11], s30 offen offset:1024 lds
    v_mfma_f32_16x16x32_bf16 v[140:143], v[88:91], a[156:159], v[140:143]
    ds_read_b128 a[172:175], v28 offset:44032
    buffer_load_dwordx4 v6, s[8:11], s30 offen offset:2048 lds
    v_mfma_f32_16x16x32_bf16 v[144:147], v[92:95], a[144:147], v[144:147]
    v_mfma_f32_16x16x32_bf16 v[148:151], v[92:95], a[148:151], v[148:151]
    buffer_load_dwordx4 v7, s[8:11], s30 offen offset:3072 lds
    v_mfma_f32_16x16x32_bf16 v[152:155], v[92:95], a[152:155], v[152:155]
    v_mfma_f32_16x16x32_bf16 v[156:159], v[92:95], a[156:159], v[156:159]
    s_waitcnt vmcnt(8) lgkmcnt(0)
    v_mfma_f32_16x16x32_bf16 v[96:99], v[64:67], a[160:163], v[96:99]
    ds_read_b64_tr_b16 v[80:81], v10 offset:12288
    v_mfma_f32_16x16x32_bf16 v[100:103], v[64:67], a[164:167], v[100:103]
    ds_read_b64_tr_b16 v[82:83], v10 offset:12800
    v_mfma_f32_16x16x32_bf16 v[104:107], v[64:67], a[168:171], v[104:107]
    ds_read_b64_tr_b16 v[84:85], v11 offset:12288
    v_mfma_f32_16x16x32_bf16 v[108:111], v[64:67], a[172:175], v[108:111]
    ds_read_b64_tr_b16 v[86:87], v11 offset:12800
    v_mfma_f32_16x16x32_bf16 v[112:115], v[68:71], a[160:163], v[112:115]
    ds_read_b64_tr_b16 v[88:89], v12 offset:12288
    v_mfma_f32_16x16x32_bf16 v[116:119], v[68:71], a[164:167], v[116:119]
    ds_read_b64_tr_b16 v[90:91], v12 offset:12800
    v_mfma_f32_16x16x32_bf16 v[120:123], v[68:71], a[168:171], v[120:123]
    ds_read_b64_tr_b16 v[92:93], v13 offset:12288
    v_mfma_f32_16x16x32_bf16 v[124:127], v[68:71], a[172:175], v[124:127]
    ds_read_b64_tr_b16 v[94:95], v13 offset:12800
    s_add_u32 m0, s25, 8192
    s_add_u32 s30, s27, s74
    v_mfma_f32_16x16x32_bf16 v[128:131], v[72:75], a[160:163], v[128:131]
    ds_read_b128 a[176:179], v28 offset:45056
    buffer_load_dwordx4 v4, s[8:11], s30 offen lds
    v_mfma_f32_16x16x32_bf16 v[132:135], v[72:75], a[164:167], v[132:135]
    ds_read_b128 a[180:183], v28 offset:46080
    v_mfma_f32_16x16x32_bf16 v[136:139], v[72:75], a[168:171], v[136:139]
    ds_read_b128 a[184:187], v28 offset:47104
    buffer_load_dwordx4 v5, s[8:11], s30 offen offset:1024 lds
    v_mfma_f32_16x16x32_bf16 v[140:143], v[72:75], a[172:175], v[140:143]
    ds_read_b128 a[188:191], v28 offset:48128
    buffer_load_dwordx4 v6, s[8:11], s30 offen offset:2048 lds
    v_mfma_f32_16x16x32_bf16 v[144:147], v[76:79], a[160:163], v[144:147]
    v_mfma_f32_16x16x32_bf16 v[148:151], v[76:79], a[164:167], v[148:151]
    buffer_load_dwordx4 v7, s[8:11], s30 offen offset:3072 lds
    v_mfma_f32_16x16x32_bf16 v[152:155], v[76:79], a[168:171], v[152:155]
    v_mfma_f32_16x16x32_bf16 v[156:159], v[76:79], a[172:175], v[156:159]
    s_waitcnt vmcnt(8) lgkmcnt(0)
    v_mfma_f32_16x16x32_bf16 v[96:99], v[80:83], a[176:179], v[96:99]
    ds_read_b64_tr_b16 v[64:65], v10 offset:0
    v_mfma_f32_16x16x32_bf16 v[100:103], v[80:83], a[180:183], v[100:103]
    ds_read_b64_tr_b16 v[66:67], v10 offset:512
    v_mfma_f32_16x16x32_bf16 v[104:107], v[80:83], a[184:187], v[104:107]
    ds_read_b64_tr_b16 v[68:69], v11 offset:0
    v_mfma_f32_16x16x32_bf16 v[108:111], v[80:83], a[188:191], v[108:111]
    ds_read_b64_tr_b16 v[70:71], v11 offset:512
    v_mfma_f32_16x16x32_bf16 v[112:115], v[84:87], a[176:179], v[112:115]
    ds_read_b64_tr_b16 v[72:73], v12 offset:0
    v_mfma_f32_16x16x32_bf16 v[116:119], v[84:87], a[180:183], v[116:119]
    ds_read_b64_tr_b16 v[74:75], v12 offset:512
    v_mfma_f32_16x16x32_bf16 v[120:123], v[84:87], a[184:187], v[120:123]
    ds_read_b64_tr_b16 v[76:77], v13 offset:0
    v_mfma_f32_16x16x32_bf16 v[124:127], v[84:87], a[188:191], v[124:127]
    ds_read_b64_tr_b16 v[78:79], v13 offset:512
    s_add_u32 m0, s25, 12288
    s_add_u32 s30, s27, s75
    v_mfma_f32_16x16x32_bf16 v[128:131], v[88:91], a[176:179], v[128:131]
    ds_read_b128 a[192:195], v28 offset:49152
    buffer_load_dwordx4 v4, s[8:11], s30 offen lds
    v_mfma_f32_16x16x32_bf16 v[132:135], v[88:91], a[180:183], v[132:135]
    ds_read_b128 a[196:199], v28 offset:50176
    v_mfma_f32_16x16x32_bf16 v[136:139], v[88:91], a[184:187], v[136:139]
    ds_read_b128 a[200:203], v28 offset:51200
    buffer_load_dwordx4 v5, s[8:11], s30 offen offset:1024 lds
    v_mfma_f32_16x16x32_bf16 v[140:143], v[88:91], a[188:191], v[140:143]
    ds_read_b128 a[204:207], v28 offset:52224
    buffer_load_dwordx4 v6, s[8:11], s30 offen offset:2048 lds
    v_mfma_f32_16x16x32_bf16 v[144:147], v[92:95], a[176:179], v[144:147]
    v_mfma_f32_16x16x32_bf16 v[148:151], v[92:95], a[180:183], v[148:151]
    buffer_load_dwordx4 v7, s[8:11], s30 offen offset:3072 lds
    v_mfma_f32_16x16x32_bf16 v[152:155], v[92:95], a[184:187], v[152:155]
    v_mfma_f32_16x16x32_bf16 v[156:159], v[92:95], a[188:191], v[156:159]
    s_waitcnt vmcnt(8) lgkmcnt(0)
    v_mfma_f32_16x16x32_bf16 v[96:99], v[64:67], a[192:195], v[96:99]
    ds_read_b64_tr_b16 v[80:81], v10 offset:4096
    v_mfma_f32_16x16x32_bf16 v[100:103], v[64:67], a[196:199], v[100:103]
    ds_read_b64_tr_b16 v[82:83], v10 offset:4608
    v_mfma_f32_16x16x32_bf16 v[104:107], v[64:67], a[200:203], v[104:107]
    ds_read_b64_tr_b16 v[84:85], v11 offset:4096
    v_mfma_f32_16x16x32_bf16 v[108:111], v[64:67], a[204:207], v[108:111]
    ds_read_b64_tr_b16 v[86:87], v11 offset:4608
    v_mfma_f32_16x16x32_bf16 v[112:115], v[68:71], a[192:195], v[112:115]
    ds_read_b64_tr_b16 v[88:89], v12 offset:4096
    v_mfma_f32_16x16x32_bf16 v[116:119], v[68:71], a[196:199], v[116:119]
    ds_read_b64_tr_b16 v[90:91], v12 offset:4608
    v_mfma_f32_16x16x32_bf16 v[120:123], v[68:71], a[200:203], v[120:123]
    ds_read_b64_tr_b16 v[92:93], v13 offset:4096
    v_mfma_f32_16x16x32_bf16 v[124:127], v[68:71], a[204:207], v[124:127]
    ds_read_b64_tr_b16 v[94:95], v13 offset:4608
    s_add_u32 m0, s25, 0
    s_add_u32 s30, s27, s76
    v_mfma_f32_16x16x32_bf16 v[128:131], v[72:75], a[192:195], v[128:131]
    ds_read_b128 a[208:211], v28 offset:53248
    buffer_load_dwordx4 v4, s[8:11], s30 offen lds
    v_mfma_f32_16x16x32_bf16 v[132:135], v[72:75], a[196:199], v[132:135]
    ds_read_b128 a[212:215], v28 offset:54272
    v_mfma_f32_16x16x32_bf16 v[136:139], v[72:75], a[200:203], v[136:139]
    ds_read_b128 a[216:219], v28 offset:55296
    buffer_load_dwordx4 v5, s[8:11], s30 offen offset:1024 lds
    v_mfma_f32_16x16x32_bf16 v[140:143], v[72:75], a[204:207], v[140:143]
    ds_read_b128 a[220:223], v28 offset:56320
    buffer_load_dwordx4 v6, s[8:11], s30 offen offset:2048 lds
    v_mfma_f32_16x16x32_bf16 v[144:147], v[76:79], a[192:195], v[144:147]
    v_mfma_f32_16x16x32_bf16 v[148:151], v[76:79], a[196:199], v[148:151]
    buffer_load_dwordx4 v7, s[8:11], s30 offen offset:3072 lds
    v_mfma_f32_16x16x32_bf16 v[152:155], v[76:79], a[200:203], v[152:155]
    v_mfma_f32_16x16x32_bf16 v[156:159], v[76:79], a[204:207], v[156:159]
    s_waitcnt vmcnt(8) lgkmcnt(0)
    v_mfma_f32_16x16x32_bf16 v[96:99], v[80:83], a[208:211], v[96:99]
    ds_read_b64_tr_b16 v[64:65], v10 offset:8192
    v_mfma_f32_16x16x32_bf16 v[100:103], v[80:83], a[212:215], v[100:103]
    ds_read_b64_tr_b16 v[66:67], v10 offset:8704
    v_mfma_f32_16x16x32_bf16 v[104:107], v[80:83], a[216:219], v[104:107]
    ds_read_b64_tr_b16 v[68:69], v11 offset:8192
    v_mfma_f32_16x16x32_bf16 v[108:111], v[80:83], a[220:223], v[108:111]
    ds_read_b64_tr_b16 v[70:71], v11 offset:8704
    v_mfma_f32_16x16x32_bf16 v[112:115], v[84:87], a[208:211], v[112:115]
    ds_read_b64_tr_b16 v[72:73], v12 offset:8192
    v_mfma_f32_16x16x32_bf16 v[116:119], v[84:87], a[212:215], v[116:119]
    ds_read_b64_tr_b16 v[74:75], v12 offset:8704
    v_mfma_f32_16x16x32_bf16 v[120:123], v[84:87], a[216:219], v[120:123]
    ds_read_b64_tr_b16 v[76:77], v13 offset:8192
    v_mfma_f32_16x16x32_bf16 v[124:127], v[84:87], a[220:223], v[124:127]
    ds_read_b64_tr_b16 v[78:79], v13 offset:8704
    s_add_u32 m0, s25, 4096
    s_add_u32 s30, s27, s77
    v_mfma_f32_16x16x32_bf16 v[128:131], v[88:91], a[208:211], v[128:131]
    ds_read_b128 a[224:227], v28 offset:57344
    buffer_load_dwordx4 v4, s[8:11], s30 offen lds
    v_mfma_f32_16x16x32_bf16 v[132:135], v[88:91], a[212:215], v[132:135]
    ds_read_b128 a[228:231], v28 offset:58368
    v_mfma_f32_16x16x32_bf16 v[136:139], v[88:91], a[216:219], v[136:139]
    ds_read_b128 a[232:235], v28 offset:59392
    buffer_load_dwordx4 v5, s[8:11], s30 offen offset:1024 lds
    v_mfma_f32_16x16x32_bf16 v[140:143], v[88:91], a[220:223], v[140:143]
    ds_read_b128 a[236:239], v28 offset:60416
    buffer_load_dwordx4 v6, s[8:11], s30 offen offset:2048 lds
    v_mfma_f32_16x16x32_bf16 v[144:147], v[92:95], a[208:211], v[144:147]
    v_mfma_f32_16x16x32_bf16 v[148:151], v[92:95], a[212:215], v[148:151]
    buffer_load_dwordx4 v7, s[8:11], s30 offen offset:3072 lds
    v_mfma_f32_16x16x32_bf16 v[152:155], v[92:95], a[216:219], v[152:155]
    v_mfma_f32_16x16x32_bf16 v[156:159], v[92:95], a[220:223], v[156:159]
    s_waitcnt vmcnt(8) lgkmcnt(0)
    v_mfma_f32_16x16x32_bf16 v[96:99], v[64:67], a[224:227], v[96:99]
    ds_read_b64_tr_b16 v[80:81], v10 offset:12288
    v_mfma_f32_16x16x32_bf16 v[100:103], v[64:67], a[228:231], v[100:103]
    ds_read_b64_tr_b16 v[82:83], v10 offset:12800
    v_mfma_f32_16x16x32_bf16 v[104:107], v[64:67], a[232:235], v[104:107]
    ds_read_b64_tr_b16 v[84:85], v11 offset:12288
    v_mfma_f32_16x16x32_bf16 v[108:111], v[64:67], a[236:239], v[108:111]
    ds_read_b64_tr_b16 v[86:87], v11 offset:12800
    v_mfma_f32_16x16x32_bf16 v[112:115], v[68:71], a[224:227], v[112:115]
    ds_read_b64_tr_b16 v[88:89], v12 offset:12288
    v_mfma_f32_16x16x32_bf16 v[116:119], v[68:71], a[228:231], v[116:119]
    ds_read_b64_tr_b16 v[90:91], v12 offset:12800
    v_mfma_f32_16x16x32_bf16 v[120:123], v[68:71], a[232:235], v[120:123]
    ds_read_b64_tr_b16 v[92:93], v13 offset:12288
    v_mfma_f32_16x16x32_bf16 v[124:127], v[68:71], a[236:239], v[124:127]
    ds_read_b64_tr_b16 v[94:95], v13 offset:12800
    s_add_u32 m0, s25, 8192
    s_cmp_eq_u32 s24, 0
    s_cselect_b32 s30, s60, s69
    s_add_u32 s30, s30, s26
    v_mfma_f32_16x16x32_bf16 v[128:131], v[72:75], a[224:227], v[128:131]
    ds_read_b128 a[240:243], v28 offset:61440
    buffer_load_dwordx4 v8, s[8:11], s30 offen lds
    v_mfma_f32_16x16x32_bf16 v[132:135], v[72:75], a[228:231], v[132:135]
    ds_read_b128 a[244:247], v28 offset:62464
    buffer_load_dwordx4 v9, s[8:11], s30 offen offset:1024 lds
    v_mfma_f32_16x16x32_bf16 v[136:139], v[72:75], a[232:235], v[136:139]
    ds_read_b128 a[248:251], v28 offset:63488
    v_mfma_f32_16x16x32_bf16 v[140:143], v[72:75], a[236:239], v[140:143]
    ds_read_b128 a[252:255], v28 offset:64512
    s_add_u32 m0, s25, 10240
    s_cmp_eq_u32 s24, 0
    s_cselect_b32 s30, s61, s70
    s_add_u32 s30, s30, s26
    v_mfma_f32_16x16x32_bf16 v[144:147], v[76:79], a[224:227], v[144:147]
    buffer_load_dwordx4 v8, s[8:11], s30 offen lds
    v_mfma_f32_16x16x32_bf16 v[148:151], v[76:79], a[228:231], v[148:151]
    buffer_load_dwordx4 v9, s[8:11], s30 offen offset:1024 lds
    v_mfma_f32_16x16x32_bf16 v[152:155], v[76:79], a[232:235], v[152:155]
    v_mfma_f32_16x16x32_bf16 v[156:159], v[76:79], a[236:239], v[156:159]
    s_waitcnt vmcnt(8) lgkmcnt(0)
    v_mfma_f32_16x16x32_bf16 v[96:99], v[80:83], a[240:243], v[96:99]
    ds_read_b64_tr_b16 v[64:65], v10 offset:0
    v_mfma_f32_16x16x32_bf16 v[100:103], v[80:83], a[244:247], v[100:103]
    ds_read_b64_tr_b16 v[66:67], v10 offset:512
    v_mfma_f32_16x16x32_bf16 v[104:107], v[80:83], a[248:251], v[104:107]
    ds_read_b64_tr_b16 v[68:69], v11 offset:0
    v_mfma_f32_16x16x32_bf16 v[108:111], v[80:83], a[252:255], v[108:111]
    ds_read_b64_tr_b16 v[70:71], v11 offset:512
    v_mfma_f32_16x16x32_bf16 v[112:115], v[84:87], a[240:243], v[112:115]
    ds_read_b64_tr_b16 v[72:73], v12 offset:0
    v_mfma_f32_16x16x32_bf16 v[116:119], v[84:87], a[244:247], v[116:119]
    ds_read_b64_tr_b16 v[74:75], v12 offset:512
    v_mfma_f32_16x16x32_bf16 v[120:123], v[84:87], a[248:251], v[120:123]
    ds_read_b64_tr_b16 v[76:77], v13 offset:0
    v_mfma_f32_16x16x32_bf16 v[124:127], v[84:87], a[252:255], v[124:127]
    ds_read_b64_tr_b16 v[78:79], v13 offset:512
    s_add_u32 m0, s25, 12288
    s_cmp_eq_u32 s24, 0
    s_cselect_b32 s30, s62, s71
    s_add_u32 s30, s30, s26
    v_mfma_f32_16x16x32_bf16 v[128:131], v[88:91], a[240:243], v[128:131]
    ds_read_b128 v[224:227], v29 offset:0
    buffer_load_dwordx4 v8, s[8:11], s30 offen lds
    v_mfma_f32_16x16x32_bf16 v[132:135], v[88:91], a[244:247], v[132:135]
    ds_read_b128 v[228:231], v29 offset:1024
    buffer_load_dwordx4 v9, s[8:11], s30 offen offset:1024 lds
    v_mfma_f32_16x16x32_bf16 v[136:139], v[88:91], a[248:251], v[136:139]
    ds_read_b128 v[232:235], v29 offset:2048
    v_mfma_f32_16x16x32_bf16 v[140:143], v[88:91], a[252:255], v[140:143]
    ds_read_b128 v[236:239], v29 offset:3072
    s_add_u32 m0, s25, 14336
    s_cmp_eq_u32 s24, 0
    s_cselect_b32 s30, s63, s72
    s_add_u32 s30, s30, s26
    v_mfma_f32_16x16x32_bf16 v[144:147], v[92:95], a[240:243], v[144:147]
    buffer_load_dwordx4 v8, s[8:11], s30 offen lds
    v_mfma_f32_16x16x32_bf16 v[148:151], v[92:95], a[244:247], v[148:151]
    buffer_load_dwordx4 v9, s[8:11], s30 offen offset:1024 lds
    v_mfma_f32_16x16x32_bf16 v[152:155], v[92:95], a[248:251], v[152:155]
    v_mfma_f32_16x16x32_bf16 v[156:159], v[92:95], a[252:255], v[156:159]
    s_waitcnt vmcnt(8) lgkmcnt(0)
    v_mfma_f32_16x16x32_bf16 v[96:99], v[64:67], v[224:227], v[96:99]
    ds_read_b64_tr_b16 v[80:81], v10 offset:4096
    v_mfma_f32_16x16x32_bf16 v[100:103], v[64:67], v[228:231], v[100:103]
    ds_read_b64_tr_b16 v[82:83], v10 offset:4608
    v_mfma_f32_16x16x32_bf16 v[104:107], v[64:67], v[232:235], v[104:107]
    ds_read_b64_tr_b16 v[84:85], v11 offset:4096
    v_mfma_f32_16x16x32_bf16 v[108:111], v[64:67], v[236:239], v[108:111]
    ds_read_b64_tr_b16 v[86:87], v11 offset:4608
    v_mfma_f32_16x16x32_bf16 v[112:115], v[68:71], v[224:227], v[112:115]
    ds_read_b64_tr_b16 v[88:89], v12 offset:4096
    v_mfma_f32_16x16x32_bf16 v[116:119], v[68:71], v[228:231], v[116:119]
    ds_read_b64_tr_b16 v[90:91], v12 offset:4608
    v_mfma_f32_16x16x32_bf16 v[120:123], v[68:71], v[232:235], v[120:123]
    ds_read_b64_tr_b16 v[92:93], v13 offset:4096
    v_mfma_f32_16x16x32_bf16 v[124:127], v[68:71], v[236:239], v[124:127]
    ds_read_b64_tr_b16 v[94:95], v13 offset:4608
    s_add_u32 m0, s25, 0
    s_cmp_eq_u32 s24, 0
    s_cselect_b32 s30, s64, s73
    s_add_u32 s30, s30, s26
    v_mfma_f32_16x16x32_bf16 v[128:131], v[72:75], v[224:227], v[128:131]
    ds_read_b128 v[240:243], v29 offset:4096
    buffer_load_dwordx4 v8, s[8:11], s30 offen lds
    v_mfma_f32_16x16x32_bf16 v[132:135], v[72:75], v[228:231], v[132:135]
    ds_read_b128 v[244:247], v29 offset:5120
    buffer_load_dwordx4 v9, s[8:11], s30 offen offset:1024 lds
    v_mfma_f32_16x16x32_bf16 v[136:139], v[72:75], v[232:235], v[136:139]
    ds_read_b128 v[248:251], v29 offset:6144
    v_mfma_f32_16x16x32_bf16 v[140:143], v[72:75], v[236:239], v[140:143]
    ds_read_b128 v[252:255], v29 offset:7168
    s_add_u32 m0, s25, 2048
    s_cmp_eq_u32 s24, 0
    s_cselect_b32 s30, s65, s74
    s_add_u32 s30, s30, s26
    v_mfma_f32_16x16x32_bf16 v[144:147], v[76:79], v[224:227], v[144:147]
    buffer_load_dwordx4 v8, s[8:11], s30 offen lds
    v_mfma_f32_16x16x32_bf16 v[148:151], v[76:79], v[228:231], v[148:151]
    buffer_load_dwordx4 v9, s[8:11], s30 offen offset:1024 lds
    v_mfma_f32_16x16x32_bf16 v[152:155], v[76:79], v[232:235], v[152:155]
    v_mfma_f32_16x16x32_bf16 v[156:159], v[76:79], v[236:239], v[156:159]
    s_waitcnt vmcnt(10) lgkmcnt(0)
    v_mfma_f32_16x16x32_bf16 v[96:99], v[80:83], v[240:243], v[96:99]
    ds_read_b64_tr_b16 v[64:65], v14 offset:8192
    v_mfma_f32_16x16x32_bf16 v[100:103], v[80:83], v[244:247], v[100:103]
    ds_read_b64_tr_b16 v[66:67], v14 offset:8448
    v_mfma_f32_16x16x32_bf16 v[104:107], v[80:83], v[248:251], v[104:107]
    ds_read_b64_tr_b16 v[68:69], v15 offset:8192
    v_mfma_f32_16x16x32_bf16 v[108:111], v[80:83], v[252:255], v[108:111]
    ds_read_b64_tr_b16 v[70:71], v15 offset:8448
    v_mfma_f32_16x16x32_bf16 v[112:115], v[84:87], v[240:243], v[112:115]
    v_mfma_f32_16x16x32_bf16 v[116:119], v[84:87], v[244:247], v[116:119]
    v_mfma_f32_16x16x32_bf16 v[120:123], v[84:87], v[248:251], v[120:123]
    v_mfma_f32_16x16x32_bf16 v[124:127], v[84:87], v[252:255], v[124:127]
    s_add_u32 m0, s25, 4096
    s_cmp_eq_u32 s24, 0
    s_cselect_b32 s30, s66, s75
    s_add_u32 s30, s30, s26
    v_mfma_f32_16x16x32_bf16 v[128:131], v[88:91], v[240:243], v[128:131]
    buffer_load_dwordx4 v8, s[8:11], s30 offen lds
    v_mfma_f32_16x16x32_bf16 v[132:135], v[88:91], v[244:247], v[132:135]
    buffer_load_dwordx4 v9, s[8:11], s30 offen offset:1024 lds
    v_mfma_f32_16x16x32_bf16 v[136:139], v[88:91], v[248:251], v[136:139]
    v_mfma_f32_16x16x32_bf16 v[140:143], v[88:91], v[252:255], v[140:143]
    s_add_u32 m0, s25, 6144
    s_cmp_eq_u32 s24, 0
    s_cselect_b32 s30, s67, s76
    s_add_u32 s30, s30, s26
    v_mfma_f32_16x16x32_bf16 v[144:147], v[92:95], v[240:243], v[144:147]
    buffer_load_dwordx4 v8, s[8:11], s30 offen lds
    v_mfma_f32_16x16x32_bf16 v[148:151], v[92:95], v[244:247], v[148:151]
    buffer_load_dwordx4 v9, s[8:11], s30 offen offset:1024 lds
    v_mfma_f32_16x16x32_bf16 v[152:155], v[92:95], v[248:251], v[152:155]
    v_mfma_f32_16x16x32_bf16 v[156:159], v[92:95], v[252:255], v[156:159]
    s_waitcnt lgkmcnt(0)
    s_barrier
    s_cmp_lg_u32 s20, 0
    s_cbranch_scc1 M_NOARR1
    s_and_b32 s36, s2, 3
    s_lshl_b32 s36, s36, 6
    v_mov_b32 v58, 1
    v_mov_b32 v59, 0
    s_mov_b64 exec, 1
    buffer_atomic_add v58, v59, s[56:59], s36 offen sc1
    s_mov_b64 exec, -1
M_NOARR1:
    s_lshl_b32 s36, s34, 1
    s_add_u32 s36, s36, 18
    s_sub_u32 s36, s36, s43
    s_cmp_ge_u32 s36, 18
    s_cselect_b32 s37, 18, 0
    s_sub_u32 s36, s36, s37
    s_lshl_b32 s36, s36, 12
    v_add_u32 v30, s36, v28
    s_lshl_b32 s36, s34, 1
    s_add_u32 s36, s36, 1
    s_add_u32 s36, s36, 18
    s_sub_u32 s36, s36, s43
    s_cmp_ge_u32 s36, 18
    s_cselect_b32 s37, 18, 0
    s_sub_u32 s36, s36, s37
    s_lshl_b32 s36, s36, 12
    v_add_u32 v3, s36, v28
    s_add_u32 s36, s23, 16
    s_add_u32 s36, s36, 18
    s_sub_u32 s36, s36, s43
    s_cmp_ge_u32 s36, 18
    s_cselect_b32 s37, 18, 0
    s_sub_u32 s36, s36, s37
    s_lshl_b32 s36, s36, 12
    v_add_u32 v60, s36, v28
    s_lshl_b32 s37, s24, 11
    v_add_u32 v60, s37, v60
    s_cmp_eq_u32 s24, 0
    s_cbranch_scc0 M_G1S_WK1
    s_waitcnt vmcnt(12) lgkmcnt(0)
    v_mfma_f32_16x16x32_bf16 v[160:163], v[64:67], a[0:3], 0
    ds_read_b64_tr_b16 v[80:81], v14 offset:10240
    v_exp_f32 v34, v96
    v_exp_f32 v35, v97
    v_mfma_f32_16x16x32_bf16 v[164:167], v[64:67], a[4:7], 0
    ds_read_b64_tr_b16 v[82:83], v14 offset:10496
    v_exp_f32 v36, v98
    v_exp_f32 v37, v99
    v_add_f32 v34, 1.0, v34
    v_mfma_f32_16x16x32_bf16 v[168:171], v[64:67], a[8:11], 0
    ds_read_b64_tr_b16 v[84:85], v15 offset:10240
    v_add_f32 v35, 1.0, v35
    v_add_f32 v36, 1.0, v36
    v_add_f32 v37, 1.0, v37
    v_mfma_f32_16x16x32_bf16 v[172:175], v[64:67], a[12:15], 0
    ds_read_b64_tr_b16 v[86:87], v15 offset:10496
    s_add_u32 m0, s25, 8192
    s_add_u32 s30, s26, s68
    v_rcp_f32 v34, v34
    v_rcp_f32 v35, v35
    v_rcp_f32 v36, v36
    v_mfma_f32_16x16x32_bf16 v[176:179], v[68:71], a[0:3], 0
    buffer_load_dwordx4 v8, s[8:11], s30 offen lds
    v_rcp_f32 v37, v37
    v_mul_f32 v96, v96, v34
    v_mfma_f32_16x16x32_bf16 v[180:183], v[68:71], a[4:7], 0
    buffer_load_dwordx4 v9, s[8:11], s30 offen offset:1024 lds
    v_mul_f32 v97, v97, v35
    v_mul_f32 v98, v98, v36
    v_mul_f32 v99, v99, v37
    v_mfma_f32_16x16x32_bf16 v[184:187], v[68:71], a[8:11], 0
    v_exp_f32 v38, v112
    v_exp_f32 v39, v113
    v_exp_f32 v40, v114
    v_mfma_f32_16x16x32_bf16 v[188:191], v[68:71], a[12:15], 0
    v_exp_f32 v41, v115
    v_add_f32 v38, 1.0, v38
    v_add_f32 v39, 1.0, v39
    s_waitcnt vmcnt(12) lgkmcnt(0)
    v_mfma_f32_16x16x32_bf16 v[160:163], v[80:83], a[16:19], v[160:163]
    ds_read_b64_tr_b16 v[64:65], v14 offset:12288
    v_add_f32 v40, 1.0, v40
    v_add_f32 v41, 1.0, v41
    v_mfma_f32_16x16x32_bf16 v[164:167], v[80:83], a[20:23], v[164:167]
    ds_read_b64_tr_b16 v[66:67], v14 offset:12544
    v_rcp_f32 v38, v38
    v_rcp_f32 v39, v39
    v_rcp_f32 v40, v40
    v_mfma_f32_16x16x32_bf16 v[168:171], v[80:83], a[24:27], v[168:171]
    ds_read_b64_tr_b16 v[68:69], v15 offset:12288
    v_rcp_f32 v41, v41
    v_mul_f32 v112, v112, v38
    v_mfma_f32_16x16x32_bf16 v[172:175], v[80:83], a[28:31], v[172:175]
    ds_read_b64_tr_b16 v[70:71], v15 offset:12544
    v_mul_f32 v113, v113, v39
    v_mul_f32 v114, v114, v40
    v_mul_f32 v115, v115, v41
    v_mfma_f32_16x16x32_bf16 v[176:179], v[84:87], a[16:19], v[176:179]
    v_cvt_pk_bf16_f32 v42, v96, v97
    v_cvt_pk_bf16_f32 v43, v98, v99
    v_cvt_pk_bf16_f32 v44, v112, v113
    v_mfma_f32_16x16x32_bf16 v[180:183], v[84:87], a[20:23], v[180:183]
    v_cvt_pk_bf16_f32 v45, v114, v115
    ds_write_b128 v30, v[42:45] offset:0
    v_mfma_f32_16x16x32_bf16 v[184:187], v[84:87], a[24:27], v[184:187]
    v_exp_f32 v34, v100
    v_exp_f32 v35, v101
    v_exp_f32 v36, v102
    v_mfma_f32_16x16x32_bf16 v[188:191], v[84:87], a[28:31], v[188:191]
    v_exp_f32 v37, v103
    v_add_f32 v34, 1.0, v34
    v_add_f32 v35, 1.0, v35
    s_waitcnt vmcnt(10) lgkmcnt(1)
    v_mfma_f32_16x16x32_bf16 v[160:163], v[64:67], a[32:35], v[160:163]
    ds_read_b64_tr_b16 v[80:81], v14 offset:14336
    v_add_f32 v36, 1.0, v36
    v_add_f32 v37, 1.0, v37
    v_mfma_f32_16x16x32_bf16 v[164:167], v[64:67], a[36:39], v[164:167]
    ds_read_b64_tr_b16 v[82:83], v14 offset:14592
    v_rcp_f32 v34, v34
    v_rcp_f32 v35, v35
    v_rcp_f32 v36, v36
    v_mfma_f32_16x16x32_bf16 v[168:171], v[64:67], a[40:43], v[168:171]
    ds_read_b64_tr_b16 v[84:85], v15 offset:14336
    v_rcp_f32 v37, v37
    v_mul_f32 v100, v100, v34
    v_mfma_f32_16x16x32_bf16 v[172:175], v[64:67], a[44:47], v[172:175]
    ds_read_b64_tr_b16 v[86:87], v15 offset:14592
    v_mul_f32 v101, v101, v35
    v_mul_f32 v102, v102, v36
    v_mul_f32 v103, v103, v37
    v_mfma_f32_16x16x32_bf16 v[176:179], v[68:71], a[32:35], v[176:179]
    v_exp_f32 v38, v116
    v_exp_f32 v39, v117
    v_exp_f32 v40, v118
    v_mfma_f32_16x16x32_bf16 v[180:183], v[68:71], a[36:39], v[180:183]
    v_exp_f32 v41, v119
    v_add_f32 v38, 1.0, v38
    v_mfma_f32_16x16x32_bf16 v[184:187], v[68:71], a[40:43], v[184:187]
    v_add_f32 v39, 1.0, v39
    v_add_f32 v40, 1.0, v40
    v_add_f32 v41, 1.0, v41
    v_mfma_f32_16x16x32_bf16 v[188:191], v[68:71], a[44:47], v[188:191]
    v_rcp_f32 v38, v38
    v_rcp_f32 v39, v39
    v_rcp_f32 v40, v40
    s_waitcnt vmcnt(8) lgkmcnt(0)
    v_mfma_f32_16x16x32_bf16 v[160:163], v[80:83], a[48:51], v[160:163]
    ds_read_b64_tr_b16 v[64:65], v14 offset:0
    v_rcp_f32 v41, v41
    v_mul_f32 v116, v116, v38
    v_mfma_f32_16x16x32_bf16 v[164:167], v[80:83], a[52:55], v[164:167]
    ds_read_b64_tr_b16 v[66:67], v14 offset:256
    v_mul_f32 v117, v117, v39
    v_mul_f32 v118, v118, v40
    v_mul_f32 v119, v119, v41
    v_mfma_f32_16x16x32_bf16 v[168:171], v[80:83], a[56:59], v[168:171]
    ds_read_b64_tr_b16 v[68:69], v15 offset:0
    v_cvt_pk_bf16_f32 v46, v100, v101
    v_cvt_pk_bf16_f32 v47, v102, v103
    v_mfma_f32_16x16x32_bf16 v[172:175], v[80:83], a[60:63], v[172:175]
    ds_read_b64_tr_b16 v[70:71], v15 offset:256
    s_add_u32 m0, s25, 12288
    s_add_u32 s30, s28, s60
    v_cvt_pk_bf16_f32 v48, v116, v117
    v_cvt_pk_bf16_f32 v49, v118, v119
    ds_write_b128 v30, v[46:49] offset:1024
    v_mfma_f32_16x16x32_bf16 v[176:179], v[84:87], a[48:51], v[176:179]
    buffer_load_dwordx4 v4, s[8:11], s30 offen lds
    v_exp_f32 v34, v104
    v_exp_f32 v35, v105
    v_exp_f32 v36, v106
    v_mfma_f32_16x16x32_bf16 v[180:183], v[84:87], a[52:55], v[180:183]
    buffer_load_dwordx4 v5, s[8:11], s30 offen offset:1024 lds
    v_exp_f32 v37, v107
    v_add_f32 v34, 1.0, v34
    v_mfma_f32_16x16x32_bf16 v[184:187], v[84:87], a[56:59], v[184:187]
    v_add_f32 v35, 1.0, v35
    v_add_f32 v36, 1.0, v36
    v_add_f32 v37, 1.0, v37
    v_mfma_f32_16x16x32_bf16 v[188:191], v[84:87], a[60:63], v[188:191]
    v_rcp_f32 v34, v34
    v_rcp_f32 v35, v35
    v_rcp_f32 v36, v36
    s_waitcnt vmcnt(8) lgkmcnt(1)
    v_mfma_f32_16x16x32_bf16 v[160:163], v[64:67], a[64:67], v[160:163]
    ds_read_b64_tr_b16 v[80:81], v14 offset:2048
    v_rcp_f32 v37, v37
    v_mul_f32 v104, v104, v34
    v_mfma_f32_16x16x32_bf16 v[164:167], v[64:67], a[68:71], v[164:167]
    ds_read_b64_tr_b16 v[82:83], v14 offset:2304
    v_mul_f32 v105, v105, v35
    v_mul_f32 v106, v106, v36
    v_mul_f32 v107, v107, v37
    v_mfma_f32_16x16x32_bf16 v[168:171], v[64:67], a[72:75], v[168:171]
    ds_read_b64_tr_b16 v[84:85], v15 offset:2048
    v_exp_f32 v38, v120
    v_exp_f32 v39, v121
    v_mfma_f32_16x16x32_bf16 v[172:175], v[64:67], a[76:79], v[172:175]
    ds_read_b64_tr_b16 v[86:87], v15 offset:2304
    buffer_load_dwordx4 v6, s[8:11], s30 offen offset:2048 lds
    v_exp_f32 v40, v122
    v_exp_f32 v41, v123
    v_add_f32 v38, 1.0, v38
    v_mfma_f32_16x16x32_bf16 v[176:179], v[68:71], a[64:67], v[176:179]
    v_add_f32 v39, 1.0, v39
    v_add_f32 v40, 1.0, v40
    v_add_f32 v41, 1.0, v41
    v_mfma_f32_16x16x32_bf16 v[180:183], v[68:71], a[68:71], v[180:183]
    buffer_load_dwordx4 v7, s[8:11], s30 offen offset:3072 lds
    v_rcp_f32 v38, v38
    v_rcp_f32 v39, v39
    v_mfma_f32_16x16x32_bf16 v[184:187], v[68:71], a[72:75], v[184:187]
    v_rcp_f32 v40, v40
    v_rcp_f32 v41, v41
    v_mul_f32 v120, v120, v38
    v_mfma_f32_16x16x32_bf16 v[188:191], v[68:71], a[76:79], v[188:191]
    v_mul_f32 v121, v121, v39
    v_mul_f32 v122, v122, v40
    v_mul_f32 v123, v123, v41
    s_waitcnt vmcnt(8) lgkmcnt(0)
    v_mfma_f32_16x16x32_bf16 v[160:163], v[80:83], a[80:83], v[160:163]
    ds_read_b64_tr_b16 v[64:65], v14 offset:4096
    v_cvt_pk_bf16_f32 v42, v104, v105
    v_cvt_pk_bf16_f32 v43, v106, v107
    v_mfma_f32_16x16x32_bf16 v[164:167], v[80:83], a[84:87], v[164:167]
    ds_read_b64_tr_b16 v[66:67], v14 offset:4352
    v_cvt_pk_bf16_f32 v44, v120, v121
    v_cvt_pk_bf16_f32 v45, v122, v123
    ds_write_b128 v30, v[42:45] offset:2048
    v_mfma_f32_16x16x32_bf16 v[168:171], v[80:83], a[88:91], v[168:171]
    ds_read_b64_tr_b16 v[68:69], v15 offset:4096
    v_exp_f32 v34, v108
    v_exp_f32 v35, v109
    v_mfma_f32_16x16x32_bf16 v[172:175], v[80:83], a[92:95], v[172:175]
    ds_read_b64_tr_b16 v[70:71], v15 offset:4352
    s_add_u32 m0, s25, 0
    s_add_u32 s30, s28, s61
    v_exp_f32 v36, v110
    v_exp_f32 v37, v111
    v_add_f32 v34, 1.0, v34
    v_mfma_f32_16x16x32_bf16 v[176:179], v[84:87], a[80:83], v[176:179]
    buffer_load_dwordx4 v4, s[8:11], s30 offen lds
    v_add_f32 v35, 1.0, v35
    v_add_f32 v36, 1.0, v36
    v_add_f32 v37, 1.0, v37
    v_mfma_f32_16x16x32_bf16 v[180:183], v[84:87], a[84:87], v[180:183]
    buffer_load_dwordx4 v5, s[8:11], s30 offen offset:1024 lds
    v_rcp_f32 v34, v34
    v_rcp_f32 v35, v35
    v_mfma_f32_16x16x32_bf16 v[184:187], v[84:87], a[88:91], v[184:187]
    v_rcp_f32 v36, v36
    v_rcp_f32 v37, v37
    v_mul_f32 v108, v108, v34
    v_mfma_f32_16x16x32_bf16 v[188:191], v[84:87], a[92:95], v[188:191]
    v_mul_f32 v109, v109, v35
    v_mul_f32 v110, v110, v36
    v_mul_f32 v111, v111, v37
    s_waitcnt vmcnt(8) lgkmcnt(0)
    v_mfma_f32_16x16x32_bf16 v[160:163], v[64:67], a[96:99], v[160:163]
    ds_read_b64_tr_b16 v[80:81], v14 offset:6144
    v_exp_f32 v38, v124
    v_exp_f32 v39, v125
    v_mfma_f32_16x16x32_bf16 v[164:167], v[64:67], a[100:103], v[164:167]
    ds_read_b64_tr_b16 v[82:83], v14 offset:6400
    v_exp_f32 v40, v126
    v_exp_f32 v41, v127
    v_add_f32 v38, 1.0, v38
    v_mfma_f32_16x16x32_bf16 v[168:171], v[64:67], a[104:107], v[168:171]
    ds_read_b64_tr_b16 v[84:85], v15 offset:6144
    v_add_f32 v39, 1.0, v39
    v_add_f32 v40, 1.0, v40
    v_mfma_f32_16x16x32_bf16 v[172:175], v[64:67], a[108:111], v[172:175]
    ds_read_b64_tr_b16 v[86:87], v15 offset:6400
    buffer_load_dwordx4 v6, s[8:11], s30 offen offset:2048 lds
    v_add_f32 v41, 1.0, v41
    v_rcp_f32 v38, v38
    v_rcp_f32 v39, v39
    v_mfma_f32_16x16x32_bf16 v[176:179], v[68:71], a[96:99], v[176:179]
    v_rcp_f32 v40, v40
    v_rcp_f32 v41, v41
    v_mul_f32 v124, v124, v38
    v_mfma_f32_16x16x32_bf16 v[180:183], v[68:71], a[100:103], v[180:183]
    buffer_load_dwordx4 v7, s[8:11], s30 offen offset:3072 lds
    v_mul_f32 v125, v125, v39
    v_mul_f32 v126, v126, v40
    v_mfma_f32_16x16x32_bf16 v[184:187], v[68:71], a[104:107], v[184:187]
    v_mul_f32 v127, v127, v41
    v_cvt_pk_bf16_f32 v46, v108, v109
    v_cvt_pk_bf16_f32 v47, v110, v111
    v_mfma_f32_16x16x32_bf16 v[188:191], v[68:71], a[108:111], v[188:191]
    v_cvt_pk_bf16_f32 v48, v124, v125
    v_cvt_pk_bf16_f32 v49, v126, v127
    ds_write_b128 v30, v[46:49] offset:3072
    s_waitcnt vmcnt(8) lgkmcnt(1)
    v_mfma_f32_16x16x32_bf16 v[160:163], v[80:83], a[112:115], v[160:163]
    ds_read_b64_tr_b16 v[64:65], v14 offset:8192
    v_mfma_f32_16x16x32_bf16 v[164:167], v[80:83], a[116:119], v[164:167]
    ds_read_b64_tr_b16 v[66:67], v14 offset:8448
    v_mfma_f32_16x16x32_bf16 v[168:171], v[80:83], a[120:123], v[168:171]
    ds_read_b64_tr_b16 v[68:69], v15 offset:8192
    v_mfma_f32_16x16x32_bf16 v[172:175], v[80:83], a[124:127], v[172:175]
    ds_read_b64_tr_b16 v[70:71], v15 offset:8448
    s_add_u32 m0, s25, 4096
    s_add_u32 s30, s28, s62
    v_mfma_f32_16x16x32_bf16 v[176:179], v[84:87], a[112:115], v[176:179]
    buffer_load_dwordx4 v4, s[8:11], s30 offen lds
    v_mfma_f32_16x16x32_bf16 v[180:183], v[84:87], a[116:119], v[180:183]
    buffer_load_dwordx4 v5, s[8:11], s30 offen offset:1024 lds
    v_mfma_f32_16x16x32_bf16 v[184:187], v[84:87], a[120:123], v[184:187]
    v_mfma_f32_16x16x32_bf16 v[188:191], v[84:87], a[124:127], v[188:191]
    s_waitcnt vmcnt(6) lgkmcnt(0)
    v_mfma_f32_16x16x32_bf16 v[160:163], v[64:67], a[128:131], v[160:163]
    ds_read_b64_tr_b16 v[80:81], v10 offset:12288
    v_mfma_f32_16x16x32_bf16 v[164:167], v[64:67], a[132:135], v[164:167]
    ds_read_b64_tr_b16 v[82:83], v10 offset:12800
    v_mfma_f32_16x16x32_bf16 v[168:171], v[64:67], a[136:139], v[168:171]
    ds_read_b64_tr_b16 v[84:85], v11 offset:12288
    v_mfma_f32_16x16x32_bf16 v[172:175], v[64:67], a[140:143], v[172:175]
    ds_read_b64_tr_b16 v[86:87], v11 offset:12800
    buffer_load_dwordx4 v6, s[8:11], s30 offen offset:2048 lds
    v_mfma_f32_16x16x32_bf16 v[176:179], v[68:71], a[128:131], v[176:179]
    ds_read_b64_tr_b16 v[88:89], v12 offset:12288
    v_mfma_f32_16x16x32_bf16 v[180:183], v[68:71], a[132:135], v[180:183]
    ds_read_b64_tr_b16 v[90:91], v12 offset:12800
    buffer_load_dwordx4 v7, s[8:11], s30 offen offset:3072 lds
    v_mfma_f32_16x16x32_bf16 v[184:187], v[68:71], a[136:139], v[184:187]
    ds_read_b64_tr_b16 v[92:93], v13 offset:12288
    v_mfma_f32_16x16x32_bf16 v[188:191], v[68:71], a[140:143], v[188:191]
    ds_read_b64_tr_b16 v[94:95], v13 offset:12800
    s_branch M_G1S_JOIN
M_G1S_WK1:
    s_waitcnt vmcnt(12) lgkmcnt(0)
    v_mfma_f32_16x16x32_bf16 v[168:171], v[64:67], a[144:147], 0
    ds_read_b64_tr_b16 v[80:81], v14 offset:10240
    v_exp_f32 v34, v96
    v_exp_f32 v35, v97
    v_mfma_f32_16x16x32_bf16 v[172:175], v[64:67], a[148:151], 0
    ds_read_b64_tr_b16 v[82:83], v14 offset:10496
    v_exp_f32 v36, v98
    v_exp_f32 v37, v99
    v_add_f32 v34, 1.0, v34
    v_mfma_f32_16x16x32_bf16 v[160:163], v[64:67], a[152:155], 0
    ds_read_b64_tr_b16 v[84:85], v15 offset:10240
    v_add_f32 v35, 1.0, v35
    v_add_f32 v36, 1.0, v36
    v_add_f32 v37, 1.0, v37
    v_mfma_f32_16x16x32_bf16 v[164:167], v[64:67], a[156:159], 0
    ds_read_b64_tr_b16 v[86:87], v15 offset:10496
    s_add_u32 m0, s25, 8192
    s_add_u32 s30, s26, s77
    v_rcp_f32 v34, v34
    v_rcp_f32 v35, v35
    v_rcp_f32 v36, v36
    v_mfma_f32_16x16x32_bf16 v[184:187], v[68:71], a[144:147], 0
    buffer_load_dwordx4 v8, s[8:11], s30 offen lds
    v_rcp_f32 v37, v37
    v_mul_f32 v96, v96, v34
    v_mfma_f32_16x16x32_bf16 v[188:191], v[68:71], a[148:151], 0
    buffer_load_dwordx4 v9, s[8:11], s30 offen offset:1024 lds
    v_mul_f32 v97, v97, v35
    v_mul_f32 v98, v98, v36
    v_mul_f32 v99, v99, v37
    v_mfma_f32_16x16x32_bf16 v[176:179], v[68:71], a[152:155], 0
    v_exp_f32 v38, v112
    v_exp_f32 v39, v113
    v_exp_f32 v40, v114
    v_mfma_f32_16x16x32_bf16 v[180:183], v[68:71], a[156:159], 0
    v_exp_f32 v41, v115
    v_add_f32 v38, 1.0, v38
    v_add_f32 v39, 1.0, v39
    s_waitcnt vmcnt(12) lgkmcnt(0)
    v_mfma_f32_16x16x32_bf16 v[168:171], v[80:83], a[160:163], v[168:171]
    ds_read_b64_tr_b16 v[64:65], v14 offset:12288
    v_add_f32 v40, 1.0, v40
    v_add_f32 v41, 1.0, v41
    v_mfma_f32_16x16x32_bf16 v[172:175], v[80:83], a[164:167], v[172:175]
    ds_read_b64_tr_b16 v[66:67], v14 offset:12544
    v_rcp_f32 v38, v38
    v_rcp_f32 v39, v39
    v_rcp_f32 v40, v40
    v_mfma_f32_16x16x32_bf16 v[160:163], v[80:83], a[168:171], v[160:163]
    ds_read_b64_tr_b16 v[68:69], v15 offset:12288
    v_rcp_f32 v41, v41
    v_mul_f32 v112, v112, v38
    v_mfma_f32_16x16x32_bf16 v[164:167], v[80:83], a[172:175], v[164:167]
    ds_read_b64_tr_b16 v[70:71], v15 offset:12544
    v_mul_f32 v113, v113, v39
    v_mul_f32 v114, v114, v40
    v_mul_f32 v115, v115, v41
    v_mfma_f32_16x16x32_bf16 v[184:187], v[84:87], a[160:163], v[184:187]
    v_cvt_pk_bf16_f32 v42, v96, v97
    v_cvt_pk_bf16_f32 v43, v98, v99
    v_cvt_pk_bf16_f32 v44, v112, v113
    v_mfma_f32_16x16x32_bf16 v[188:191], v[84:87], a[164:167], v[188:191]
    v_cvt_pk_bf16_f32 v45, v114, v115
    ds_write_b128 v30, v[42:45] offset:0
    v_mfma_f32_16x16x32_bf16 v[176:179], v[84:87], a[168:171], v[176:179]
    v_exp_f32 v34, v100
    v_exp_f32 v35, v101
    v_exp_f32 v36, v102
    v_mfma_f32_16x16x32_bf16 v[180:183], v[84:87], a[172:175], v[180:183]
    v_exp_f32 v37, v103
    v_add_f32 v34, 1.0, v34
    v_add_f32 v35, 1.0, v35
    s_waitcnt vmcnt(10) lgkmcnt(1)
    v_mfma_f32_16x16x32_bf16 v[168:171], v[64:67], a[176:179], v[168:171]
    ds_read_b64_tr_b16 v[80:81], v14 offset:14336
    v_add_f32 v36, 1.0, v36
    v_add_f32 v37, 1.0, v37
    v_mfma_f32_16x16x32_bf16 v[172:175], v[64:67], a[180:183], v[172:175]
    ds_read_b64_tr_b16 v[82:83], v14 offset:14592
    v_rcp_f32 v34, v34
    v_rcp_f32 v35, v35
    v_rcp_f32 v36, v36
    v_mfma_f32_16x16x32_bf16 v[160:163], v[64:67], a[184:187], v[160:163]
    ds_read_b64_tr_b16 v[84:85], v15 offset:14336
    v_rcp_f32 v37, v37
    v_mul_f32 v100, v100, v34
    v_mfma_f32_16x16x32_bf16 v[164:167], v[64:67], a[188:191], v[164:167]
    ds_read_b64_tr_b16 v[86:87], v15 offset:14592
    v_mul_f32 v101, v101, v35
    v_mul_f32 v102, v102, v36
    v_mul_f32 v103, v103, v37
    v_mfma_f32_16x16x32_bf16 v[184:187], v[68:71], a[176:179], v[184:187]
    v_exp_f32 v38, v116
    v_exp_f32 v39, v117
    v_exp_f32 v40, v118
    v_mfma_f32_16x16x32_bf16 v[188:191], v[68:71], a[180:183], v[188:191]
    v_exp_f32 v41, v119
    v_add_f32 v38, 1.0, v38
    v_mfma_f32_16x16x32_bf16 v[176:179], v[68:71], a[184:187], v[176:179]
    v_add_f32 v39, 1.0, v39
    v_add_f32 v40, 1.0, v40
    v_add_f32 v41, 1.0, v41
    v_mfma_f32_16x16x32_bf16 v[180:183], v[68:71], a[188:191], v[180:183]
    v_rcp_f32 v38, v38
    v_rcp_f32 v39, v39
    v_rcp_f32 v40, v40
    s_waitcnt vmcnt(8) lgkmcnt(0)
    v_mfma_f32_16x16x32_bf16 v[168:171], v[80:83], a[192:195], v[168:171]
    ds_read_b64_tr_b16 v[64:65], v14 offset:0
    v_rcp_f32 v41, v41
    v_mul_f32 v116, v116, v38
    v_mfma_f32_16x16x32_bf16 v[172:175], v[80:83], a[196:199], v[172:175]
    ds_read_b64_tr_b16 v[66:67], v14 offset:256
    v_mul_f32 v117, v117, v39
    v_mul_f32 v118, v118, v40
    v_mul_f32 v119, v119, v41
    v_mfma_f32_16x16x32_bf16 v[160:163], v[80:83], a[200:203], v[160:163]
    ds_read_b64_tr_b16 v[68:69], v15 offset:0
    v_cvt_pk_bf16_f32 v46, v100, v101
    v_cvt_pk_bf16_f32 v47, v102, v103
    v_mfma_f32_16x16x32_bf16 v[164:167], v[80:83], a[204:207], v[164:167]
    ds_read_b64_tr_b16 v[70:71], v15 offset:256
    s_add_u32 m0, s25, 12288
    s_add_u32 s30, s28, s60
    v_cvt_pk_bf16_f32 v48, v116, v117
    v_cvt_pk_bf16_f32 v49, v118, v119
    ds_write_b128 v30, v[46:49] offset:1024
    v_mfma_f32_16x16x32_bf16 v[184:187], v[84:87], a[192:195], v[184:187]
    buffer_load_dwordx4 v4, s[8:11], s30 offen lds
    v_exp_f32 v34, v104
    v_exp_f32 v35, v105
    v_exp_f32 v36, v106
    v_mfma_f32_16x16x32_bf16 v[188:191], v[84:87], a[196:199], v[188:191]
    buffer_load_dwordx4 v5, s[8:11], s30 offen offset:1024 lds
    v_exp_f32 v37, v107
    v_add_f32 v34, 1.0, v34
    v_mfma_f32_16x16x32_bf16 v[176:179], v[84:87], a[200:203], v[176:179]
    v_add_f32 v35, 1.0, v35
    v_add_f32 v36, 1.0, v36
    v_add_f32 v37, 1.0, v37
    v_mfma_f32_16x16x32_bf16 v[180:183], v[84:87], a[204:207], v[180:183]
    v_rcp_f32 v34, v34
    v_rcp_f32 v35, v35
    v_rcp_f32 v36, v36
    s_waitcnt vmcnt(8) lgkmcnt(1)
    v_mfma_f32_16x16x32_bf16 v[168:171], v[64:67], a[208:211], v[168:171]
    ds_read_b64_tr_b16 v[80:81], v14 offset:2048
    v_rcp_f32 v37, v37
    v_mul_f32 v104, v104, v34
    v_mfma_f32_16x16x32_bf16 v[172:175], v[64:67], a[212:215], v[172:175]
    ds_read_b64_tr_b16 v[82:83], v14 offset:2304
    v_mul_f32 v105, v105, v35
    v_mul_f32 v106, v106, v36
    v_mul_f32 v107, v107, v37
    v_mfma_f32_16x16x32_bf16 v[160:163], v[64:67], a[216:219], v[160:163]
    ds_read_b64_tr_b16 v[84:85], v15 offset:2048
    v_exp_f32 v38, v120
    v_exp_f32 v39, v121
    v_mfma_f32_16x16x32_bf16 v[164:167], v[64:67], a[220:223], v[164:167]
    ds_read_b64_tr_b16 v[86:87], v15 offset:2304
    buffer_load_dwordx4 v6, s[8:11], s30 offen offset:2048 lds
    v_exp_f32 v40, v122
    v_exp_f32 v41, v123
    v_add_f32 v38, 1.0, v38
    v_mfma_f32_16x16x32_bf16 v[184:187], v[68:71], a[208:211], v[184:187]
    v_add_f32 v39, 1.0, v39
    v_add_f32 v40, 1.0, v40
    v_add_f32 v41, 1.0, v41
    v_mfma_f32_16x16x32_bf16 v[188:191], v[68:71], a[212:215], v[188:191]
    buffer_load_dwordx4 v7, s[8:11], s30 offen offset:3072 lds
    v_rcp_f32 v38, v38
    v_rcp_f32 v39, v39
    v_mfma_f32_16x16x32_bf16 v[176:179], v[68:71], a[216:219], v[176:179]
    v_rcp_f32 v40, v40
    v_rcp_f32 v41, v41
    v_mul_f32 v120, v120, v38
    v_mfma_f32_16x16x32_bf16 v[180:183], v[68:71], a[220:223], v[180:183]
    v_mul_f32 v121, v121, v39
    v_mul_f32 v122, v122, v40
    v_mul_f32 v123, v123, v41
    s_waitcnt vmcnt(8) lgkmcnt(0)
    v_mfma_f32_16x16x32_bf16 v[168:171], v[80:83], a[224:227], v[168:171]
    ds_read_b64_tr_b16 v[64:65], v14 offset:4096
    v_cvt_pk_bf16_f32 v42, v104, v105
    v_cvt_pk_bf16_f32 v43, v106, v107
    v_mfma_f32_16x16x32_bf16 v[172:175], v[80:83], a[228:231], v[172:175]
    ds_read_b64_tr_b16 v[66:67], v14 offset:4352
    v_cvt_pk_bf16_f32 v44, v120, v121
    v_cvt_pk_bf16_f32 v45, v122, v123
    ds_write_b128 v30, v[42:45] offset:2048
    v_mfma_f32_16x16x32_bf16 v[160:163], v[80:83], a[232:235], v[160:163]
    ds_read_b64_tr_b16 v[68:69], v15 offset:4096
    v_exp_f32 v34, v108
    v_exp_f32 v35, v109
    v_mfma_f32_16x16x32_bf16 v[164:167], v[80:83], a[236:239], v[164:167]
    ds_read_b64_tr_b16 v[70:71], v15 offset:4352
    s_add_u32 m0, s25, 0
    s_add_u32 s30, s28, s61
    v_exp_f32 v36, v110
    v_exp_f32 v37, v111
    v_add_f32 v34, 1.0, v34
    v_mfma_f32_16x16x32_bf16 v[184:187], v[84:87], a[224:227], v[184:187]
    buffer_load_dwordx4 v4, s[8:11], s30 offen lds
    v_add_f32 v35, 1.0, v35
    v_add_f32 v36, 1.0, v36
    v_add_f32 v37, 1.0, v37
    v_mfma_f32_16x16x32_bf16 v[188:191], v[84:87], a[228:231], v[188:191]
    buffer_load_dwordx4 v5, s[8:11], s30 offen offset:1024 lds
    v_rcp_f32 v34, v34
    v_rcp_f32 v35, v35
    v_mfma_f32_16x16x32_bf16 v[176:179], v[84:87], a[232:235], v[176:179]
    v_rcp_f32 v36, v36
    v_rcp_f32 v37, v37
    v_mul_f32 v108, v108, v34
    v_mfma_f32_16x16x32_bf16 v[180:183], v[84:87], a[236:239], v[180:183]
    v_mul_f32 v109, v109, v35
    v_mul_f32 v110, v110, v36
    v_mul_f32 v111, v111, v37
    s_waitcnt vmcnt(8) lgkmcnt(0)
    v_mfma_f32_16x16x32_bf16 v[168:171], v[64:67], a[240:243], v[168:171]
    ds_read_b64_tr_b16 v[80:81], v14 offset:6144
    v_exp_f32 v38, v124
    v_exp_f32 v39, v125
    v_mfma_f32_16x16x32_bf16 v[172:175], v[64:67], a[244:247], v[172:175]
    ds_read_b64_tr_b16 v[82:83], v14 offset:6400
    v_exp_f32 v40, v126
    v_exp_f32 v41, v127
    v_add_f32 v38, 1.0, v38
    v_mfma_f32_16x16x32_bf16 v[160:163], v[64:67], a[248:251], v[160:163]
    ds_read_b64_tr_b16 v[84:85], v15 offset:6144
    v_add_f32 v39, 1.0, v39
    v_add_f32 v40, 1.0, v40
    v_mfma_f32_16x16x32_bf16 v[164:167], v[64:67], a[252:255], v[164:167]
    ds_read_b64_tr_b16 v[86:87], v15 offset:6400
    buffer_load_dwordx4 v6, s[8:11], s30 offen offset:2048 lds
    v_add_f32 v41, 1.0, v41
    v_rcp_f32 v38, v38
    v_rcp_f32 v39, v39
    v_mfma_f32_16x16x32_bf16 v[184:187], v[68:71], a[240:243], v[184:187]
    v_rcp_f32 v40, v40
    v_rcp_f32 v41, v41
    v_mul_f32 v124, v124, v38
    v_mfma_f32_16x16x32_bf16 v[188:191], v[68:71], a[244:247], v[188:191]
    buffer_load_dwordx4 v7, s[8:11], s30 offen offset:3072 lds
    v_mul_f32 v125, v125, v39
    v_mul_f32 v126, v126, v40
    v_mfma_f32_16x16x32_bf16 v[176:179], v[68:71], a[248:251], v[176:179]
    v_mul_f32 v127, v127, v41
    v_cvt_pk_bf16_f32 v46, v108, v109
    v_cvt_pk_bf16_f32 v47, v110, v111
    v_mfma_f32_16x16x32_bf16 v[180:183], v[68:71], a[252:255], v[180:183]
    v_cvt_pk_bf16_f32 v48, v124, v125
    v_cvt_pk_bf16_f32 v49, v126, v127
    ds_write_b128 v30, v[46:49] offset:3072
    s_waitcnt vmcnt(8) lgkmcnt(1)
    v_mfma_f32_16x16x32_bf16 v[168:171], v[80:83], v[224:227], v[168:171]
    ds_read_b64_tr_b16 v[64:65], v14 offset:8192
    v_mfma_f32_16x16x32_bf16 v[172:175], v[80:83], v[228:231], v[172:175]
    ds_read_b64_tr_b16 v[66:67], v14 offset:8448
    v_mfma_f32_16x16x32_bf16 v[160:163], v[80:83], v[232:235], v[160:163]
    ds_read_b64_tr_b16 v[68:69], v15 offset:8192
    v_mfma_f32_16x16x32_bf16 v[164:167], v[80:83], v[236:239], v[164:167]
    ds_read_b64_tr_b16 v[70:71], v15 offset:8448
    s_add_u32 m0, s25, 4096
    s_add_u32 s30, s28, s62
    v_mfma_f32_16x16x32_bf16 v[184:187], v[84:87], v[224:227], v[184:187]
    buffer_load_dwordx4 v4, s[8:11], s30 offen lds
    v_mfma_f32_16x16x32_bf16 v[188:191], v[84:87], v[228:231], v[188:191]
    buffer_load_dwordx4 v5, s[8:11], s30 offen offset:1024 lds
    v_mfma_f32_16x16x32_bf16 v[176:179], v[84:87], v[232:235], v[176:179]
    v_mfma_f32_16x16x32_bf16 v[180:183], v[84:87], v[236:239], v[180:183]
    s_waitcnt vmcnt(6) lgkmcnt(0)
    v_mfma_f32_16x16x32_bf16 v[168:171], v[64:67], v[240:243], v[168:171]
    ds_read_b64_tr_b16 v[80:81], v10 offset:12288
    v_mfma_f32_16x16x32_bf16 v[172:175], v[64:67], v[244:247], v[172:175]
    ds_read_b64_tr_b16 v[82:83], v10 offset:12800
    v_mfma_f32_16x16x32_bf16 v[160:163], v[64:67], v[248:251], v[160:163]
    ds_read_b64_tr_b16 v[84:85], v11 offset:12288
    v_mfma_f32_16x16x32_bf16 v[164:167], v[64:67], v[252:255], v[164:167]
    ds_read_b64_tr_b16 v[86:87], v11 offset:12800
    buffer_load_dwordx4 v6, s[8:11], s30 offen offset:2048 lds
    v_mfma_f32_16x16x32_bf16 v[184:187], v[68:71], v[240:243], v[184:187]
    ds_read_b64_tr_b16 v[88:89], v12 offset:12288
    v_mfma_f32_16x16x32_bf16 v[188:191], v[68:71], v[244:247], v[188:191]
    ds_read_b64_tr_b16 v[90:91], v12 offset:12800
    buffer_load_dwordx4 v7, s[8:11], s30 offen offset:3072 lds
    v_mfma_f32_16x16x32_bf16 v[176:179], v[68:71], v[248:251], v[176:179]
    ds_read_b64_tr_b16 v[92:93], v13 offset:12288
    v_mfma_f32_16x16x32_bf16 v[180:183], v[68:71], v[252:255], v[180:183]
    ds_read_b64_tr_b16 v[94:95], v13 offset:12800
M_G1S_JOIN:
    s_waitcnt vmcnt(4) lgkmcnt(0)
    v_mfma_f32_16x16x32_bf16 v[96:99], v[80:83], a[0:3], 0
    ds_read_b64_tr_b16 v[64:65], v10 offset:0
    v_mfma_f32_16x16x32_bf16 v[100:103], v[80:83], a[4:7], 0
    ds_read_b64_tr_b16 v[66:67], v10 offset:512
    v_mfma_f32_16x16x32_bf16 v[104:107], v[80:83], a[8:11], 0
    ds_read_b64_tr_b16 v[68:69], v11 offset:0
    v_mfma_f32_16x16x32_bf16 v[108:111], v[80:83], a[12:15], 0
    ds_read_b64_tr_b16 v[70:71], v11 offset:512
    v_mfma_f32_16x16x32_bf16 v[112:115], v[84:87], a[0:3], 0
    ds_read_b64_tr_b16 v[72:73], v12 offset:0
    ds_write_b128 v31, v[168:171] offset:0
    v_mfma_f32_16x16x32_bf16 v[116:119], v[84:87], a[4:7], 0
    ds_read_b64_tr_b16 v[74:75], v12 offset:512
    ds_write_b128 v31, v[172:175] offset:1024
    v_mfma_f32_16x16x32_bf16 v[120:123], v[84:87], a[8:11], 0
    ds_read_b64_tr_b16 v[76:77], v13 offset:0
    v_exp_f32 v34, v128
    v_mfma_f32_16x16x32_bf16 v[124:127], v[84:87], a[12:15], 0
    ds_read_b64_tr_b16 v[78:79], v13 offset:512
    s_add_u32 m0, s25, 8192
    s_add_u32 s30, s28, s63
    buffer_load_dwordx4 v4, s[8:11], s30 offen lds
    v_exp_f32 v35, v129
    v_mfma_f32_16x16x32_bf16 v[192:195], v[88:91], a[0:3], 0
    buffer_load_dwordx4 v5, s[8:11], s30 offen offset:1024 lds
    v_exp_f32 v36, v130
    v_mfma_f32_16x16x32_bf16 v[196:199], v[88:91], a[4:7], 0
    buffer_load_dwordx4 v6, s[8:11], s30 offen offset:2048 lds
    v_exp_f32 v37, v131
    v_mfma_f32_16x16x32_bf16 v[200:203], v[88:91], a[8:11], 0
    buffer_load_dwordx4 v7, s[8:11], s30 offen offset:3072 lds
    v_add_f32 v34, 1.0, v34
    v_mfma_f32_16x16x32_bf16 v[204:207], v[88:91], a[12:15], 0
    s_add_u32 m0, s25, 12288
    s_add_u32 s30, s28, s64
    buffer_load_dwordx4 v4, s[8:11], s30 offen lds
    v_add_f32 v35, 1.0, v35
    v_mfma_f32_16x16x32_bf16 v[208:211], v[92:95], a[0:3], 0
    buffer_load_dwordx4 v5, s[8:11], s30 offen offset:1024 lds
    v_add_f32 v36, 1.0, v36
    v_mfma_f32_16x16x32_bf16 v[212:215], v[92:95], a[4:7], 0
    buffer_load_dwordx4 v6, s[8:11], s30 offen offset:2048 lds
    v_add_f32 v37, 1.0, v37
    v_mfma_f32_16x16x32_bf16 v[216:219], v[92:95], a[8:11], 0
    buffer_load_dwordx4 v7, s[8:11], s30 offen offset:3072 lds
    v_rcp_f32 v34, v34
    v_mfma_f32_16x16x32_bf16 v[220:223], v[92:95], a[12:15], 0
    v_rcp_f32 v35, v35
    s_waitcnt vmcnt(8) lgkmcnt(0)
    v_mfma_f32_16x16x32_bf16 v[96:99], v[64:67], a[16:19], v[96:99]
    ds_read_b64_tr_b16 v[80:81], v10 offset:4096
    v_rcp_f32 v36, v36
    v_mfma_f32_16x16x32_bf16 v[100:103], v[64:67], a[20:23], v[100:103]
    ds_read_b64_tr_b16 v[82:83], v10 offset:4608
    v_rcp_f32 v37, v37
    v_mfma_f32_16x16x32_bf16 v[104:107], v[64:67], a[24:27], v[104:107]
    ds_read_b64_tr_b16 v[84:85], v11 offset:4096
    v_mul_f32 v128, v128, v34
    v_mfma_f32_16x16x32_bf16 v[108:111], v[64:67], a[28:31], v[108:111]
    ds_read_b64_tr_b16 v[86:87], v11 offset:4608
    v_mul_f32 v129, v129, v35
    v_mfma_f32_16x16x32_bf16 v[112:115], v[68:71], a[16:19], v[112:115]
    ds_read_b64_tr_b16 v[88:89], v12 offset:4096
    v_mul_f32 v130, v130, v36
    v_mfma_f32_16x16x32_bf16 v[116:119], v[68:71], a[20:23], v[116:119]
    ds_read_b64_tr_b16 v[90:91], v12 offset:4608
    v_mul_f32 v131, v131, v37
    v_mfma_f32_16x16x32_bf16 v[120:123], v[68:71], a[24:27], v[120:123]
    ds_read_b64_tr_b16 v[92:93], v13 offset:4096
    v_exp_f32 v38, v144
    v_mfma_f32_16x16x32_bf16 v[124:127], v[68:71], a[28:31], v[124:127]
    ds_read_b64_tr_b16 v[94:95], v13 offset:4608
    s_add_u32 m0, s25, 0
    s_add_u32 s30, s28, s65
    v_exp_f32 v39, v145
    v_mfma_f32_16x16x32_bf16 v[192:195], v[72:75], a[16:19], v[192:195]
    buffer_load_dwordx4 v4, s[8:11], s30 offen lds
    v_mfma_f32_16x16x32_bf16 v[196:199], v[72:75], a[20:23], v[196:199]
    v_mfma_f32_16x16x32_bf16 v[200:203], v[72:75], a[24:27], v[200:203]
    buffer_load_dwordx4 v5, s[8:11], s30 offen offset:1024 lds
    v_mfma_f32_16x16x32_bf16 v[204:207], v[72:75], a[28:31], v[204:207]
    buffer_load_dwordx4 v6, s[8:11], s30 offen offset:2048 lds
    v_mfma_f32_16x16x32_bf16 v[208:211], v[76:79], a[16:19], v[208:211]
    v_mfma_f32_16x16x32_bf16 v[212:215], v[76:79], a[20:23], v[212:215]
    buffer_load_dwordx4 v7, s[8:11], s30 offen offset:3072 lds
    v_mfma_f32_16x16x32_bf16 v[216:219], v[76:79], a[24:27], v[216:219]
    v_mfma_f32_16x16x32_bf16 v[220:223], v[76:79], a[28:31], v[220:223]
    s_waitcnt vmcnt(8) lgkmcnt(0)
    v_mfma_f32_16x16x32_bf16 v[96:99], v[80:83], a[32:35], v[96:99]
    ds_read_b64_tr_b16 v[64:65], v10 offset:8192
    v_mfma_f32_16x16x32_bf16 v[100:103], v[80:83], a[36:39], v[100:103]
    ds_read_b64_tr_b16 v[66:67], v10 offset:8704
    v_mfma_f32_16x16x32_bf16 v[104:107], v[80:83], a[40:43], v[104:107]
    ds_read_b64_tr_b16 v[68:69], v11 offset:8192
    v_mfma_f32_16x16x32_bf16 v[108:111], v[80:83], a[44:47], v[108:111]
    ds_read_b64_tr_b16 v[70:71], v11 offset:8704
    v_mfma_f32_16x16x32_bf16 v[112:115], v[84:87], a[32:35], v[112:115]
    ds_read_b64_tr_b16 v[72:73], v12 offset:8192
    ds_write_b128 v31, v[184:187] offset:2048
    v_mfma_f32_16x16x32_bf16 v[116:119], v[84:87], a[36:39], v[116:119]
    ds_read_b64_tr_b16 v[74:75], v12 offset:8704
    ds_write_b128 v31, v[188:191] offset:3072
    v_mfma_f32_16x16x32_bf16 v[120:123], v[84:87], a[40:43], v[120:123]
    ds_read_b64_tr_b16 v[76:77], v13 offset:8192
    v_exp_f32 v40, v146
    v_mfma_f32_16x16x32_bf16 v[124:127], v[84:87], a[44:47], v[124:127]
    ds_read_b64_tr_b16 v[78:79], v13 offset:8704
    s_add_u32 m0, s25, 4096
    s_add_u32 s30, s28, s66
    v_exp_f32 v41, v147
    v_mfma_f32_16x16x32_bf16 v[192:195], v[88:91], a[32:35], v[192:195]
    buffer_load_dwordx4 v4, s[8:11], s30 offen lds
    v_add_f32 v38, 1.0, v38
    v_mfma_f32_16x16x32_bf16 v[196:199], v[88:91], a[36:39], v[196:199]
    v_add_f32 v39, 1.0, v39
    v_mfma_f32_16x16x32_bf16 v[200:203], v[88:91], a[40:43], v[200:203]
    buffer_load_dwordx4 v5, s[8:11], s30 offen offset:1024 lds
    v_add_f32 v40, 1.0, v40
    v_mfma_f32_16x16x32_bf16 v[204:207], v[88:91], a[44:47], v[204:207]
    buffer_load_dwordx4 v6, s[8:11], s30 offen offset:2048 lds
    v_add_f32 v41, 1.0, v41
    v_mfma_f32_16x16x32_bf16 v[208:211], v[92:95], a[32:35], v[208:211]
    v_rcp_f32 v38, v38
    v_mfma_f32_16x16x32_bf16 v[212:215], v[92:95], a[36:39], v[212:215]
    buffer_load_dwordx4 v7, s[8:11], s30 offen offset:3072 lds
    v_rcp_f32 v39, v39
    v_mfma_f32_16x16x32_bf16 v[216:219], v[92:95], a[40:43], v[216:219]
    v_rcp_f32 v40, v40
    v_mfma_f32_16x16x32_bf16 v[220:223], v[92:95], a[44:47], v[220:223]
    v_rcp_f32 v41, v41
    s_waitcnt vmcnt(8) lgkmcnt(0)
    v_mfma_f32_16x16x32_bf16 v[96:99], v[64:67], a[48:51], v[96:99]
    ds_read_b64_tr_b16 v[80:81], v10 offset:12288
    v_mul_f32 v144, v144, v38
    v_mfma_f32_16x16x32_bf16 v[100:103], v[64:67], a[52:55], v[100:103]
    ds_read_b64_tr_b16 v[82:83], v10 offset:12800
    v_mul_f32 v145, v145, v39
    v_mfma_f32_16x16x32_bf16 v[104:107], v[64:67], a[56:59], v[104:107]
    ds_read_b64_tr_b16 v[84:85], v11 offset:12288
    v_mul_f32 v146, v146, v40
    v_mfma_f32_16x16x32_bf16 v[108:111], v[64:67], a[60:63], v[108:111]
    ds_read_b64_tr_b16 v[86:87], v11 offset:12800
    v_mul_f32 v147, v147, v41
    v_mfma_f32_16x16x32_bf16 v[112:115], v[68:71], a[48:51], v[112:115]
    ds_read_b64_tr_b16 v[88:89], v12 offset:12288
    v_cvt_pk_bf16_f32 v42, v128, v129
    v_mfma_f32_16x16x32_bf16 v[116:119], v[68:71], a[52:55], v[116:119]
    ds_read_b64_tr_b16 v[90:91], v12 offset:12800
    v_cvt_pk_bf16_f32 v43, v130, v131
    v_mfma_f32_16x16x32_bf16 v[120:123], v[68:71], a[56:59], v[120:123]
    ds_read_b64_tr_b16 v[92:93], v13 offset:12288
    v_cvt_pk_bf16_f32 v44, v144, v145
    v_mfma_f32_16x16x32_bf16 v[124:127], v[68:71], a[60:63], v[124:127]
    ds_read_b64_tr_b16 v[94:95], v13 offset:12800
    s_add_u32 m0, s25, 8192
    s_add_u32 s30, s28, s67
    v_cvt_pk_bf16_f32 v45, v146, v147
    v_mfma_f32_16x16x32_bf16 v[192:195], v[72:75], a[48:51], v[192:195]
    buffer_load_dwordx4 v4, s[8:11], s30 offen lds
    ds_write_b128 v3, v[42:45] offset:0
    v_mfma_f32_16x16x32_bf16 v[196:199], v[72:75], a[52:55], v[196:199]
    v_mfma_f32_16x16x32_bf16 v[200:203], v[72:75], a[56:59], v[200:203]
    buffer_load_dwordx4 v5, s[8:11], s30 offen offset:1024 lds
    v_mfma_f32_16x16x32_bf16 v[204:207], v[72:75], a[60:63], v[204:207]
    buffer_load_dwordx4 v6, s[8:11], s30 offen offset:2048 lds
    v_mfma_f32_16x16x32_bf16 v[208:211], v[76:79], a[48:51], v[208:211]
    v_mfma_f32_16x16x32_bf16 v[212:215], v[76:79], a[52:55], v[212:215]
    buffer_load_dwordx4 v7, s[8:11], s30 offen offset:3072 lds
    v_mfma_f32_16x16x32_bf16 v[216:219], v[76:79], a[56:59], v[216:219]
    v_mfma_f32_16x16x32_bf16 v[220:223], v[76:79], a[60:63], v[220:223]
    s_waitcnt vmcnt(8) lgkmcnt(0)
    s_barrier
    v_mfma_f32_16x16x32_bf16 v[96:99], v[80:83], a[64:67], v[96:99]
    ds_read_b64_tr_b16 v[64:65], v10 offset:0
    v_exp_f32 v34, v132
    v_mfma_f32_16x16x32_bf16 v[100:103], v[80:83], a[68:71], v[100:103]
    ds_read_b64_tr_b16 v[66:67], v10 offset:512
    v_exp_f32 v35, v133
    v_mfma_f32_16x16x32_bf16 v[104:107], v[80:83], a[72:75], v[104:107]
    ds_read_b64_tr_b16 v[68:69], v11 offset:0
    v_exp_f32 v36, v134
    v_mfma_f32_16x16x32_bf16 v[108:111], v[80:83], a[76:79], v[108:111]
    ds_read_b64_tr_b16 v[70:71], v11 offset:512
    v_exp_f32 v37, v135
    v_mfma_f32_16x16x32_bf16 v[112:115], v[84:87], a[64:67], v[112:115]
    ds_read_b64_tr_b16 v[72:73], v12 offset:0
    v_add_f32 v34, 1.0, v34
    v_mfma_f32_16x16x32_bf16 v[116:119], v[84:87], a[68:71], v[116:119]
    ds_read_b64_tr_b16 v[74:75], v12 offset:512
    v_add_f32 v35, 1.0, v35
    v_mfma_f32_16x16x32_bf16 v[120:123], v[84:87], a[72:75], v[120:123]
    ds_read_b64_tr_b16 v[76:77], v13 offset:0
    v_add_f32 v36, 1.0, v36
    v_mfma_f32_16x16x32_bf16 v[124:127], v[84:87], a[76:79], v[124:127]
    ds_read_b64_tr_b16 v[78:79], v13 offset:512
    s_add_u32 m0, s25, 12288
    s_add_u32 s30, s28, s68
    v_add_f32 v37, 1.0, v37
    v_mfma_f32_16x16x32_bf16 v[192:195], v[88:91], a[64:67], v[192:195]
    buffer_load_dwordx4 v4, s[8:11], s30 offen lds
    v_rcp_f32 v34, v34
    v_mfma_f32_16x16x32_bf16 v[196:199], v[88:91], a[68:71], v[196:199]
    v_rcp_f32 v35, v35
    v_mfma_f32_16x16x32_bf16 v[200:203], v[88:91], a[72:75], v[200:203]
    buffer_load_dwordx4 v5, s[8:11], s30 offen offset:1024 lds
    v_rcp_f32 v36, v36
    v_mfma_f32_16x16x32_bf16 v[204:207], v[88:91], a[76:79], v[204:207]
    buffer_load_dwordx4 v6, s[8:11], s30 offen offset:2048 lds
    v_rcp_f32 v37, v37
    v_mfma_f32_16x16x32_bf16 v[208:211], v[92:95], a[64:67], v[208:211]
    v_mul_f32 v132, v132, v34
    v_mfma_f32_16x16x32_bf16 v[212:215], v[92:95], a[68:71], v[212:215]
    buffer_load_dwordx4 v7, s[8:11], s30 offen offset:3072 lds
    v_mul_f32 v133, v133, v35
    v_mfma_f32_16x16x32_bf16 v[216:219], v[92:95], a[72:75], v[216:219]
    v_mul_f32 v134, v134, v36
    v_mfma_f32_16x16x32_bf16 v[220:223], v[92:95], a[76:79], v[220:223]
    v_mul_f32 v135, v135, v37
    s_waitcnt vmcnt(8) lgkmcnt(0)
    v_mfma_f32_16x16x32_bf16 v[96:99], v[64:67], a[80:83], v[96:99]
    ds_read_b64_tr_b16 v[80:81], v10 offset:4096
    v_exp_f32 v38, v148
    v_mfma_f32_16x16x32_bf16 v[100:103], v[64:67], a[84:87], v[100:103]
    ds_read_b64_tr_b16 v[82:83], v10 offset:4608
    v_exp_f32 v39, v149
    v_mfma_f32_16x16x32_bf16 v[104:107], v[64:67], a[88:91], v[104:107]
    ds_read_b64_tr_b16 v[84:85], v11 offset:4096
    v_exp_f32 v40, v150
    v_mfma_f32_16x16x32_bf16 v[108:111], v[64:67], a[92:95], v[108:111]
    ds_read_b64_tr_b16 v[86:87], v11 offset:4608
    v_exp_f32 v41, v151
    v_mfma_f32_16x16x32_bf16 v[112:115], v[68:71], a[80:83], v[112:115]
    ds_read_b64_tr_b16 v[88:89], v12 offset:4096
    v_add_f32 v38, 1.0, v38
    v_mfma_f32_16x16x32_bf16 v[116:119], v[68:71], a[84:87], v[116:119]
    ds_read_b64_tr_b16 v[90:91], v12 offset:4608
    v_add_f32 v39, 1.0, v39
    v_mfma_f32_16x16x32_bf16 v[120:123], v[68:71], a[88:91], v[120:123]
    ds_read_b64_tr_b16 v[92:93], v13 offset:4096
    v_add_f32 v40, 1.0, v40
    v_mfma_f32_16x16x32_bf16 v[124:127], v[68:71], a[92:95], v[124:127]
    ds_read_b64_tr_b16 v[94:95], v13 offset:4608
    s_add_u32 m0, s25, 0
    s_add_u32 s30, s28, s69
    v_add_f32 v41, 1.0, v41
    v_mfma_f32_16x16x32_bf16 v[192:195], v[72:75], a[80:83], v[192:195]
    buffer_load_dwordx4 v4, s[8:11], s30 offen lds
    v_rcp_f32 v38, v38
    v_mfma_f32_16x16x32_bf16 v[196:199], v[72:75], a[84:87], v[196:199]
    v_rcp_f32 v39, v39
    v_mfma_f32_16x16x32_bf16 v[200:203], v[72:75], a[88:91], v[200:203]
    buffer_load_dwordx4 v5, s[8:11], s30 offen offset:1024 lds
    v_rcp_f32 v40, v40
    v_mfma_f32_16x16x32_bf16 v[204:207], v[72:75], a[92:95], v[204:207]
    buffer_load_dwordx4 v6, s[8:11], s30 offen offset:2048 lds
    v_rcp_f32 v41, v41
    v_mfma_f32_16x16x32_bf16 v[208:211], v[76:79], a[80:83], v[208:211]
    v_mul_f32 v148, v148, v38
    v_mfma_f32_16x16x32_bf16 v[212:215], v[76:79], a[84:87], v[212:215]
    buffer_load_dwordx4 v7, s[8:11], s30 offen offset:3072 lds
    v_mul_f32 v149, v149, v39
    v_mfma_f32_16x16x32_bf16 v[216:219], v[76:79], a[88:91], v[216:219]
    v_mul_f32 v150, v150, v40
    v_mfma_f32_16x16x32_bf16 v[220:223], v[76:79], a[92:95], v[220:223]
    v_mul_f32 v151, v151, v41
    s_waitcnt vmcnt(8) lgkmcnt(0)
    v_mfma_f32_16x16x32_bf16 v[96:99], v[80:83], a[96:99], v[96:99]
    ds_read_b64_tr_b16 v[64:65], v10 offset:8192
    v_cvt_pk_bf16_f32 v46, v132, v133
    v_mfma_f32_16x16x32_bf16 v[100:103], v[80:83], a[100:103], v[100:103]
    ds_read_b64_tr_b16 v[66:67], v10 offset:8704
    v_cvt_pk_bf16_f32 v47, v134, v135
    v_mfma_f32_16x16x32_bf16 v[104:107], v[80:83], a[104:107], v[104:107]
    ds_read_b64_tr_b16 v[68:69], v11 offset:8192
    v_cvt_pk_bf16_f32 v48, v148, v149
    v_mfma_f32_16x16x32_bf16 v[108:111], v[80:83], a[108:111], v[108:111]
    ds_read_b64_tr_b16 v[70:71], v11 offset:8704
    v_cvt_pk_bf16_f32 v49, v150, v151
    v_mfma_f32_16x16x32_bf16 v[112:115], v[84:87], a[96:99], v[112:115]
    ds_read_b64_tr_b16 v[72:73], v12 offset:8192
    ds_write_b128 v3, v[46:49] offset:1024
    v_mfma_f32_16x16x32_bf16 v[116:119], v[84:87], a[100:103], v[116:119]
    ds_read_b64_tr_b16 v[74:75], v12 offset:8704
    ds_read_b128 v[50:53], v32 offset:0
    v_mfma_f32_16x16x32_bf16 v[120:123], v[84:87], a[104:107], v[120:123]
    ds_read_b64_tr_b16 v[76:77], v13 offset:8192
    ds_read_b128 v[54:57], v32 offset:1024
    v_mfma_f32_16x16x32_bf16 v[124:127], v[84:87], a[108:111], v[124:127]
    ds_read_b64_tr_b16 v[78:79], v13 offset:8704
    s_add_u32 m0, s25, 4096
    s_add_u32 s30, s28, s70
    v_exp_f32 v34, v136
    v_mfma_f32_16x16x32_bf16 v[192:195], v[88:91], a[96:99], v[192:195]
    buffer_load_dwordx4 v4, s[8:11], s30 offen lds
    v_exp_f32 v35, v137
    v_mfma_f32_16x16x32_bf16 v[196:199], v[88:91], a[100:103], v[196:199]
    v_exp_f32 v36, v138
    v_mfma_f32_16x16x32_bf16 v[200:203], v[88:91], a[104:107], v[200:203]
    buffer_load_dwordx4 v5, s[8:11], s30 offen offset:1024 lds
    v_exp_f32 v37, v139
    v_mfma_f32_16x16x32_bf16 v[204:207], v[88:91], a[108:111], v[204:207]
    buffer_load_dwordx4 v6, s[8:11], s30 offen offset:2048 lds
    v_add_f32 v34, 1.0, v34
    v_mfma_f32_16x16x32_bf16 v[208:211], v[92:95], a[96:99], v[208:211]
    v_add_f32 v35, 1.0, v35
    v_mfma_f32_16x16x32_bf16 v[212:215], v[92:95], a[100:103], v[212:215]
    buffer_load_dwordx4 v7, s[8:11], s30 offen offset:3072 lds
    v_add_f32 v36, 1.0, v36
    v_mfma_f32_16x16x32_bf16 v[216:219], v[92:95], a[104:107], v[216:219]
    v_add_f32 v37, 1.0, v37
    v_mfma_f32_16x16x32_bf16 v[220:223], v[92:95], a[108:111], v[220:223]
    s_waitcnt vmcnt(8) lgkmcnt(0)
    v_mfma_f32_16x16x32_bf16 v[96:99], v[64:67], a[112:115], v[96:99]
    ds_read_b64_tr_b16 v[80:81], v10 offset:12288
    v_add_f32 v160, v160, v50
    v_mfma_f32_16x16x32_bf16 v[100:103], v[64:67], a[116:119], v[100:103]
    ds_read_b64_tr_b16 v[82:83], v10 offset:12800
    v_add_f32 v161, v161, v51
    v_mfma_f32_16x16x32_bf16 v[104:107], v[64:67], a[120:123], v[104:107]
    ds_read_b64_tr_b16 v[84:85], v11 offset:12288
    v_add_f32 v162, v162, v52
    v_mfma_f32_16x16x32_bf16 v[108:111], v[64:67], a[124:127], v[108:111]
    ds_read_b64_tr_b16 v[86:87], v11 offset:12800
    v_add_f32 v163, v163, v53
    v_mfma_f32_16x16x32_bf16 v[112:115], v[68:71], a[112:115], v[112:115]
    ds_read_b64_tr_b16 v[88:89], v12 offset:12288
    v_add_f32 v164, v164, v54
    v_mfma_f32_16x16x32_bf16 v[116:119], v[68:71], a[116:119], v[116:119]
    ds_read_b64_tr_b16 v[90:91], v12 offset:12800
    v_add_f32 v165, v165, v55
    v_mfma_f32_16x16x32_bf16 v[120:123], v[68:71], a[120:123], v[120:123]
    ds_read_b64_tr_b16 v[92:93], v13 offset:12288
    v_add_f32 v166, v166, v56
    v_mfma_f32_16x16x32_bf16 v[124:127], v[68:71], a[124:127], v[124:127]
    ds_read_b64_tr_b16 v[94:95], v13 offset:12800
    s_add_u32 m0, s25, 8192
    s_add_u32 s30, s28, s71
    v_add_f32 v167, v167, v57
    v_mfma_f32_16x16x32_bf16 v[192:195], v[72:75], a[112:115], v[192:195]
    buffer_load_dwordx4 v4, s[8:11], s30 offen lds
    ds_read_b128 v[50:53], v32 offset:2048
    v_mfma_f32_16x16x32_bf16 v[196:199], v[72:75], a[116:119], v[196:199]
    ds_read_b128 v[54:57], v32 offset:3072
    v_mfma_f32_16x16x32_bf16 v[200:203], v[72:75], a[120:123], v[200:203]
    buffer_load_dwordx4 v5, s[8:11], s30 offen offset:1024 lds
    v_rcp_f32 v34, v34
    v_mfma_f32_16x16x32_bf16 v[204:207], v[72:75], a[124:127], v[204:207]
    buffer_load_dwordx4 v6, s[8:11], s30 offen offset:2048 lds
    v_rcp_f32 v35, v35
    v_mfma_f32_16x16x32_bf16 v[208:211], v[76:79], a[112:115], v[208:211]
    v_rcp_f32 v36, v36
    v_mfma_f32_16x16x32_bf16 v[212:215], v[76:79], a[116:119], v[212:215]
    buffer_load_dwordx4 v7, s[8:11], s30 offen offset:3072 lds
    v_rcp_f32 v37, v37
    v_mfma_f32_16x16x32_bf16 v[216:219], v[76:79], a[120:123], v[216:219]
    v_mul_f32 v136, v136, v34
    v_mfma_f32_16x16x32_bf16 v[220:223], v[76:79], a[124:127], v[220:223]
    v_mul_f32 v137, v137, v35
    s_waitcnt vmcnt(8) lgkmcnt(0)
    v_mfma_f32_16x16x32_bf16 v[96:99], v[80:83], a[128:131], v[96:99]
    ds_read_b64_tr_b16 v[64:65], v10 offset:0
    v_mul_f32 v138, v138, v36
    v_mfma_f32_16x16x32_bf16 v[100:103], v[80:83], a[132:135], v[100:103]
    ds_read_b64_tr_b16 v[66:67], v10 offset:512
    v_mul_f32 v139, v139, v37
    v_mfma_f32_16x16x32_bf16 v[104:107], v[80:83], a[136:139], v[104:107]
    ds_read_b64_tr_b16 v[68:69], v11 offset:0
    v_exp_f32 v38, v152
    v_mfma_f32_16x16x32_bf16 v[108:111], v[80:83], a[140:143], v[108:111]
    ds_read_b64_tr_b16 v[70:71], v11 offset:512
    v_exp_f32 v39, v153
    v_mfma_f32_16x16x32_bf16 v[112:115], v[84:87], a[128:131], v[112:115]
    ds_read_b64_tr_b16 v[72:73], v12 offset:0
    v_exp_f32 v40, v154
    v_mfma_f32_16x16x32_bf16 v[116:119], v[84:87], a[132:135], v[116:119]
    ds_read_b64_tr_b16 v[74:75], v12 offset:512
    v_exp_f32 v41, v155
    v_mfma_f32_16x16x32_bf16 v[120:123], v[84:87], a[136:139], v[120:123]
    ds_read_b64_tr_b16 v[76:77], v13 offset:0
    v_add_f32 v38, 1.0, v38
    v_mfma_f32_16x16x32_bf16 v[124:127], v[84:87], a[140:143], v[124:127]
    ds_read_b64_tr_b16 v[78:79], v13 offset:512
    s_add_u32 m0, s25, 12288
    s_add_u32 s30, s28, s72
    v_add_f32 v39, 1.0, v39
    v_mfma_f32_16x16x32_bf16 v[192:195], v[88:91], a[128:131], v[192:195]
    buffer_load_dwordx4 v4, s[8:11], s30 offen lds
    v_add_f32 v40, 1.0, v40
    v_mfma_f32_16x16x32_bf16 v[196:199], v[88:91], a[132:135], v[196:199]
    v_add_f32 v41, 1.0, v41
    v_mfma_f32_16x16x32_bf16 v[200:203], v[88:91], a[136:139], v[200:203]
    buffer_load_dwordx4 v5, s[8:11], s30 offen offset:1024 lds
    v_rcp_f32 v38, v38
    v_mfma_f32_16x16x32_bf16 v[204:207], v[88:91], a[140:143], v[204:207]
    buffer_load_dwordx4 v6, s[8:11], s30 offen offset:2048 lds
    v_rcp_f32 v39, v39
    v_mfma_f32_16x16x32_bf16 v[208:211], v[92:95], a[128:131], v[208:211]
    v_rcp_f32 v40, v40
    v_mfma_f32_16x16x32_bf16 v[212:215], v[92:95], a[132:135], v[212:215]
    buffer_load_dwordx4 v7, s[8:11], s30 offen offset:3072 lds
    v_rcp_f32 v41, v41
    v_mfma_f32_16x16x32_bf16 v[216:219], v[92:95], a[136:139], v[216:219]
    v_mul_f32 v152, v152, v38
    v_mfma_f32_16x16x32_bf16 v[220:223], v[92:95], a[140:143], v[220:223]
    v_mul_f32 v153, v153, v39
    s_waitcnt vmcnt(8) lgkmcnt(0)
    v_mfma_f32_16x16x32_bf16 v[96:99], v[64:67], a[144:147], v[96:99]
    ds_read_b64_tr_b16 v[80:81], v10 offset:4096
    v_mul_f32 v154, v154, v40
    v_mfma_f32_16x16x32_bf16 v[100:103], v[64:67], a[148:151], v[100:103]
    ds_read_b64_tr_b16 v[82:83], v10 offset:4608
    v_mul_f32 v155, v155, v41
    v_mfma_f32_16x16x32_bf16 v[104:107], v[64:67], a[152:155], v[104:107]
    ds_read_b64_tr_b16 v[84:85], v11 offset:4096
    v_cvt_pk_bf16_f32 v42, v136, v137
    v_mfma_f32_16x16x32_bf16 v[108:111], v[64:67], a[156:159], v[108:111]
    ds_read_b64_tr_b16 v[86:87], v11 offset:4608
    v_cvt_pk_bf16_f32 v43, v138, v139
    v_mfma_f32_16x16x32_bf16 v[112:115], v[68:71], a[144:147], v[112:115]
    ds_read_b64_tr_b16 v[88:89], v12 offset:4096
    v_cvt_pk_bf16_f32 v44, v152, v153
    v_mfma_f32_16x16x32_bf16 v[116:119], v[68:71], a[148:151], v[116:119]
    ds_read_b64_tr_b16 v[90:91], v12 offset:4608
    v_cvt_pk_bf16_f32 v45, v154, v155
    v_mfma_f32_16x16x32_bf16 v[120:123], v[68:71], a[152:155], v[120:123]
    ds_read_b64_tr_b16 v[92:93], v13 offset:4096
    ds_write_b128 v3, v[42:45] offset:2048
    v_mfma_f32_16x16x32_bf16 v[124:127], v[68:71], a[156:159], v[124:127]
    ds_read_b64_tr_b16 v[94:95], v13 offset:4608
    s_add_u32 m0, s25, 0
    s_add_u32 s30, s28, s73
    v_mfma_f32_16x16x32_bf16 v[192:195], v[72:75], a[144:147], v[192:195]
    buffer_load_dwordx4 v4, s[8:11], s30 offen lds
    v_mfma_f32_16x16x32_bf16 v[196:199], v[72:75], a[148:151], v[196:199]
    v_mfma_f32_16x16x32_bf16 v[200:203], v[72:75], a[152:155], v[200:203]
    buffer_load_dwordx4 v5, s[8:11], s30 offen offset:1024 lds
    v_mfma_f32_16x16x32_bf16 v[204:207], v[72:75], a[156:159], v[204:207]
    buffer_load_dwordx4 v6, s[8:11], s30 offen offset:2048 lds
    v_mfma_f32_16x16x32_bf16 v[208:211], v[76:79], a[144:147], v[208:211]
    v_mfma_f32_16x16x32_bf16 v[212:215], v[76:79], a[148:151], v[212:215]
    buffer_load_dwordx4 v7, s[8:11], s30 offen offset:3072 lds
    v_mfma_f32_16x16x32_bf16 v[216:219], v[76:79], a[152:155], v[216:219]
    v_mfma_f32_16x16x32_bf16 v[220:223], v[76:79], a[156:159], v[220:223]
    s_waitcnt vmcnt(8) lgkmcnt(0)
    v_mfma_f32_16x16x32_bf16 v[96:99], v[80:83], a[160:163], v[96:99]
    ds_read_b64_tr_b16 v[64:65], v10 offset:8192
    v_add_f32 v176, v176, v50
    v_mfma_f32_16x16x32_bf16 v[100:103], v[80:83], a[164:167], v[100:103]
    ds_read_b64_tr_b16 v[66:67], v10 offset:8704
    v_add_f32 v177, v177, v51
    v_mfma_f32_16x16x32_bf16 v[104:107], v[80:83], a[168:171], v[104:107]
    ds_read_b64_tr_b16 v[68:69], v11 offset:8192
    v_add_f32 v178, v178, v52
    v_mfma_f32_16x16x32_bf16 v[108:111], v[80:83], a[172:175], v[108:111]
    ds_read_b64_tr_b16 v[70:71], v11 offset:8704
    v_add_f32 v179, v179, v53
    v_mfma_f32_16x16x32_bf16 v[112:115], v[84:87], a[160:163], v[112:115]
    ds_read_b64_tr_b16 v[72:73], v12 offset:8192
    v_add_f32 v180, v180, v54
    v_mfma_f32_16x16x32_bf16 v[116:119], v[84:87], a[164:167], v[116:119]
    ds_read_b64_tr_b16 v[74:75], v12 offset:8704
    v_add_f32 v181, v181, v55
    v_mfma_f32_16x16x32_bf16 v[120:123], v[84:87], a[168:171], v[120:123]
    ds_read_b64_tr_b16 v[76:77], v13 offset:8192
    v_add_f32 v182, v182, v56
    v_mfma_f32_16x16x32_bf16 v[124:127], v[84:87], a[172:175], v[124:127]
    ds_read_b64_tr_b16 v[78:79], v13 offset:8704
    s_add_u32 m0, s25, 4096
    s_add_u32 s30, s28, s74
    v_add_f32 v183, v183, v57
    v_mfma_f32_16x16x32_bf16 v[192:195], v[88:91], a[160:163], v[192:195]
    buffer_load_dwordx4 v4, s[8:11], s30 offen lds
    v_exp_f32 v34, v140
    v_mfma_f32_16x16x32_bf16 v[196:199], v[88:91], a[164:167], v[196:199]
    v_exp_f32 v35, v141
    v_mfma_f32_16x16x32_bf16 v[200:203], v[88:91], a[168:171], v[200:203]
    buffer_load_dwordx4 v5, s[8:11], s30 offen offset:1024 lds
    v_exp_f32 v36, v142
    v_mfma_f32_16x16x32_bf16 v[204:207], v[88:91], a[172:175], v[204:207]
    buffer_load_dwordx4 v6, s[8:11], s30 offen offset:2048 lds
    v_exp_f32 v37, v143
    v_mfma_f32_16x16x32_bf16 v[208:211], v[92:95], a[160:163], v[208:211]
    v_add_f32 v34, 1.0, v34
    v_mfma_f32_16x16x32_bf16 v[212:215], v[92:95], a[164:167], v[212:215]
    buffer_load_dwordx4 v7, s[8:11], s30 offen offset:3072 lds
    v_add_f32 v35, 1.0, v35
    v_mfma_f32_16x16x32_bf16 v[216:219], v[92:95], a[168:171], v[216:219]
    v_add_f32 v36, 1.0, v36
    v_mfma_f32_16x16x32_bf16 v[220:223], v[92:95], a[172:175], v[220:223]
    v_add_f32 v37, 1.0, v37
    s_waitcnt vmcnt(8) lgkmcnt(0)
    v_mfma_f32_16x16x32_bf16 v[96:99], v[64:67], a[176:179], v[96:99]
    ds_read_b64_tr_b16 v[80:81], v10 offset:12288
    v_rcp_f32 v34, v34
    v_mfma_f32_16x16x32_bf16 v[100:103], v[64:67], a[180:183], v[100:103]
    ds_read_b64_tr_b16 v[82:83], v10 offset:12800
    v_rcp_f32 v35, v35
    v_mfma_f32_16x16x32_bf16 v[104:107], v[64:67], a[184:187], v[104:107]
    ds_read_b64_tr_b16 v[84:85], v11 offset:12288
    v_rcp_f32 v36, v36
    v_mfma_f32_16x16x32_bf16 v[108:111], v[64:67], a[188:191], v[108:111]
    ds_read_b64_tr_b16 v[86:87], v11 offset:12800
    v_rcp_f32 v37, v37
    v_mfma_f32_16x16x32_bf16 v[112:115], v[68:71], a[176:179], v[112:115]
    ds_read_b64_tr_b16 v[88:89], v12 offset:12288
    v_mul_f32 v140, v140, v34
    v_mfma_f32_16x16x32_bf16 v[116:119], v[68:71], a[180:183], v[116:119]
    ds_read_b64_tr_b16 v[90:91], v12 offset:12800
    v_mul_f32 v141, v141, v35
    v_mfma_f32_16x16x32_bf16 v[120:123], v[68:71], a[184:187], v[120:123]
    ds_read_b64_tr_b16 v[92:93], v13 offset:12288
    v_mul_f32 v142, v142, v36
    v_mfma_f32_16x16x32_bf16 v[124:127], v[68:71], a[188:191], v[124:127]
    ds_read_b64_tr_b16 v[94:95], v13 offset:12800
    s_add_u32 m0, s25, 8192
    s_add_u32 s30, s28, s75
    v_mul_f32 v143, v143, v37
    v_mfma_f32_16x16x32_bf16 v[192:195], v[72:75], a[176:179], v[192:195]
    buffer_load_dwordx4 v4, s[8:11], s30 offen lds
    v_exp_f32 v38, v156
    v_mfma_f32_16x16x32_bf16 v[196:199], v[72:75], a[180:183], v[196:199]
    v_exp_f32 v39, v157
    v_mfma_f32_16x16x32_bf16 v[200:203], v[72:75], a[184:187], v[200:203]
    buffer_load_dwordx4 v5, s[8:11], s30 offen offset:1024 lds
    v_exp_f32 v40, v158
    v_mfma_f32_16x16x32_bf16 v[204:207], v[72:75], a[188:191], v[204:207]
    buffer_load_dwordx4 v6, s[8:11], s30 offen offset:2048 lds
    v_exp_f32 v41, v159
    v_mfma_f32_16x16x32_bf16 v[208:211], v[76:79], a[176:179], v[208:211]
    v_add_f32 v38, 1.0, v38
    v_mfma_f32_16x16x32_bf16 v[212:215], v[76:79], a[180:183], v[212:215]
    buffer_load_dwordx4 v7, s[8:11], s30 offen offset:3072 lds
    v_add_f32 v39, 1.0, v39
    v_mfma_f32_16x16x32_bf16 v[216:219], v[76:79], a[184:187], v[216:219]
    v_add_f32 v40, 1.0, v40
    v_mfma_f32_16x16x32_bf16 v[220:223], v[76:79], a[188:191], v[220:223]
    v_add_f32 v41, 1.0, v41
    s_waitcnt vmcnt(8) lgkmcnt(0)
    v_mfma_f32_16x16x32_bf16 v[96:99], v[80:83], a[192:195], v[96:99]
    ds_read_b64_tr_b16 v[64:65], v10 offset:0
    v_rcp_f32 v38, v38
    v_mfma_f32_16x16x32_bf16 v[100:103], v[80:83], a[196:199], v[100:103]
    ds_read_b64_tr_b16 v[66:67], v10 offset:512
    v_rcp_f32 v39, v39
    v_mfma_f32_16x16x32_bf16 v[104:107], v[80:83], a[200:203], v[104:107]
    ds_read_b64_tr_b16 v[68:69], v11 offset:0
    v_rcp_f32 v40, v40
    v_mfma_f32_16x16x32_bf16 v[108:111], v[80:83], a[204:207], v[108:111]
    ds_read_b64_tr_b16 v[70:71], v11 offset:512
    v_rcp_f32 v41, v41
    v_mfma_f32_16x16x32_bf16 v[112:115], v[84:87], a[192:195], v[112:115]
    ds_read_b64_tr_b16 v[72:73], v12 offset:0
    v_mul_f32 v156, v156, v38
    v_mfma_f32_16x16x32_bf16 v[116:119], v[84:87], a[196:199], v[116:119]
    ds_read_b64_tr_b16 v[74:75], v12 offset:512
    v_mul_f32 v157, v157, v39
    v_mfma_f32_16x16x32_bf16 v[120:123], v[84:87], a[200:203], v[120:123]
    ds_read_b64_tr_b16 v[76:77], v13 offset:0
    v_mul_f32 v158, v158, v40
    v_mfma_f32_16x16x32_bf16 v[124:127], v[84:87], a[204:207], v[124:127]
    ds_read_b64_tr_b16 v[78:79], v13 offset:512
    s_add_u32 m0, s25, 12288
    s_add_u32 s30, s28, s76
    v_mul_f32 v159, v159, v41
    v_mfma_f32_16x16x32_bf16 v[192:195], v[88:91], a[192:195], v[192:195]
    buffer_load_dwordx4 v4, s[8:11], s30 offen lds
    v_cvt_pk_bf16_f32 v46, v140, v141
    v_mfma_f32_16x16x32_bf16 v[196:199], v[88:91], a[196:199], v[196:199]
    v_cvt_pk_bf16_f32 v47, v142, v143
    v_mfma_f32_16x16x32_bf16 v[200:203], v[88:91], a[200:203], v[200:203]
    buffer_load_dwordx4 v5, s[8:11], s30 offen offset:1024 lds
    v_cvt_pk_bf16_f32 v48, v156, v157
    v_mfma_f32_16x16x32_bf16 v[204:207], v[88:91], a[204:207], v[204:207]
    buffer_load_dwordx4 v6, s[8:11], s30 offen offset:2048 lds
    v_cvt_pk_bf16_f32 v49, v158, v159
    v_mfma_f32_16x16x32_bf16 v[208:211], v[92:95], a[192:195], v[208:211]
    ds_write_b128 v3, v[46:49] offset:3072
    v_mfma_f32_16x16x32_bf16 v[212:215], v[92:95], a[196:199], v[212:215]
    buffer_load_dwordx4 v7, s[8:11], s30 offen offset:3072 lds
    v_exp_f32 v34, v160
    v_mfma_f32_16x16x32_bf16 v[216:219], v[92:95], a[200:203], v[216:219]
    v_exp_f32 v35, v161
    v_mfma_f32_16x16x32_bf16 v[220:223], v[92:95], a[204:207], v[220:223]
    v_exp_f32 v36, v162
    s_waitcnt vmcnt(8) lgkmcnt(1)
    v_mfma_f32_16x16x32_bf16 v[96:99], v[64:67], a[208:211], v[96:99]
    ds_read_b64_tr_b16 v[80:81], v10 offset:4096
    v_exp_f32 v37, v163
    v_mfma_f32_16x16x32_bf16 v[100:103], v[64:67], a[212:215], v[100:103]
    ds_read_b64_tr_b16 v[82:83], v10 offset:4608
    v_add_f32 v34, 1.0, v34
    v_mfma_f32_16x16x32_bf16 v[104:107], v[64:67], a[216:219], v[104:107]
    ds_read_b64_tr_b16 v[84:85], v11 offset:4096
    v_add_f32 v35, 1.0, v35
    v_mfma_f32_16x16x32_bf16 v[108:111], v[64:67], a[220:223], v[108:111]
    ds_read_b64_tr_b16 v[86:87], v11 offset:4608
    v_add_f32 v36, 1.0, v36
    v_mfma_f32_16x16x32_bf16 v[112:115], v[68:71], a[208:211], v[112:115]
    ds_read_b64_tr_b16 v[88:89], v12 offset:4096
    v_add_f32 v37, 1.0, v37
    v_mfma_f32_16x16x32_bf16 v[116:119], v[68:71], a[212:215], v[116:119]
    ds_read_b64_tr_b16 v[90:91], v12 offset:4608
    v_rcp_f32 v34, v34
    v_mfma_f32_16x16x32_bf16 v[120:123], v[68:71], a[216:219], v[120:123]
    ds_read_b64_tr_b16 v[92:93], v13 offset:4096
    v_rcp_f32 v35, v35
    v_mfma_f32_16x16x32_bf16 v[124:127], v[68:71], a[220:223], v[124:127]
    ds_read_b64_tr_b16 v[94:95], v13 offset:4608
    s_add_u32 m0, s25, 0
    s_add_u32 s30, s28, s77
    v_rcp_f32 v36, v36
    v_mfma_f32_16x16x32_bf16 v[192:195], v[72:75], a[208:211], v[192:195]
    buffer_load_dwordx4 v4, s[8:11], s30 offen lds
    v_rcp_f32 v37, v37
    v_mfma_f32_16x16x32_bf16 v[196:199], v[72:75], a[212:215], v[196:199]
    v_mul_f32 v160, v160, v34
    v_mfma_f32_16x16x32_bf16 v[200:203], v[72:75], a[216:219], v[200:203]
    buffer_load_dwordx4 v5, s[8:11], s30 offen offset:1024 lds
    v_mul_f32 v161, v161, v35
    v_mfma_f32_16x16x32_bf16 v[204:207], v[72:75], a[220:223], v[204:207]
    buffer_load_dwordx4 v6, s[8:11], s30 offen offset:2048 lds
    v_mul_f32 v162, v162, v36
    v_mfma_f32_16x16x32_bf16 v[208:211], v[76:79], a[208:211], v[208:211]
    v_mul_f32 v163, v163, v37
    v_mfma_f32_16x16x32_bf16 v[212:215], v[76:79], a[212:215], v[212:215]
    buffer_load_dwordx4 v7, s[8:11], s30 offen offset:3072 lds
    v_exp_f32 v38, v176
    v_mfma_f32_16x16x32_bf16 v[216:219], v[76:79], a[216:219], v[216:219]
    v_exp_f32 v39, v177
    v_mfma_f32_16x16x32_bf16 v[220:223], v[76:79], a[220:223], v[220:223]
    v_exp_f32 v40, v178
    s_waitcnt vmcnt(8) lgkmcnt(0)
    v_mfma_f32_16x16x32_bf16 v[96:99], v[80:83], a[224:227], v[96:99]
    ds_read_b64_tr_b16 v[64:65], v10 offset:8192
    v_exp_f32 v41, v179
    v_mfma_f32_16x16x32_bf16 v[100:103], v[80:83], a[228:231], v[100:103]
    ds_read_b64_tr_b16 v[66:67], v10 offset:8704
    v_add_f32 v38, 1.0, v38
    v_mfma_f32_16x16x32_bf16 v[104:107], v[80:83], a[232:235], v[104:107]
    ds_read_b64_tr_b16 v[68:69], v11 offset:8192
    v_add_f32 v39, 1.0, v39
    v_mfma_f32_16x16x32_bf16 v[108:111], v[80:83], a[236:239], v[108:111]
    ds_read_b64_tr_b16 v[70:71], v11 offset:8704
    v_add_f32 v40, 1.0, v40
    v_mfma_f32_16x16x32_bf16 v[112:115], v[84:87], a[224:227], v[112:115]
    ds_read_b64_tr_b16 v[72:73], v12 offset:8192
    v_add_f32 v41, 1.0, v41
    v_mfma_f32_16x16x32_bf16 v[116:119], v[84:87], a[228:231], v[116:119]
    ds_read_b64_tr_b16 v[74:75], v12 offset:8704
    v_rcp_f32 v38, v38
    v_mfma_f32_16x16x32_bf16 v[120:123], v[84:87], a[232:235], v[120:123]
    ds_read_b64_tr_b16 v[76:77], v13 offset:8192
    v_rcp_f32 v39, v39
    v_mfma_f32_16x16x32_bf16 v[124:127], v[84:87], a[236:239], v[124:127]
    ds_read_b64_tr_b16 v[78:79], v13 offset:8704
    s_add_u32 m0, s25, 4096
    s_add_u32 s30, s32, s78
    v_rcp_f32 v40, v40
    v_mfma_f32_16x16x32_bf16 v[192:195], v[88:91], a[224:227], v[192:195]
    buffer_load_dwordx4 v16, s[12:15], s30 offen lds
    v_rcp_f32 v41, v41
    v_mfma_f32_16x16x32_bf16 v[196:199], v[88:91], a[228:231], v[196:199]
    v_mul_f32 v176, v176, v38
    v_mfma_f32_16x16x32_bf16 v[200:203], v[88:91], a[232:235], v[200:203]
    buffer_load_dwordx4 v17, s[12:15], s30 offen offset:1024 lds
    v_mul_f32 v177, v177, v39
    v_mfma_f32_16x16x32_bf16 v[204:207], v[88:91], a[236:239], v[204:207]
    buffer_load_dwordx4 v18, s[12:15], s30 offen offset:2048 lds
    v_mul_f32 v178, v178, v40
    v_mfma_f32_16x16x32_bf16 v[208:211], v[92:95], a[224:227], v[208:211]
    v_mul_f32 v179, v179, v41
    v_mfma_f32_16x16x32_bf16 v[212:215], v[92:95], a[228:231], v[212:215]
    buffer_load_dwordx4 v19, s[12:15], s30 offen offset:3072 lds
    v_cvt_pk_bf16_f32 v42, v160, v161
    v_mfma_f32_16x16x32_bf16 v[216:219], v[92:95], a[232:235], v[216:219]
    v_cvt_pk_bf16_f32 v43, v162, v163
    v_mfma_f32_16x16x32_bf16 v[220:223], v[92:95], a[236:239], v[220:223]
    v_cvt_pk_bf16_f32 v44, v176, v177
    s_waitcnt vmcnt(8) lgkmcnt(0)
    v_mfma_f32_16x16x32_bf16 v[96:99], v[64:67], a[240:243], v[96:99]
    ds_read_b64_tr_b16 v[80:81], v10 offset:12288
    v_cvt_pk_bf16_f32 v45, v178, v179
    v_mfma_f32_16x16x32_bf16 v[100:103], v[64:67], a[244:247], v[100:103]
    ds_read_b64_tr_b16 v[82:83], v10 offset:12800
    ds_write_b128 v60, v[42:45] offset:0
    v_mfma_f32_16x16x32_bf16 v[104:107], v[64:67], a[248:251], v[104:107]
    ds_read_b64_tr_b16 v[84:85], v11 offset:12288
    v_exp_f32 v34, v164
    v_mfma_f32_16x16x32_bf16 v[108:111], v[64:67], a[252:255], v[108:111]
    ds_read_b64_tr_b16 v[86:87], v11 offset:12800
    v_exp_f32 v35, v165
    v_mfma_f32_16x16x32_bf16 v[112:115], v[68:71], a[240:243], v[112:115]
    ds_read_b64_tr_b16 v[88:89], v12 offset:12288
    v_exp_f32 v36, v166
    v_mfma_f32_16x16x32_bf16 v[116:119], v[68:71], a[244:247], v[116:119]
    ds_read_b64_tr_b16 v[90:91], v12 offset:12800
    v_exp_f32 v37, v167
    v_mfma_f32_16x16x32_bf16 v[120:123], v[68:71], a[248:251], v[120:123]
    ds_read_b64_tr_b16 v[92:93], v13 offset:12288
    v_add_f32 v34, 1.0, v34
    v_mfma_f32_16x16x32_bf16 v[124:127], v[68:71], a[252:255], v[124:127]
    ds_read_b64_tr_b16 v[94:95], v13 offset:12800
    s_add_u32 m0, s25, 8192
    s_add_u32 s30, s32, s79
    v_add_f32 v35, 1.0, v35
    v_mfma_f32_16x16x32_bf16 v[192:195], v[72:75], a[240:243], v[192:195]
    buffer_load_dwordx4 v16, s[12:15], s30 offen lds
    v_add_f32 v36, 1.0, v36
    v_mfma_f32_16x16x32_bf16 v[196:199], v[72:75], a[244:247], v[196:199]
    v_add_f32 v37, 1.0, v37
    v_mfma_f32_16x16x32_bf16 v[200:203], v[72:75], a[248:251], v[200:203]
    buffer_load_dwordx4 v17, s[12:15], s30 offen offset:1024 lds
    v_rcp_f32 v34, v34
    v_mfma_f32_16x16x32_bf16 v[204:207], v[72:75], a[252:255], v[204:207]
    buffer_load_dwordx4 v18, s[12:15], s30 offen offset:2048 lds
    v_rcp_f32 v35, v35
    v_mfma_f32_16x16x32_bf16 v[208:211], v[76:79], a[240:243], v[208:211]
    v_rcp_f32 v36, v36
    v_mfma_f32_16x16x32_bf16 v[212:215], v[76:79], a[244:247], v[212:215]
    buffer_load_dwordx4 v19, s[12:15], s30 offen offset:3072 lds
    v_rcp_f32 v37, v37
    v_mfma_f32_16x16x32_bf16 v[216:219], v[76:79], a[248:251], v[216:219]
    v_mul_f32 v164, v164, v34
    v_mfma_f32_16x16x32_bf16 v[220:223], v[76:79], a[252:255], v[220:223]
    v_mul_f32 v165, v165, v35
    s_waitcnt vmcnt(8) lgkmcnt(0)
    v_mfma_f32_16x16x32_bf16 v[96:99], v[80:83], v[224:227], v[96:99]
    ds_read_b64_tr_b16 v[64:65], v10 offset:0
    v_mul_f32 v166, v166, v36
    v_mfma_f32_16x16x32_bf16 v[100:103], v[80:83], v[228:231], v[100:103]
    ds_read_b64_tr_b16 v[66:67], v10 offset:512
    v_mul_f32 v167, v167, v37
    v_mfma_f32_16x16x32_bf16 v[104:107], v[80:83], v[232:235], v[104:107]
    ds_read_b64_tr_b16 v[68:69], v11 offset:0
    v_exp_f32 v38, v180
    v_mfma_f32_16x16x32_bf16 v[108:111], v[80:83], v[236:239], v[108:111]
    ds_read_b64_tr_b16 v[70:71], v11 offset:512
    v_exp_f32 v39, v181
    v_mfma_f32_16x16x32_bf16 v[112:115], v[84:87], v[224:227], v[112:115]
    ds_read_b64_tr_b16 v[72:73], v12 offset:0
    v_exp_f32 v40, v182
    v_mfma_f32_16x16x32_bf16 v[116:119], v[84:87], v[228:231], v[116:119]
    ds_read_b64_tr_b16 v[74:75], v12 offset:512
    v_exp_f32 v41, v183
    v_mfma_f32_16x16x32_bf16 v[120:123], v[84:87], v[232:235], v[120:123]
    ds_read_b64_tr_b16 v[76:77], v13 offset:0
    v_add_f32 v38, 1.0, v38
    v_mfma_f32_16x16x32_bf16 v[124:127], v[84:87], v[236:239], v[124:127]
    ds_read_b64_tr_b16 v[78:79], v13 offset:512
    s_add_u32 m0, s25, 12288
    s_add_u32 s30, s32, s80
    v_add_f32 v39, 1.0, v39
    v_mfma_f32_16x16x32_bf16 v[192:195], v[88:91], v[224:227], v[192:195]
    buffer_load_dwordx4 v16, s[12:15], s30 offen lds
    v_add_f32 v40, 1.0, v40
    v_mfma_f32_16x16x32_bf16 v[196:199], v[88:91], v[228:231], v[196:199]
    v_add_f32 v41, 1.0, v41
    v_mfma_f32_16x16x32_bf16 v[200:203], v[88:91], v[232:235], v[200:203]
    buffer_load_dwordx4 v17, s[12:15], s30 offen offset:1024 lds
    v_rcp_f32 v38, v38
    v_mfma_f32_16x16x32_bf16 v[204:207], v[88:91], v[236:239], v[204:207]
    buffer_load_dwordx4 v18, s[12:15], s30 offen offset:2048 lds
    v_rcp_f32 v39, v39
    v_mfma_f32_16x16x32_bf16 v[208:211], v[92:95], v[224:227], v[208:211]
    v_rcp_f32 v40, v40
    v_mfma_f32_16x16x32_bf16 v[212:215], v[92:95], v[228:231], v[212:215]
    buffer_load_dwordx4 v19, s[12:15], s30 offen offset:3072 lds
    v_rcp_f32 v41, v41
    v_mfma_f32_16x16x32_bf16 v[216:219], v[92:95], v[232:235], v[216:219]
    v_mul_f32 v180, v180, v38
    v_mfma_f32_16x16x32_bf16 v[220:223], v[92:95], v[236:239], v[220:223]
    v_mul_f32 v181, v181, v39
    s_waitcnt lgkmcnt(0)
    v_mfma_f32_16x16x32_bf16 v[96:99], v[64:67], v[240:243], v[96:99]
    v_mul_f32 v182, v182, v40
    v_mfma_f32_16x16x32_bf16 v[100:103], v[64:67], v[244:247], v[100:103]
    v_mul_f32 v183, v183, v41
    v_mfma_f32_16x16x32_bf16 v[104:107], v[64:67], v[248:251], v[104:107]
    v_cvt_pk_bf16_f32 v46, v164, v165
    v_mfma_f32_16x16x32_bf16 v[108:111], v[64:67], v[252:255], v[108:111]
    v_cvt_pk_bf16_f32 v47, v166, v167
    v_mfma_f32_16x16x32_bf16 v[112:115], v[68:71], v[240:243], v[112:115]
    v_cvt_pk_bf16_f32 v48, v180, v181
    v_mfma_f32_16x16x32_bf16 v[116:119], v[68:71], v[244:247], v[116:119]
    v_cvt_pk_bf16_f32 v49, v182, v183
    v_mfma_f32_16x16x32_bf16 v[120:123], v[68:71], v[248:251], v[120:123]
    ds_write_b128 v60, v[46:49] offset:1024
    v_mfma_f32_16x16x32_bf16 v[124:127], v[68:71], v[252:255], v[124:127]
    s_add_u32 m0, s25, 0
    s_add_u32 s30, s32, s81
    v_mfma_f32_16x16x32_bf16 v[192:195], v[72:75], v[240:243], v[192:195]
    buffer_load_dwordx4 v16, s[12:15], s30 offen lds
    v_mfma_f32_16x16x32_bf16 v[196:199], v[72:75], v[244:247], v[196:199]
    v_mfma_f32_16x16x32_bf16 v[200:203], v[72:75], v[248:251], v[200:203]
    buffer_load_dwordx4 v17, s[12:15], s30 offen offset:1024 lds
    v_mfma_f32_16x16x32_bf16 v[204:207], v[72:75], v[252:255], v[204:207]
    buffer_load_dwordx4 v18, s[12:15], s30 offen offset:2048 lds
    v_mfma_f32_16x16x32_bf16 v[208:211], v[76:79], v[240:243], v[208:211]
    v_mfma_f32_16x16x32_bf16 v[212:215], v[76:79], v[244:247], v[212:215]
    buffer_load_dwordx4 v19, s[12:15], s30 offen offset:3072 lds
    v_mfma_f32_16x16x32_bf16 v[216:219], v[76:79], v[248:251], v[216:219]
    v_mfma_f32_16x16x32_bf16 v[220:223], v[76:79], v[252:255], v[220:223]
    s_lshl_b32 s36, s35, 1
    s_add_u32 s36, s36, 18
    s_sub_u32 s36, s36, s43
    s_cmp_ge_u32 s36, 18
    s_cselect_b32 s37, 18, 0
    s_sub_u32 s36, s36, s37
    s_lshl_b32 s36, s36, 12
    v_add_u32 v30, s36, v28
    s_lshl_b32 s36, s35, 1
    s_add_u32 s36, s36, 1
    s_add_u32 s36, s36, 18
    s_sub_u32 s36, s36, s43
    s_cmp_ge_u32 s36, 18
    s_cselect_b32 s37, 18, 0
    s_sub_u32 s36, s36, s37
    s_lshl_b32 s36, s36, 12
    v_add_u32 v3, s36, v28
    s_nop 3
    v_exp_f32 v128, v96
    v_exp_f32 v129, v97
    v_exp_f32 v130, v98
    v_exp_f32 v131, v99
    v_exp_f32 v132, v112
    v_exp_f32 v133, v113
    v_exp_f32 v134, v114
    v_exp_f32 v135, v115
    v_pk_add_f32 v[128:129], v[128:129], 1.0 op_sel_hi:[1,0]
    v_pk_add_f32 v[130:131], v[130:131], 1.0 op_sel_hi:[1,0]
    v_pk_add_f32 v[132:133], v[132:133], 1.0 op_sel_hi:[1,0]
    v_pk_add_f32 v[134:135], v[134:135], 1.0 op_sel_hi:[1,0]
    v_rcp_f32 v128, v128
    v_rcp_f32 v129, v129
    v_rcp_f32 v130, v130
    v_rcp_f32 v131, v131
    v_rcp_f32 v132, v132
    v_rcp_f32 v133, v133
    v_rcp_f32 v134, v134
    v_rcp_f32 v135, v135
    v_pk_mul_f32 v[128:129], v[128:129], v[96:97]
    v_pk_mul_f32 v[130:131], v[130:131], v[98:99]
    v_pk_mul_f32 v[132:133], v[132:133], v[112:113]
    v_pk_mul_f32 v[134:135], v[134:135], v[114:115]
    v_cvt_pk_bf16_f32 v42, v128, v129
    v_cvt_pk_bf16_f32 v43, v130, v131
    v_cvt_pk_bf16_f32 v44, v132, v133
    v_cvt_pk_bf16_f32 v45, v134, v135
    v_exp_f32 v136, v100
    v_exp_f32 v137, v101
    ds_write_b128 v30, v[42:45] offset:0
    v_exp_f32 v138, v102
    v_exp_f32 v139, v103
    v_exp_f32 v140, v116
    v_exp_f32 v141, v117
    v_exp_f32 v142, v118
    v_exp_f32 v143, v119
    v_pk_add_f32 v[136:137], v[136:137], 1.0 op_sel_hi:[1,0]
    v_pk_add_f32 v[138:139], v[138:139], 1.0 op_sel_hi:[1,0]
    v_pk_add_f32 v[140:141], v[140:141], 1.0 op_sel_hi:[1,0]
    v_pk_add_f32 v[142:143], v[142:143], 1.0 op_sel_hi:[1,0]
    v_rcp_f32 v136, v136
    v_rcp_f32 v137, v137
    v_rcp_f32 v138, v138
    v_rcp_f32 v139, v139
    v_rcp_f32 v140, v140
    v_rcp_f32 v141, v141
    v_rcp_f32 v142, v142
    v_rcp_f32 v143, v143
    v_pk_mul_f32 v[136:137], v[136:137], v[100:101]
    v_pk_mul_f32 v[138:139], v[138:139], v[102:103]
    v_pk_mul_f32 v[140:141], v[140:141], v[116:117]
    v_pk_mul_f32 v[142:143], v[142:143], v[118:119]
    v_cvt_pk_bf16_f32 v46, v136, v137
    v_cvt_pk_bf16_f32 v47, v138, v139
    v_cvt_pk_bf16_f32 v48, v140, v141
    v_cvt_pk_bf16_f32 v49, v142, v143
    v_exp_f32 v144, v104
    v_exp_f32 v145, v105
    ds_write_b128 v30, v[46:49] offset:1024
    v_exp_f32 v146, v106
    v_exp_f32 v147, v107
    v_exp_f32 v148, v120
    v_exp_f32 v149, v121
    v_exp_f32 v150, v122
    v_exp_f32 v151, v123
    v_pk_add_f32 v[144:145], v[144:145], 1.0 op_sel_hi:[1,0]
    v_pk_add_f32 v[146:147], v[146:147], 1.0 op_sel_hi:[1,0]
    v_pk_add_f32 v[148:149], v[148:149], 1.0 op_sel_hi:[1,0]
    v_pk_add_f32 v[150:151], v[150:151], 1.0 op_sel_hi:[1,0]
    v_rcp_f32 v144, v144
    v_rcp_f32 v145, v145
    v_rcp_f32 v146, v146
    v_rcp_f32 v147, v147
    v_rcp_f32 v148, v148
    v_rcp_f32 v149, v149
    v_rcp_f32 v150, v150
    v_rcp_f32 v151, v151
    v_pk_mul_f32 v[144:145], v[144:145], v[104:105]
    v_pk_mul_f32 v[146:147], v[146:147], v[106:107]
    v_pk_mul_f32 v[148:149], v[148:149], v[120:121]
    v_pk_mul_f32 v[150:151], v[150:151], v[122:123]
    v_cvt_pk_bf16_f32 v42, v144, v145
    v_cvt_pk_bf16_f32 v43, v146, v147
    v_cvt_pk_bf16_f32 v44, v148, v149
    v_cvt_pk_bf16_f32 v45, v150, v151
    v_exp_f32 v152, v108
    v_exp_f32 v153, v109
    ds_write_b128 v30, v[42:45] offset:2048
    v_exp_f32 v154, v110
    v_exp_f32 v155, v111
    v_exp_f32 v156, v124
    v_exp_f32 v157, v125
    v_exp_f32 v158, v126
    v_exp_f32 v159, v127
    v_pk_add_f32 v[152:153], v[152:153], 1.0 op_sel_hi:[1,0]
    v_pk_add_f32 v[154:155], v[154:155], 1.0 op_sel_hi:[1,0]
    v_pk_add_f32 v[156:157], v[156:157], 1.0 op_sel_hi:[1,0]
    v_pk_add_f32 v[158:159], v[158:159], 1.0 op_sel_hi:[1,0]
    v_rcp_f32 v152, v152
    v_rcp_f32 v153, v153
    v_rcp_f32 v154, v154
    v_rcp_f32 v155, v155
    v_rcp_f32 v156, v156
    v_rcp_f32 v157, v157
    v_rcp_f32 v158, v158
    v_rcp_f32 v159, v159
    v_pk_mul_f32 v[152:153], v[152:153], v[108:109]
    v_pk_mul_f32 v[154:155], v[154:155], v[110:111]
    v_pk_mul_f32 v[156:157], v[156:157], v[124:125]
    v_pk_mul_f32 v[158:159], v[158:159], v[126:127]
    v_cvt_pk_bf16_f32 v46, v152, v153
    v_cvt_pk_bf16_f32 v47, v154, v155
    v_cvt_pk_bf16_f32 v48, v156, v157
    v_cvt_pk_bf16_f32 v49, v158, v159
    v_exp_f32 v160, v192
    v_exp_f32 v161, v193
    ds_write_b128 v30, v[46:49] offset:3072
    v_exp_f32 v162, v194
    v_exp_f32 v163, v195
    v_exp_f32 v164, v208
    v_exp_f32 v165, v209
    v_exp_f32 v166, v210
    v_exp_f32 v167, v211
    v_pk_add_f32 v[160:161], v[160:161], 1.0 op_sel_hi:[1,0]
    v_pk_add_f32 v[162:163], v[162:163], 1.0 op_sel_hi:[1,0]
    v_pk_add_f32 v[164:165], v[164:165], 1.0 op_sel_hi:[1,0]
    v_pk_add_f32 v[166:167], v[166:167], 1.0 op_sel_hi:[1,0]
    v_rcp_f32 v160, v160
    v_rcp_f32 v161, v161
    v_rcp_f32 v162, v162
    v_rcp_f32 v163, v163
    v_rcp_f32 v164, v164
    v_rcp_f32 v165, v165
    v_rcp_f32 v166, v166
    v_rcp_f32 v167, v167
    v_pk_mul_f32 v[160:161], v[160:161], v[192:193]
    v_pk_mul_f32 v[162:163], v[162:163], v[194:195]
    v_pk_mul_f32 v[164:165], v[164:165], v[208:209]
    v_pk_mul_f32 v[166:167], v[166:167], v[210:211]
    v_cvt_pk_bf16_f32 v42, v160, v161
    v_cvt_pk_bf16_f32 v43, v162, v163
    v_cvt_pk_bf16_f32 v44, v164, v165
    v_cvt_pk_bf16_f32 v45, v166, v167
    v_exp_f32 v168, v196
    v_exp_f32 v169, v197
    ds_write_b128 v3, v[42:45] offset:0
    v_exp_f32 v170, v198
    v_exp_f32 v171, v199
    v_exp_f32 v172, v212
    v_exp_f32 v173, v213
    v_exp_f32 v174, v214
    v_exp_f32 v175, v215
    v_pk_add_f32 v[168:169], v[168:169], 1.0 op_sel_hi:[1,0]
    v_pk_add_f32 v[170:171], v[170:171], 1.0 op_sel_hi:[1,0]
    v_pk_add_f32 v[172:173], v[172:173], 1.0 op_sel_hi:[1,0]
    v_pk_add_f32 v[174:175], v[174:175], 1.0 op_sel_hi:[1,0]
    v_rcp_f32 v168, v168
    v_rcp_f32 v169, v169
    v_rcp_f32 v170, v170
    v_rcp_f32 v171, v171
    v_rcp_f32 v172, v172
    v_rcp_f32 v173, v173
    v_rcp_f32 v174, v174
    v_rcp_f32 v175, v175
    v_pk_mul_f32 v[168:169], v[168:169], v[196:197]
    v_pk_mul_f32 v[170:171], v[170:171], v[198:199]
    v_pk_mul_f32 v[172:173], v[172:173], v[212:213]
    v_pk_mul_f32 v[174:175], v[174:175], v[214:215]
    v_cvt_pk_bf16_f32 v46, v168, v169
    v_cvt_pk_bf16_f32 v47, v170, v171
    v_cvt_pk_bf16_f32 v48, v172, v173
    v_cvt_pk_bf16_f32 v49, v174, v175
    v_exp_f32 v176, v200
    v_exp_f32 v177, v201
    ds_write_b128 v3, v[46:49] offset:1024
    v_exp_f32 v178, v202
    v_exp_f32 v179, v203
    v_exp_f32 v180, v216
    v_exp_f32 v181, v217
    v_exp_f32 v182, v218
    v_exp_f32 v183, v219
    v_pk_add_f32 v[176:177], v[176:177], 1.0 op_sel_hi:[1,0]
    v_pk_add_f32 v[178:179], v[178:179], 1.0 op_sel_hi:[1,0]
    v_pk_add_f32 v[180:181], v[180:181], 1.0 op_sel_hi:[1,0]
    v_pk_add_f32 v[182:183], v[182:183], 1.0 op_sel_hi:[1,0]
    v_rcp_f32 v176, v176
    v_rcp_f32 v177, v177
    v_rcp_f32 v178, v178
    v_rcp_f32 v179, v179
    v_rcp_f32 v180, v180
    v_rcp_f32 v181, v181
    v_rcp_f32 v182, v182
    v_rcp_f32 v183, v183
    v_pk_mul_f32 v[176:177], v[176:177], v[200:201]
    v_pk_mul_f32 v[178:179], v[178:179], v[202:203]
    v_pk_mul_f32 v[180:181], v[180:181], v[216:217]
    v_pk_mul_f32 v[182:183], v[182:183], v[218:219]
    v_cvt_pk_bf16_f32 v42, v176, v177
    v_cvt_pk_bf16_f32 v43, v178, v179
    v_cvt_pk_bf16_f32 v44, v180, v181
    v_cvt_pk_bf16_f32 v45, v182, v183
    v_exp_f32 v184, v204
    v_exp_f32 v185, v205
    ds_write_b128 v3, v[42:45] offset:2048
    v_exp_f32 v186, v206
    v_exp_f32 v187, v207
    v_exp_f32 v188, v220
    v_exp_f32 v189, v221
    v_exp_f32 v190, v222
    v_exp_f32 v191, v223
    v_pk_add_f32 v[184:185], v[184:185], 1.0 op_sel_hi:[1,0]
    v_pk_add_f32 v[186:187], v[186:187], 1.0 op_sel_hi:[1,0]
    v_pk_add_f32 v[188:189], v[188:189], 1.0 op_sel_hi:[1,0]
    v_pk_add_f32 v[190:191], v[190:191], 1.0 op_sel_hi:[1,0]
    v_rcp_f32 v184, v184
    v_rcp_f32 v185, v185
    v_rcp_f32 v186, v186
    v_rcp_f32 v187, v187
    v_rcp_f32 v188, v188
    v_rcp_f32 v189, v189
    v_rcp_f32 v190, v190
    v_rcp_f32 v191, v191
    v_pk_mul_f32 v[184:185], v[184:185], v[204:205]
    v_pk_mul_f32 v[186:187], v[186:187], v[206:207]
    v_pk_mul_f32 v[188:189], v[188:189], v[220:221]
    v_pk_mul_f32 v[190:191], v[190:191], v[222:223]
    v_cvt_pk_bf16_f32 v46, v184, v185
    v_cvt_pk_bf16_f32 v47, v186, v187
    v_cvt_pk_bf16_f32 v48, v188, v189
    v_cvt_pk_bf16_f32 v49, v190, v191
    ds_write_b128 v3, v[46:49] offset:3072
    s_waitcnt vmcnt(12)
    ds_read_b64_tr_b16 v[80:81], v22 offset:4096
    ds_read_b64_tr_b16 v[82:83], v22 offset:6144
    ds_read_b64_tr_b16 v[84:85], v23 offset:4096
    ds_read_b64_tr_b16 v[86:87], v23 offset:6144
    ds_read_b64_tr_b16 v[88:89], v24 offset:4096
    ds_read_b64_tr_b16 v[90:91], v24 offset:6144
    ds_read_b64_tr_b16 v[92:93], v25 offset:4096
    ds_read_b64_tr_b16 v[94:95], v25 offset:6144
    s_waitcnt lgkmcnt(0)
    s_barrier
    ds_read_b128 a[0:3], v28 offset:0
    ds_read_b128 a[4:7], v28 offset:1024
    ds_read_b128 a[8:11], v28 offset:2048
    ds_read_b128 a[12:15], v28 offset:3072
    s_waitcnt vmcnt(8) lgkmcnt(0)
    v_mfma_f32_16x16x32_bf16 v[96:99], v[80:83], a[0:3], 0
    ds_read_b64_tr_b16 v[64:65], v22 offset:8192
    v_mfma_f32_16x16x32_bf16 v[100:103], v[80:83], a[4:7], 0
    ds_read_b64_tr_b16 v[66:67], v22 offset:10240
    v_mfma_f32_16x16x32_bf16 v[104:107], v[80:83], a[8:11], 0
    ds_read_b64_tr_b16 v[68:69], v23 offset:8192
    v_mfma_f32_16x16x32_bf16 v[108:111], v[80:83], a[12:15], 0
    ds_read_b64_tr_b16 v[70:71], v23 offset:10240
    v_mfma_f32_16x16x32_bf16 v[112:115], v[84:87], a[0:3], 0
    ds_read_b64_tr_b16 v[72:73], v24 offset:8192
    v_mfma_f32_16x16x32_bf16 v[116:119], v[84:87], a[4:7], 0
    ds_read_b64_tr_b16 v[74:75], v24 offset:10240
    v_mfma_f32_16x16x32_bf16 v[120:123], v[84:87], a[8:11], 0
    ds_read_b64_tr_b16 v[76:77], v25 offset:8192
    v_mfma_f32_16x16x32_bf16 v[124:127], v[84:87], a[12:15], 0
    ds_read_b64_tr_b16 v[78:79], v25 offset:10240
    s_add_u32 m0, s25, 4096
    s_add_u32 s30, s32, s82
    v_mfma_f32_16x16x32_bf16 v[128:131], v[88:91], a[0:3], 0
    ds_read_b128 a[16:19], v28 offset:4096
    buffer_load_dwordx4 v16, s[12:15], s30 offen lds
    v_mfma_f32_16x16x32_bf16 v[132:135], v[88:91], a[4:7], 0
    ds_read_b128 a[20:23], v28 offset:5120
    v_mfma_f32_16x16x32_bf16 v[136:139], v[88:91], a[8:11], 0
    ds_read_b128 a[24:27], v28 offset:6144
    buffer_load_dwordx4 v17, s[12:15], s30 offen offset:1024 lds
    v_mfma_f32_16x16x32_bf16 v[140:143], v[88:91], a[12:15], 0
    ds_read_b128 a[28:31], v28 offset:7168
    buffer_load_dwordx4 v18, s[12:15], s30 offen offset:2048 lds
    v_mfma_f32_16x16x32_bf16 v[144:147], v[92:95], a[0:3], 0
    v_mfma_f32_16x16x32_bf16 v[148:151], v[92:95], a[4:7], 0
    buffer_load_dwordx4 v19, s[12:15], s30 offen offset:3072 lds
    v_mfma_f32_16x16x32_bf16 v[152:155], v[92:95], a[8:11], 0
    v_mfma_f32_16x16x32_bf16 v[156:159], v[92:95], a[12:15], 0
    s_waitcnt vmcnt(8) lgkmcnt(0)
    v_mfma_f32_16x16x32_bf16 v[96:99], v[64:67], a[16:19], v[96:99]
    ds_read_b64_tr_b16 v[80:81], v22 offset:12288
    v_mfma_f32_16x16x32_bf16 v[100:103], v[64:67], a[20:23], v[100:103]
    ds_read_b64_tr_b16 v[82:83], v22 offset:14336
    v_mfma_f32_16x16x32_bf16 v[104:107], v[64:67], a[24:27], v[104:107]
    ds_read_b64_tr_b16 v[84:85], v23 offset:12288
    v_mfma_f32_16x16x32_bf16 v[108:111], v[64:67], a[28:31], v[108:111]
    ds_read_b64_tr_b16 v[86:87], v23 offset:14336
    v_mfma_f32_16x16x32_bf16 v[112:115], v[68:71], a[16:19], v[112:115]
    ds_read_b64_tr_b16 v[88:89], v24 offset:12288
    v_mfma_f32_16x16x32_bf16 v[116:119], v[68:71], a[20:23], v[116:119]
    ds_read_b64_tr_b16 v[90:91], v24 offset:14336
    v_mfma_f32_16x16x32_bf16 v[120:123], v[68:71], a[24:27], v[120:123]
    ds_read_b64_tr_b16 v[92:93], v25 offset:12288
    v_mfma_f32_16x16x32_bf16 v[124:127], v[68:71], a[28:31], v[124:127]
    ds_read_b64_tr_b16 v[94:95], v25 offset:14336
    s_add_u32 m0, s25, 8192
    s_add_u32 s30, s32, s83
    v_mfma_f32_16x16x32_bf16 v[128:131], v[72:75], a[16:19], v[128:131]
    ds_read_b128 a[32:35], v28 offset:8192
    buffer_load_dwordx4 v16, s[12:15], s30 offen lds
    v_mfma_f32_16x16x32_bf16 v[132:135], v[72:75], a[20:23], v[132:135]
    ds_read_b128 a[36:39], v28 offset:9216
    v_mfma_f32_16x16x32_bf16 v[136:139], v[72:75], a[24:27], v[136:139]
    ds_read_b128 a[40:43], v28 offset:10240
    buffer_load_dwordx4 v17, s[12:15], s30 offen offset:1024 lds
    v_mfma_f32_16x16x32_bf16 v[140:143], v[72:75], a[28:31], v[140:143]
    ds_read_b128 a[44:47], v28 offset:11264
    buffer_load_dwordx4 v18, s[12:15], s30 offen offset:2048 lds
    v_mfma_f32_16x16x32_bf16 v[144:147], v[76:79], a[16:19], v[144:147]
    v_mfma_f32_16x16x32_bf16 v[148:151], v[76:79], a[20:23], v[148:151]
    buffer_load_dwordx4 v19, s[12:15], s30 offen offset:3072 lds
    v_mfma_f32_16x16x32_bf16 v[152:155], v[76:79], a[24:27], v[152:155]
    v_mfma_f32_16x16x32_bf16 v[156:159], v[76:79], a[28:31], v[156:159]
    s_waitcnt vmcnt(8) lgkmcnt(0)
    v_mfma_f32_16x16x32_bf16 v[96:99], v[80:83], a[32:35], v[96:99]
    ds_read_b64_tr_b16 v[64:65], v22 offset:0
    v_mfma_f32_16x16x32_bf16 v[100:103], v[80:83], a[36:39], v[100:103]
    ds_read_b64_tr_b16 v[66:67], v22 offset:2048
    v_mfma_f32_16x16x32_bf16 v[104:107], v[80:83], a[40:43], v[104:107]
    ds_read_b64_tr_b16 v[68:69], v23 offset:0
    v_mfma_f32_16x16x32_bf16 v[108:111], v[80:83], a[44:47], v[108:111]
    ds_read_b64_tr_b16 v[70:71], v23 offset:2048
    v_mfma_f32_16x16x32_bf16 v[112:115], v[84:87], a[32:35], v[112:115]
    ds_read_b64_tr_b16 v[72:73], v24 offset:0
    v_mfma_f32_16x16x32_bf16 v[116:119], v[84:87], a[36:39], v[116:119]
    ds_read_b64_tr_b16 v[74:75], v24 offset:2048
    v_mfma_f32_16x16x32_bf16 v[120:123], v[84:87], a[40:43], v[120:123]
    ds_read_b64_tr_b16 v[76:77], v25 offset:0
    v_mfma_f32_16x16x32_bf16 v[124:127], v[84:87], a[44:47], v[124:127]
    ds_read_b64_tr_b16 v[78:79], v25 offset:2048
    s_add_u32 m0, s25, 12288
    s_add_u32 s30, s32, s84
    v_mfma_f32_16x16x32_bf16 v[128:131], v[88:91], a[32:35], v[128:131]
    ds_read_b128 a[48:51], v28 offset:12288
    buffer_load_dwordx4 v16, s[12:15], s30 offen lds
    v_mfma_f32_16x16x32_bf16 v[132:135], v[88:91], a[36:39], v[132:135]
    ds_read_b128 a[52:55], v28 offset:13312
    v_mfma_f32_16x16x32_bf16 v[136:139], v[88:91], a[40:43], v[136:139]
    ds_read_b128 a[56:59], v28 offset:14336
    buffer_load_dwordx4 v17, s[12:15], s30 offen offset:1024 lds
    v_mfma_f32_16x16x32_bf16 v[140:143], v[88:91], a[44:47], v[140:143]
    ds_read_b128 a[60:63], v28 offset:15360
    buffer_load_dwordx4 v18, s[12:15], s30 offen offset:2048 lds
    v_mfma_f32_16x16x32_bf16 v[144:147], v[92:95], a[32:35], v[144:147]
    v_mfma_f32_16x16x32_bf16 v[148:151], v[92:95], a[36:39], v[148:151]
    buffer_load_dwordx4 v19, s[12:15], s30 offen offset:3072 lds
    v_mfma_f32_16x16x32_bf16 v[152:155], v[92:95], a[40:43], v[152:155]
    v_mfma_f32_16x16x32_bf16 v[156:159], v[92:95], a[44:47], v[156:159]
    s_waitcnt vmcnt(8) lgkmcnt(0)
    v_mfma_f32_16x16x32_bf16 v[96:99], v[64:67], a[48:51], v[96:99]
    ds_read_b64_tr_b16 v[80:81], v22 offset:4096
    v_mfma_f32_16x16x32_bf16 v[100:103], v[64:67], a[52:55], v[100:103]
    ds_read_b64_tr_b16 v[82:83], v22 offset:6144
    v_mfma_f32_16x16x32_bf16 v[104:107], v[64:67], a[56:59], v[104:107]
    ds_read_b64_tr_b16 v[84:85], v23 offset:4096
    v_mfma_f32_16x16x32_bf16 v[108:111], v[64:67], a[60:63], v[108:111]
    ds_read_b64_tr_b16 v[86:87], v23 offset:6144
    v_mfma_f32_16x16x32_bf16 v[112:115], v[68:71], a[48:51], v[112:115]
    ds_read_b64_tr_b16 v[88:89], v24 offset:4096
    v_mfma_f32_16x16x32_bf16 v[116:119], v[68:71], a[52:55], v[116:119]
    ds_read_b64_tr_b16 v[90:91], v24 offset:6144
    v_mfma_f32_16x16x32_bf16 v[120:123], v[68:71], a[56:59], v[120:123]
    ds_read_b64_tr_b16 v[92:93], v25 offset:4096
    v_mfma_f32_16x16x32_bf16 v[124:127], v[68:71], a[60:63], v[124:127]
    ds_read_b64_tr_b16 v[94:95], v25 offset:6144
    s_add_u32 m0, s25, 0
    s_add_u32 s30, s32, s85
    v_mfma_f32_16x16x32_bf16 v[128:131], v[72:75], a[48:51], v[128:131]
    ds_read_b128 a[64:67], v28 offset:16384
    buffer_load_dwordx4 v16, s[12:15], s30 offen lds
    v_mfma_f32_16x16x32_bf16 v[132:135], v[72:75], a[52:55], v[132:135]
    ds_read_b128 a[68:71], v28 offset:17408
    v_mfma_f32_16x16x32_bf16 v[136:139], v[72:75], a[56:59], v[136:139]
    ds_read_b128 a[72:75], v28 offset:18432
    buffer_load_dwordx4 v17, s[12:15], s30 offen offset:1024 lds
    v_mfma_f32_16x16x32_bf16 v[140:143], v[72:75], a[60:63], v[140:143]
    ds_read_b128 a[76:79], v28 offset:19456
    buffer_load_dwordx4 v18, s[12:15], s30 offen offset:2048 lds
    v_mfma_f32_16x16x32_bf16 v[144:147], v[76:79], a[48:51], v[144:147]
    v_mfma_f32_16x16x32_bf16 v[148:151], v[76:79], a[52:55], v[148:151]
    buffer_load_dwordx4 v19, s[12:15], s30 offen offset:3072 lds
    v_mfma_f32_16x16x32_bf16 v[152:155], v[76:79], a[56:59], v[152:155]
    v_mfma_f32_16x16x32_bf16 v[156:159], v[76:79], a[60:63], v[156:159]
    s_waitcnt vmcnt(8) lgkmcnt(0)
    v_mfma_f32_16x16x32_bf16 v[96:99], v[80:83], a[64:67], v[96:99]
    ds_read_b64_tr_b16 v[64:65], v22 offset:8192
    v_mfma_f32_16x16x32_bf16 v[100:103], v[80:83], a[68:71], v[100:103]
    ds_read_b64_tr_b16 v[66:67], v22 offset:10240
    v_mfma_f32_16x16x32_bf16 v[104:107], v[80:83], a[72:75], v[104:107]
    ds_read_b64_tr_b16 v[68:69], v23 offset:8192
    v_mfma_f32_16x16x32_bf16 v[108:111], v[80:83], a[76:79], v[108:111]
    ds_read_b64_tr_b16 v[70:71], v23 offset:10240
    v_mfma_f32_16x16x32_bf16 v[112:115], v[84:87], a[64:67], v[112:115]
    ds_read_b64_tr_b16 v[72:73], v24 offset:8192
    v_mfma_f32_16x16x32_bf16 v[116:119], v[84:87], a[68:71], v[116:119]
    ds_read_b64_tr_b16 v[74:75], v24 offset:10240
    v_mfma_f32_16x16x32_bf16 v[120:123], v[84:87], a[72:75], v[120:123]
    ds_read_b64_tr_b16 v[76:77], v25 offset:8192
    v_mfma_f32_16x16x32_bf16 v[124:127], v[84:87], a[76:79], v[124:127]
    ds_read_b64_tr_b16 v[78:79], v25 offset:10240
    s_add_u32 m0, s25, 4096
    s_add_u32 s30, s32, s86
    v_mfma_f32_16x16x32_bf16 v[128:131], v[88:91], a[64:67], v[128:131]
    ds_read_b128 a[80:83], v28 offset:20480
    buffer_load_dwordx4 v16, s[12:15], s30 offen lds
    v_mfma_f32_16x16x32_bf16 v[132:135], v[88:91], a[68:71], v[132:135]
    ds_read_b128 a[84:87], v28 offset:21504
    v_mfma_f32_16x16x32_bf16 v[136:139], v[88:91], a[72:75], v[136:139]
    ds_read_b128 a[88:91], v28 offset:22528
    buffer_load_dwordx4 v17, s[12:15], s30 offen offset:1024 lds
    v_mfma_f32_16x16x32_bf16 v[140:143], v[88:91], a[76:79], v[140:143]
    ds_read_b128 a[92:95], v28 offset:23552
    buffer_load_dwordx4 v18, s[12:15], s30 offen offset:2048 lds
    v_mfma_f32_16x16x32_bf16 v[144:147], v[92:95], a[64:67], v[144:147]
    v_mfma_f32_16x16x32_bf16 v[148:151], v[92:95], a[68:71], v[148:151]
    buffer_load_dwordx4 v19, s[12:15], s30 offen offset:3072 lds
    v_mfma_f32_16x16x32_bf16 v[152:155], v[92:95], a[72:75], v[152:155]
    v_mfma_f32_16x16x32_bf16 v[156:159], v[92:95], a[76:79], v[156:159]
    s_waitcnt vmcnt(8) lgkmcnt(0)
    v_mfma_f32_16x16x32_bf16 v[96:99], v[64:67], a[80:83], v[96:99]
    ds_read_b64_tr_b16 v[80:81], v22 offset:12288
    v_mfma_f32_16x16x32_bf16 v[100:103], v[64:67], a[84:87], v[100:103]
    ds_read_b64_tr_b16 v[82:83], v22 offset:14336
    v_mfma_f32_16x16x32_bf16 v[104:107], v[64:67], a[88:91], v[104:107]
    ds_read_b64_tr_b16 v[84:85], v23 offset:12288
    v_mfma_f32_16x16x32_bf16 v[108:111], v[64:67], a[92:95], v[108:111]
    ds_read_b64_tr_b16 v[86:87], v23 offset:14336
    v_mfma_f32_16x16x32_bf16 v[112:115], v[68:71], a[80:83], v[112:115]
    ds_read_b64_tr_b16 v[88:89], v24 offset:12288
    v_mfma_f32_16x16x32_bf16 v[116:119], v[68:71], a[84:87], v[116:119]
    ds_read_b64_tr_b16 v[90:91], v24 offset:14336
    v_mfma_f32_16x16x32_bf16 v[120:123], v[68:71], a[88:91], v[120:123]
    ds_read_b64_tr_b16 v[92:93], v25 offset:12288
    v_mfma_f32_16x16x32_bf16 v[124:127], v[68:71], a[92:95], v[124:127]
    ds_read_b64_tr_b16 v[94:95], v25 offset:14336
    s_add_u32 m0, s25, 8192
    s_add_u32 s30, s32, s87
    v_mfma_f32_16x16x32_bf16 v[128:131], v[72:75], a[80:83], v[128:131]
    ds_read_b128 a[96:99], v28 offset:24576
    buffer_load_dwordx4 v16, s[12:15], s30 offen lds
    v_mfma_f32_16x16x32_bf16 v[132:135], v[72:75], a[84:87], v[132:135]
    ds_read_b128 a[100:103], v28 offset:25600
    v_mfma_f32_16x16x32_bf16 v[136:139], v[72:75], a[88:91], v[136:139]
    ds_read_b128 a[104:107], v28 offset:26624
    buffer_load_dwordx4 v17, s[12:15], s30 offen offset:1024 lds
    v_mfma_f32_16x16x32_bf16 v[140:143], v[72:75], a[92:95], v[140:143]
    ds_read_b128 a[108:111], v28 offset:27648
    buffer_load_dwordx4 v18, s[12:15], s30 offen offset:2048 lds
    v_mfma_f32_16x16x32_bf16 v[144:147], v[76:79], a[80:83], v[144:147]
    v_mfma_f32_16x16x32_bf16 v[148:151], v[76:79], a[84:87], v[148:151]
    buffer_load_dwordx4 v19, s[12:15], s30 offen offset:3072 lds
    v_mfma_f32_16x16x32_bf16 v[152:155], v[76:79], a[88:91], v[152:155]
    v_mfma_f32_16x16x32_bf16 v[156:159], v[76:79], a[92:95], v[156:159]
    v_lshlrev_b32 v61, 6, v1
    v_min_u32 v61, 192, v61
    buffer_load_dword v62, v61, s[56:59], 0 offen sc1
    s_waitcnt vmcnt(9) lgkmcnt(0)
    v_mfma_f32_16x16x32_bf16 v[96:99], v[80:83], a[96:99], v[96:99]
    ds_read_b64_tr_b16 v[64:65], v22 offset:0
    v_mfma_f32_16x16x32_bf16 v[100:103], v[80:83], a[100:103], v[100:103]
    ds_read_b64_tr_b16 v[66:67], v22 offset:2048
    v_mfma_f32_16x16x32_bf16 v[104:107], v[80:83], a[104:107], v[104:107]
    ds_read_b64_tr_b16 v[68:69], v23 offset:0
    v_mfma_f32_16x16x32_bf16 v[108:111], v[80:83], a[108:111], v[108:111]
    ds_read_b64_tr_b16 v[70:71], v23 offset:2048
    v_mfma_f32_16x16x32_bf16 v[112:115], v[84:87], a[96:99], v[112:115]
    ds_read_b64_tr_b16 v[72:73], v24 offset:0
    v_mfma_f32_16x16x32_bf16 v[116:119], v[84:87], a[100:103], v[116:119]
    ds_read_b64_tr_b16 v[74:75], v24 offset:2048
    v_mfma_f32_16x16x32_bf16 v[120:123], v[84:87], a[104:107], v[120:123]
    ds_read_b64_tr_b16 v[76:77], v25 offset:0
    v_mfma_f32_16x16x32_bf16 v[124:127], v[84:87], a[108:111], v[124:127]
    ds_read_b64_tr_b16 v[78:79], v25 offset:2048
    s_add_u32 m0, s25, 12288
    s_add_u32 s30, s32, s88
    v_mfma_f32_16x16x32_bf16 v[128:131], v[88:91], a[96:99], v[128:131]
    ds_read_b128 a[112:115], v28 offset:28672
    buffer_load_dwordx4 v16, s[12:15], s30 offen lds
    v_mfma_f32_16x16x32_bf16 v[132:135], v[88:91], a[100:103], v[132:135]
    ds_read_b128 a[116:119], v28 offset:29696
    v_mfma_f32_16x16x32_bf16 v[136:139], v[88:91], a[104:107], v[136:139]
    ds_read_b128 a[120:123], v28 offset:30720
    buffer_load_dwordx4 v17, s[12:15], s30 offen offset:1024 lds
    v_mfma_f32_16x16x32_bf16 v[140:143], v[88:91], a[108:111], v[140:143]
    ds_read_b128 a[124:127], v28 offset:31744
    buffer_load_dwordx4 v18, s[12:15], s30 offen offset:2048 lds
    v_mfma_f32_16x16x32_bf16 v[144:147], v[92:95], a[96:99], v[144:147]
    v_mfma_f32_16x16x32_bf16 v[148:151], v[92:95], a[100:103], v[148:151]
    buffer_load_dwordx4 v19, s[12:15], s30 offen offset:3072 lds
    v_mfma_f32_16x16x32_bf16 v[152:155], v[92:95], a[104:107], v[152:155]
    v_mfma_f32_16x16x32_bf16 v[156:159], v[92:95], a[108:111], v[156:159]
    s_waitcnt vmcnt(9) lgkmcnt(0)
    v_mfma_f32_16x16x32_bf16 v[96:99], v[64:67], a[112:115], v[96:99]
    ds_read_b64_tr_b16 v[80:81], v22 offset:4096
    v_mfma_f32_16x16x32_bf16 v[100:103], v[64:67], a[116:119], v[100:103]
    ds_read_b64_tr_b16 v[82:83], v22 offset:6144
    v_mfma_f32_16x16x32_bf16 v[104:107], v[64:67], a[120:123], v[104:107]
    ds_read_b64_tr_b16 v[84:85], v23 offset:4096
    v_mfma_f32_16x16x32_bf16 v[108:111], v[64:67], a[124:127], v[108:111]
    ds_read_b64_tr_b16 v[86:87], v23 offset:6144
    v_mfma_f32_16x16x32_bf16 v[112:115], v[68:71], a[112:115], v[112:115]
    ds_read_b64_tr_b16 v[88:89], v24 offset:4096
    v_mfma_f32_16x16x32_bf16 v[116:119], v[68:71], a[116:119], v[116:119]
    ds_read_b64_tr_b16 v[90:91], v24 offset:6144
    v_mfma_f32_16x16x32_bf16 v[120:123], v[68:71], a[120:123], v[120:123]
    ds_read_b64_tr_b16 v[92:93], v25 offset:4096
    v_mfma_f32_16x16x32_bf16 v[124:127], v[68:71], a[124:127], v[124:127]
    ds_read_b64_tr_b16 v[94:95], v25 offset:6144
    s_add_u32 m0, s25, 0
    s_add_u32 s30, s32, s89
    v_mfma_f32_16x16x32_bf16 v[128:131], v[72:75], a[112:115], v[128:131]
    ds_read_b128 a[128:131], v28 offset:32768
    buffer_load_dwordx4 v16, s[12:15], s30 offen lds
    v_mfma_f32_16x16x32_bf16 v[132:135], v[72:75], a[116:119], v[132:135]
    ds_read_b128 a[132:135], v28 offset:33792
    v_mfma_f32_16x16x32_bf16 v[136:139], v[72:75], a[120:123], v[136:139]
    ds_read_b128 a[136:139], v28 offset:34816
    buffer_load_dwordx4 v17, s[12:15], s30 offen offset:1024 lds
    v_mfma_f32_16x16x32_bf16 v[140:143], v[72:75], a[124:127], v[140:143]
    ds_read_b128 a[140:143], v28 offset:35840
    buffer_load_dwordx4 v18, s[12:15], s30 offen offset:2048 lds
    v_mfma_f32_16x16x32_bf16 v[144:147], v[76:79], a[112:115], v[144:147]
    v_mfma_f32_16x16x32_bf16 v[148:151], v[76:79], a[116:119], v[148:151]
    buffer_load_dwordx4 v19, s[12:15], s30 offen offset:3072 lds
    v_mfma_f32_16x16x32_bf16 v[152:155], v[76:79], a[120:123], v[152:155]
    v_mfma_f32_16x16x32_bf16 v[156:159], v[76:79], a[124:127], v[156:159]
    s_waitcnt vmcnt(9) lgkmcnt(0)
    v_mfma_f32_16x16x32_bf16 v[96:99], v[80:83], a[128:131], v[96:99]
    ds_read_b64_tr_b16 v[64:65], v22 offset:8192
    v_mfma_f32_16x16x32_bf16 v[100:103], v[80:83], a[132:135], v[100:103]
    ds_read_b64_tr_b16 v[66:67], v22 offset:10240
    v_mfma_f32_16x16x32_bf16 v[104:107], v[80:83], a[136:139], v[104:107]
    ds_read_b64_tr_b16 v[68:69], v23 offset:8192
    v_mfma_f32_16x16x32_bf16 v[108:111], v[80:83], a[140:143], v[108:111]
    ds_read_b64_tr_b16 v[70:71], v23 offset:10240
    v_mfma_f32_16x16x32_bf16 v[112:115], v[84:87], a[128:131], v[112:115]
    ds_read_b64_tr_b16 v[72:73], v24 offset:8192
    v_mfma_f32_16x16x32_bf16 v[116:119], v[84:87], a[132:135], v[116:119]
    ds_read_b64_tr_b16 v[74:75], v24 offset:10240
    v_mfma_f32_16x16x32_bf16 v[120:123], v[84:87], a[136:139], v[120:123]
    ds_read_b64_tr_b16 v[76:77], v25 offset:8192
    v_mfma_f32_16x16x32_bf16 v[124:127], v[84:87], a[140:143], v[124:127]
    ds_read_b64_tr_b16 v[78:79], v25 offset:10240
    s_add_u32 m0, s25, 4096
    s_add_u32 s30, s32, s90
    v_mfma_f32_16x16x32_bf16 v[128:131], v[88:91], a[128:131], v[128:131]
    ds_read_b128 a[144:147], v28 offset:36864
    buffer_load_dwordx4 v16, s[12:15], s30 offen lds
    v_mfma_f32_16x16x32_bf16 v[132:135], v[88:91], a[132:135], v[132:135]
    ds_read_b128 a[148:151], v28 offset:37888
    v_mfma_f32_16x16x32_bf16 v[136:139], v[88:91], a[136:139], v[136:139]
    ds_read_b128 a[152:155], v28 offset:38912
    buffer_load_dwordx4 v17, s[12:15], s30 offen offset:1024 lds
    v_mfma_f32_16x16x32_bf16 v[140:143], v[88:91], a[140:143], v[140:143]
    ds_read_b128 a[156:159], v28 offset:39936
    buffer_load_dwordx4 v18, s[12:15], s30 offen offset:2048 lds
    v_mfma_f32_16x16x32_bf16 v[144:147], v[92:95], a[128:131], v[144:147]
    v_mfma_f32_16x16x32_bf16 v[148:151], v[92:95], a[132:135], v[148:151]
    buffer_load_dwordx4 v19, s[12:15], s30 offen offset:3072 lds
    v_mfma_f32_16x16x32_bf16 v[152:155], v[92:95], a[136:139], v[152:155]
    v_mfma_f32_16x16x32_bf16 v[156:159], v[92:95], a[140:143], v[156:159]
    s_waitcnt vmcnt(8) lgkmcnt(0)
    v_mfma_f32_16x16x32_bf16 v[96:99], v[64:67], a[144:147], v[96:99]
    ds_read_b64_tr_b16 v[80:81], v22 offset:12288
    v_mfma_f32_16x16x32_bf16 v[100:103], v[64:67], a[148:151], v[100:103]
    ds_read_b64_tr_b16 v[82:83], v22 offset:14336
    v_mfma_f32_16x16x32_bf16 v[104:107], v[64:67], a[152:155], v[104:107]
    ds_read_b64_tr_b16 v[84:85], v23 offset:12288
    v_mfma_f32_16x16x32_bf16 v[108:111], v[64:67], a[156:159], v[108:111]
    ds_read_b64_tr_b16 v[86:87], v23 offset:14336
    v_mfma_f32_16x16x32_bf16 v[112:115], v[68:71], a[144:147], v[112:115]
    ds_read_b64_tr_b16 v[88:89], v24 offset:12288
    v_mfma_f32_16x16x32_bf16 v[116:119], v[68:71], a[148:151], v[116:119]
    ds_read_b64_tr_b16 v[90:91], v24 offset:14336
    v_mfma_f32_16x16x32_bf16 v[120:123], v[68:71], a[152:155], v[120:123]
    ds_read_b64_tr_b16 v[92:93], v25 offset:12288
    v_mfma_f32_16x16x32_bf16 v[124:127], v[68:71], a[156:159], v[124:127]
    ds_read_b64_tr_b16 v[94:95], v25 offset:14336
    s_add_u32 m0, s25, 8192
    s_add_u32 s30, s32, s91
    v_mfma_f32_16x16x32_bf16 v[128:131], v[72:75], a[144:147], v[128:131]
    ds_read_b128 a[160:163], v28 offset:40960
    buffer_load_dwordx4 v16, s[12:15], s30 offen lds
    v_mfma_f32_16x16x32_bf16 v[132:135], v[72:75], a[148:151], v[132:135]
    ds_read_b128 a[164:167], v28 offset:41984
    v_mfma_f32_16x16x32_bf16 v[136:139], v[72:75], a[152:155], v[136:139]
    ds_read_b128 a[168:171], v28 offset:43008
    buffer_load_dwordx4 v17, s[12:15], s30 offen offset:1024 lds
    v_mfma_f32_16x16x32_bf16 v[140:143], v[72:75], a[156:159], v[140:143]
    ds_read_b128 a[172:175], v28 offset:44032
    buffer_load_dwordx4 v18, s[12:15], s30 offen offset:2048 lds
    v_mfma_f32_16x16x32_bf16 v[144:147], v[76:79], a[144:147], v[144:147]
    v_mfma_f32_16x16x32_bf16 v[148:151], v[76:79], a[148:151], v[148:151]
    buffer_load_dwordx4 v19, s[12:15], s30 offen offset:3072 lds
    v_mfma_f32_16x16x32_bf16 v[152:155], v[76:79], a[152:155], v[152:155]
    v_mfma_f32_16x16x32_bf16 v[156:159], v[76:79], a[156:159], v[156:159]
    s_waitcnt vmcnt(8) lgkmcnt(0)
    v_mfma_f32_16x16x32_bf16 v[96:99], v[80:83], a[160:163], v[96:99]
    ds_read_b64_tr_b16 v[64:65], v22 offset:0
    v_mfma_f32_16x16x32_bf16 v[100:103], v[80:83], a[164:167], v[100:103]
    ds_read_b64_tr_b16 v[66:67], v22 offset:2048
    v_mfma_f32_16x16x32_bf16 v[104:107], v[80:83], a[168:171], v[104:107]
    ds_read_b64_tr_b16 v[68:69], v23 offset:0
    v_mfma_f32_16x16x32_bf16 v[108:111], v[80:83], a[172:175], v[108:111]
    ds_read_b64_tr_b16 v[70:71], v23 offset:2048
    v_mfma_f32_16x16x32_bf16 v[112:115], v[84:87], a[160:163], v[112:115]
    ds_read_b64_tr_b16 v[72:73], v24 offset:0
    v_mfma_f32_16x16x32_bf16 v[116:119], v[84:87], a[164:167], v[116:119]
    ds_read_b64_tr_b16 v[74:75], v24 offset:2048
    v_mfma_f32_16x16x32_bf16 v[120:123], v[84:87], a[168:171], v[120:123]
    ds_read_b64_tr_b16 v[76:77], v25 offset:0
    v_mfma_f32_16x16x32_bf16 v[124:127], v[84:87], a[172:175], v[124:127]
    ds_read_b64_tr_b16 v[78:79], v25 offset:2048
    s_add_u32 m0, s25, 12288
    s_add_u32 s30, s32, s92
    v_mfma_f32_16x16x32_bf16 v[128:131], v[88:91], a[160:163], v[128:131]
    ds_read_b128 a[176:179], v28 offset:45056
    buffer_load_dwordx4 v16, s[12:15], s30 offen lds
    v_mfma_f32_16x16x32_bf16 v[132:135], v[88:91], a[164:167], v[132:135]
    ds_read_b128 a[180:183], v28 offset:46080
    v_mfma_f32_16x16x32_bf16 v[136:139], v[88:91], a[168:171], v[136:139]
    ds_read_b128 a[184:187], v28 offset:47104
    buffer_load_dwordx4 v17, s[12:15], s30 offen offset:1024 lds
    v_mfma_f32_16x16x32_bf16 v[140:143], v[88:91], a[172:175], v[140:143]
    ds_read_b128 a[188:191], v28 offset:48128
    buffer_load_dwordx4 v18, s[12:15], s30 offen offset:2048 lds
    v_mfma_f32_16x16x32_bf16 v[144:147], v[92:95], a[160:163], v[144:147]
    v_mfma_f32_16x16x32_bf16 v[148:151], v[92:95], a[164:167], v[148:151]
    buffer_load_dwordx4 v19, s[12:15], s30 offen offset:3072 lds
    v_mfma_f32_16x16x32_bf16 v[152:155], v[92:95], a[168:171], v[152:155]
    v_mfma_f32_16x16x32_bf16 v[156:159], v[92:95], a[172:175], v[156:159]
    s_waitcnt vmcnt(8) lgkmcnt(0)
    v_mfma_f32_16x16x32_bf16 v[96:99], v[64:67], a[176:179], v[96:99]
    ds_read_b64_tr_b16 v[80:81], v22 offset:4096
    v_mfma_f32_16x16x32_bf16 v[100:103], v[64:67], a[180:183], v[100:103]
    ds_read_b64_tr_b16 v[82:83], v22 offset:6144
    v_mfma_f32_16x16x32_bf16 v[104:107], v[64:67], a[184:187], v[104:107]
    ds_read_b64_tr_b16 v[84:85], v23 offset:4096
    v_mfma_f32_16x16x32_bf16 v[108:111], v[64:67], a[188:191], v[108:111]
    ds_read_b64_tr_b16 v[86:87], v23 offset:6144
    v_mfma_f32_16x16x32_bf16 v[112:115], v[68:71], a[176:179], v[112:115]
    ds_read_b64_tr_b16 v[88:89], v24 offset:4096
    v_mfma_f32_16x16x32_bf16 v[116:119], v[68:71], a[180:183], v[116:119]
    ds_read_b64_tr_b16 v[90:91], v24 offset:6144
    v_mfma_f32_16x16x32_bf16 v[120:123], v[68:71], a[184:187], v[120:123]
    ds_read_b64_tr_b16 v[92:93], v25 offset:4096
    v_mfma_f32_16x16x32_bf16 v[124:127], v[68:71], a[188:191], v[124:127]
    ds_read_b64_tr_b16 v[94:95], v25 offset:6144
    s_add_u32 m0, s25, 0
    s_add_u32 s30, s32, s93
    v_mfma_f32_16x16x32_bf16 v[128:131], v[72:75], a[176:179], v[128:131]
    ds_read_b128 a[192:195], v28 offset:49152
    buffer_load_dwordx4 v16, s[12:15], s30 offen lds
    v_mfma_f32_16x16x32_bf16 v[132:135], v[72:75], a[180:183], v[132:135]
    ds_read_b128 a[196:199], v28 offset:50176
    v_mfma_f32_16x16x32_bf16 v[136:139], v[72:75], a[184:187], v[136:139]
    ds_read_b128 a[200:203], v28 offset:51200
    buffer_load_dwordx4 v17, s[12:15], s30 offen offset:1024 lds
    v_mfma_f32_16x16x32_bf16 v[140:143], v[72:75], a[188:191], v[140:143]
    ds_read_b128 a[204:207], v28 offset:52224
    buffer_load_dwordx4 v18, s[12:15], s30 offen offset:2048 lds
    v_mfma_f32_16x16x32_bf16 v[144:147], v[76:79], a[176:179], v[144:147]
    v_mfma_f32_16x16x32_bf16 v[148:151], v[76:79], a[180:183], v[148:151]
    buffer_load_dwordx4 v19, s[12:15], s30 offen offset:3072 lds
    v_mfma_f32_16x16x32_bf16 v[152:155], v[76:79], a[184:187], v[152:155]
    v_mfma_f32_16x16x32_bf16 v[156:159], v[76:79], a[188:191], v[156:159]
    s_waitcnt vmcnt(8) lgkmcnt(0)
    v_mfma_f32_16x16x32_bf16 v[96:99], v[80:83], a[192:195], v[96:99]
    ds_read_b64_tr_b16 v[64:65], v22 offset:8192
    v_mfma_f32_16x16x32_bf16 v[100:103], v[80:83], a[196:199], v[100:103]
    ds_read_b64_tr_b16 v[66:67], v22 offset:10240
    v_mfma_f32_16x16x32_bf16 v[104:107], v[80:83], a[200:203], v[104:107]
    ds_read_b64_tr_b16 v[68:69], v23 offset:8192
    v_mfma_f32_16x16x32_bf16 v[108:111], v[80:83], a[204:207], v[108:111]
    ds_read_b64_tr_b16 v[70:71], v23 offset:10240
    v_mfma_f32_16x16x32_bf16 v[112:115], v[84:87], a[192:195], v[112:115]
    ds_read_b64_tr_b16 v[72:73], v24 offset:8192
    v_mfma_f32_16x16x32_bf16 v[116:119], v[84:87], a[196:199], v[116:119]
    ds_read_b64_tr_b16 v[74:75], v24 offset:10240
    v_mfma_f32_16x16x32_bf16 v[120:123], v[84:87], a[200:203], v[120:123]
    ds_read_b64_tr_b16 v[76:77], v25 offset:8192
    v_mfma_f32_16x16x32_bf16 v[124:127], v[84:87], a[204:207], v[124:127]
    ds_read_b64_tr_b16 v[78:79], v25 offset:10240
    s_add_u32 m0, s25, 4096
    s_add_u32 s30, s32, s94
    v_mfma_f32_16x16x32_bf16 v[128:131], v[88:91], a[192:195], v[128:131]
    ds_read_b128 a[208:211], v28 offset:53248
    buffer_load_dwordx4 v16, s[12:15], s30 offen lds
    v_mfma_f32_16x16x32_bf16 v[132:135], v[88:91], a[196:199], v[132:135]
    ds_read_b128 a[212:215], v28 offset:54272
    v_mfma_f32_16x16x32_bf16 v[136:139], v[88:91], a[200:203], v[136:139]
    ds_read_b128 a[216:219], v28 offset:55296
    buffer_load_dwordx4 v17, s[12:15], s30 offen offset:1024 lds
    v_mfma_f32_16x16x32_bf16 v[140:143], v[88:91], a[204:207], v[140:143]
    ds_read_b128 a[220:223], v28 offset:56320
    buffer_load_dwordx4 v18, s[12:15], s30 offen offset:2048 lds
    v_mfma_f32_16x16x32_bf16 v[144:147], v[92:95], a[192:195], v[144:147]
    v_mfma_f32_16x16x32_bf16 v[148:151], v[92:95], a[196:199], v[148:151]
    buffer_load_dwordx4 v19, s[12:15], s30 offen offset:3072 lds
    v_mfma_f32_16x16x32_bf16 v[152:155], v[92:95], a[200:203], v[152:155]
    v_mfma_f32_16x16x32_bf16 v[156:159], v[92:95], a[204:207], v[156:159]
    s_waitcnt vmcnt(8) lgkmcnt(0)
    v_mfma_f32_16x16x32_bf16 v[96:99], v[64:67], a[208:211], v[96:99]
    ds_read_b64_tr_b16 v[80:81], v22 offset:12288
    v_mfma_f32_16x16x32_bf16 v[100:103], v[64:67], a[212:215], v[100:103]
    ds_read_b64_tr_b16 v[82:83], v22 offset:14336
    v_mfma_f32_16x16x32_bf16 v[104:107], v[64:67], a[216:219], v[104:107]
    ds_read_b64_tr_b16 v[84:85], v23 offset:12288
    v_mfma_f32_16x16x32_bf16 v[108:111], v[64:67], a[220:223], v[108:111]
    ds_read_b64_tr_b16 v[86:87], v23 offset:14336
    v_mfma_f32_16x16x32_bf16 v[112:115], v[68:71], a[208:211], v[112:115]
    ds_read_b64_tr_b16 v[88:89], v24 offset:12288
    v_mfma_f32_16x16x32_bf16 v[116:119], v[68:71], a[212:215], v[116:119]
    ds_read_b64_tr_b16 v[90:91], v24 offset:14336
    v_mfma_f32_16x16x32_bf16 v[120:123], v[68:71], a[216:219], v[120:123]
    ds_read_b64_tr_b16 v[92:93], v25 offset:12288
    v_mfma_f32_16x16x32_bf16 v[124:127], v[68:71], a[220:223], v[124:127]
    ds_read_b64_tr_b16 v[94:95], v25 offset:14336
    s_add_u32 m0, s25, 8192
    s_add_u32 s30, s32, s95
    v_mfma_f32_16x16x32_bf16 v[128:131], v[72:75], a[208:211], v[128:131]
    ds_read_b128 a[224:227], v28 offset:57344
    buffer_load_dwordx4 v16, s[12:15], s30 offen lds
    v_mfma_f32_16x16x32_bf16 v[132:135], v[72:75], a[212:215], v[132:135]
    ds_read_b128 a[228:231], v28 offset:58368
    v_mfma_f32_16x16x32_bf16 v[136:139], v[72:75], a[216:219], v[136:139]
    ds_read_b128 a[232:235], v28 offset:59392
    buffer_load_dwordx4 v17, s[12:15], s30 offen offset:1024 lds
    v_mfma_f32_16x16x32_bf16 v[140:143], v[72:75], a[220:223], v[140:143]
    ds_read_b128 a[236:239], v28 offset:60416
    buffer_load_dwordx4 v18, s[12:15], s30 offen offset:2048 lds
    v_mfma_f32_16x16x32_bf16 v[144:147], v[76:79], a[208:211], v[144:147]
    v_mfma_f32_16x16x32_bf16 v[148:151], v[76:79], a[212:215], v[148:151]
    buffer_load_dwordx4 v19, s[12:15], s30 offen offset:3072 lds
    v_mfma_f32_16x16x32_bf16 v[152:155], v[76:79], a[216:219], v[152:155]
    v_mfma_f32_16x16x32_bf16 v[156:159], v[76:79], a[220:223], v[156:159]
    s_waitcnt vmcnt(8) lgkmcnt(0)
    v_mfma_f32_16x16x32_bf16 v[96:99], v[80:83], a[224:227], v[96:99]
    ds_read_b64_tr_b16 v[64:65], v22 offset:0
    v_mfma_f32_16x16x32_bf16 v[100:103], v[80:83], a[228:231], v[100:103]
    ds_read_b64_tr_b16 v[66:67], v22 offset:2048
    v_mfma_f32_16x16x32_bf16 v[104:107], v[80:83], a[232:235], v[104:107]
    ds_read_b64_tr_b16 v[68:69], v23 offset:0
    v_mfma_f32_16x16x32_bf16 v[108:111], v[80:83], a[236:239], v[108:111]
    ds_read_b64_tr_b16 v[70:71], v23 offset:2048
    v_mfma_f32_16x16x32_bf16 v[112:115], v[84:87], a[224:227], v[112:115]
    ds_read_b64_tr_b16 v[72:73], v24 offset:0
    v_mfma_f32_16x16x32_bf16 v[116:119], v[84:87], a[228:231], v[116:119]
    ds_read_b64_tr_b16 v[74:75], v24 offset:2048
    v_mfma_f32_16x16x32_bf16 v[120:123], v[84:87], a[232:235], v[120:123]
    ds_read_b64_tr_b16 v[76:77], v25 offset:0
    v_mfma_f32_16x16x32_bf16 v[124:127], v[84:87], a[236:239], v[124:127]
    ds_read_b64_tr_b16 v[78:79], v25 offset:2048
    s_add_u32 m0, s25, 12288
    s_cmp_eq_u32 s24, 0
    s_cselect_b32 s30, s78, s87
    s_add_u32 s30, s30, s31
    v_mfma_f32_16x16x32_bf16 v[128:131], v[88:91], a[224:227], v[128:131]
    ds_read_b128 a[240:243], v28 offset:61440
    buffer_load_dwordx4 v20, s[12:15], s30 offen lds
    v_mfma_f32_16x16x32_bf16 v[132:135], v[88:91], a[228:231], v[132:135]
    ds_read_b128 a[244:247], v28 offset:62464
    buffer_load_dwordx4 v21, s[12:15], s30 offen offset:1024 lds
    v_mfma_f32_16x16x32_bf16 v[136:139], v[88:91], a[232:235], v[136:139]
    ds_read_b128 a[248:251], v28 offset:63488
    v_mfma_f32_16x16x32_bf16 v[140:143], v[88:91], a[236:239], v[140:143]
    ds_read_b128 a[252:255], v28 offset:64512
    s_add_u32 m0, s25, 14336
    s_cmp_eq_u32 s24, 0
    s_cselect_b32 s30, s79, s88
    s_add_u32 s30, s30, s31
    v_mfma_f32_16x16x32_bf16 v[144:147], v[92:95], a[224:227], v[144:147]
    buffer_load_dwordx4 v20, s[12:15], s30 offen lds
    v_mfma_f32_16x16x32_bf16 v[148:151], v[92:95], a[228:231], v[148:151]
    buffer_load_dwordx4 v21, s[12:15], s30 offen offset:1024 lds
    v_mfma_f32_16x16x32_bf16 v[152:155], v[92:95], a[232:235], v[152:155]
    v_mfma_f32_16x16x32_bf16 v[156:159], v[92:95], a[236:239], v[156:159]
    s_waitcnt vmcnt(8) lgkmcnt(0)
    v_mfma_f32_16x16x32_bf16 v[96:99], v[64:67], a[240:243], v[96:99]
    ds_read_b64_tr_b16 v[80:81], v22 offset:4096
    v_mfma_f32_16x16x32_bf16 v[100:103], v[64:67], a[244:247], v[100:103]
    ds_read_b64_tr_b16 v[82:83], v22 offset:6144
    v_mfma_f32_16x16x32_bf16 v[104:107], v[64:67], a[248:251], v[104:107]
    ds_read_b64_tr_b16 v[84:85], v23 offset:4096
    v_mfma_f32_16x16x32_bf16 v[108:111], v[64:67], a[252:255], v[108:111]
    ds_read_b64_tr_b16 v[86:87], v23 offset:6144
    v_mfma_f32_16x16x32_bf16 v[112:115], v[68:71], a[240:243], v[112:115]
    ds_read_b64_tr_b16 v[88:89], v24 offset:4096
    v_mfma_f32_16x16x32_bf16 v[116:119], v[68:71], a[244:247], v[116:119]
    ds_read_b64_tr_b16 v[90:91], v24 offset:6144
    v_mfma_f32_16x16x32_bf16 v[120:123], v[68:71], a[248:251], v[120:123]
    ds_read_b64_tr_b16 v[92:93], v25 offset:4096
    v_mfma_f32_16x16x32_bf16 v[124:127], v[68:71], a[252:255], v[124:127]
    ds_read_b64_tr_b16 v[94:95], v25 offset:6144
    s_add_u32 m0, s25, 0
    s_cmp_eq_u32 s24, 0
    s_cselect_b32 s30, s80, s89
    s_add_u32 s30, s30, s31
    v_mfma_f32_16x16x32_bf16 v[128:131], v[72:75], a[240:243], v[128:131]
    ds_read_b128 v[224:227], v29 offset:0
    buffer_load_dwordx4 v20, s[12:15], s30 offen lds
    v_mfma_f32_16x16x32_bf16 v[132:135], v[72:75], a[244:247], v[132:135]
    ds_read_b128 v[228:231], v29 offset:1024
    buffer_load_dwordx4 v21, s[12:15], s30 offen offset:1024 lds
    v_mfma_f32_16x16x32_bf16 v[136:139], v[72:75], a[248:251], v[136:139]
    ds_read_b128 v[232:235], v29 offset:2048
    v_mfma_f32_16x16x32_bf16 v[140:143], v[72:75], a[252:255], v[140:143]
    ds_read_b128 v[236:239], v29 offset:3072
    s_add_u32 m0, s25, 2048
    s_cmp_eq_u32 s24, 0
    s_cselect_b32 s30, s81, s90
    s_add_u32 s30, s30, s31
    v_mfma_f32_16x16x32_bf16 v[144:147], v[76:79], a[240:243], v[144:147]
    buffer_load_dwordx4 v20, s[12:15], s30 offen lds
    v_mfma_f32_16x16x32_bf16 v[148:151], v[76:79], a[244:247], v[148:151]
    buffer_load_dwordx4 v21, s[12:15], s30 offen offset:1024 lds
    v_mfma_f32_16x16x32_bf16 v[152:155], v[76:79], a[248:251], v[152:155]
    v_mfma_f32_16x16x32_bf16 v[156:159], v[76:79], a[252:255], v[156:159]
    s_waitcnt vmcnt(8) lgkmcnt(0)
    v_mfma_f32_16x16x32_bf16 v[96:99], v[80:83], v[224:227], v[96:99]
    ds_read_b64_tr_b16 v[64:65], v22 offset:8192
    v_mfma_f32_16x16x32_bf16 v[100:103], v[80:83], v[228:231], v[100:103]
    ds_read_b64_tr_b16 v[66:67], v22 offset:10240
    v_mfma_f32_16x16x32_bf16 v[104:107], v[80:83], v[232:235], v[104:107]
    ds_read_b64_tr_b16 v[68:69], v23 offset:8192
    v_mfma_f32_16x16x32_bf16 v[108:111], v[80:83], v[236:239], v[108:111]
    ds_read_b64_tr_b16 v[70:71], v23 offset:10240
    v_mfma_f32_16x16x32_bf16 v[112:115], v[84:87], v[224:227], v[112:115]
    ds_read_b64_tr_b16 v[72:73], v24 offset:8192
    v_mfma_f32_16x16x32_bf16 v[116:119], v[84:87], v[228:231], v[116:119]
    ds_read_b64_tr_b16 v[74:75], v24 offset:10240
    v_mfma_f32_16x16x32_bf16 v[120:123], v[84:87], v[232:235], v[120:123]
    ds_read_b64_tr_b16 v[76:77], v25 offset:8192
    v_mfma_f32_16x16x32_bf16 v[124:127], v[84:87], v[236:239], v[124:127]
    ds_read_b64_tr_b16 v[78:79], v25 offset:10240
    s_add_u32 m0, s25, 4096
    s_cmp_eq_u32 s24, 0
    s_cselect_b32 s30, s82, s91
    s_add_u32 s30, s30, s31
    v_mfma_f32_16x16x32_bf16 v[128:131], v[88:91], v[224:227], v[128:131]
    ds_read_b128 v[240:243], v29 offset:4096
    buffer_load_dwordx4 v20, s[12:15], s30 offen lds
    v_mfma_f32_16x16x32_bf16 v[132:135], v[88:91], v[228:231], v[132:135]
    ds_read_b128 v[244:247], v29 offset:5120
    buffer_load_dwordx4 v21, s[12:15], s30 offen offset:1024 lds
    v_mfma_f32_16x16x32_bf16 v[136:139], v[88:91], v[232:235], v[136:139]
    ds_read_b128 v[248:251], v29 offset:6144
    v_mfma_f32_16x16x32_bf16 v[140:143], v[88:91], v[236:239], v[140:143]
    ds_read_b128 v[252:255], v29 offset:7168
    s_add_u32 m0, s25, 6144
    s_cmp_eq_u32 s24, 0
    s_cselect_b32 s30, s83, s92
    s_add_u32 s30, s30, s31
    v_mfma_f32_16x16x32_bf16 v[144:147], v[92:95], v[224:227], v[144:147]
    buffer_load_dwordx4 v20, s[12:15], s30 offen lds
    v_mfma_f32_16x16x32_bf16 v[148:151], v[92:95], v[228:231], v[148:151]
    buffer_load_dwordx4 v21, s[12:15], s30 offen offset:1024 lds
    v_mfma_f32_16x16x32_bf16 v[152:155], v[92:95], v[232:235], v[152:155]
    v_mfma_f32_16x16x32_bf16 v[156:159], v[92:95], v[236:239], v[156:159]
    s_waitcnt vmcnt(10) lgkmcnt(0)
    v_mfma_f32_16x16x32_bf16 v[96:99], v[64:67], v[240:243], v[96:99]
    ds_read_b64_tr_b16 v[80:81], v26 offset:12288
    v_mfma_f32_16x16x32_bf16 v[100:103], v[64:67], v[244:247], v[100:103]
    ds_read_b64_tr_b16 v[82:83], v26 offset:13312
    v_mfma_f32_16x16x32_bf16 v[104:107], v[64:67], v[248:251], v[104:107]
    ds_read_b64_tr_b16 v[84:85], v27 offset:12288
    v_mfma_f32_16x16x32_bf16 v[108:111], v[64:67], v[252:255], v[108:111]
    ds_read_b64_tr_b16 v[86:87], v27 offset:13312
    v_mfma_f32_16x16x32_bf16 v[112:115], v[68:71], v[240:243], v[112:115]
    v_mfma_f32_16x16x32_bf16 v[116:119], v[68:71], v[244:247], v[116:119]
    v_mfma_f32_16x16x32_bf16 v[120:123], v[68:71], v[248:251], v[120:123]
    v_mfma_f32_16x16x32_bf16 v[124:127], v[68:71], v[252:255], v[124:127]
    s_add_u32 m0, s25, 8192
    s_cmp_eq_u32 s24, 0
    s_cselect_b32 s30, s84, s93
    s_add_u32 s30, s30, s31
    v_mfma_f32_16x16x32_bf16 v[128:131], v[72:75], v[240:243], v[128:131]
    buffer_load_dwordx4 v20, s[12:15], s30 offen lds
    v_mfma_f32_16x16x32_bf16 v[132:135], v[72:75], v[244:247], v[132:135]
    buffer_load_dwordx4 v21, s[12:15], s30 offen offset:1024 lds
    v_mfma_f32_16x16x32_bf16 v[136:139], v[72:75], v[248:251], v[136:139]
    v_mfma_f32_16x16x32_bf16 v[140:143], v[72:75], v[252:255], v[140:143]
    s_add_u32 m0, s25, 10240
    s_cmp_eq_u32 s24, 0
    s_cselect_b32 s30, s85, s94
    s_add_u32 s30, s30, s31
    v_mfma_f32_16x16x32_bf16 v[144:147], v[76:79], v[240:243], v[144:147]
    buffer_load_dwordx4 v20, s[12:15], s30 offen lds
    v_mfma_f32_16x16x32_bf16 v[148:151], v[76:79], v[244:247], v[148:151]
    buffer_load_dwordx4 v21, s[12:15], s30 offen offset:1024 lds
    v_mfma_f32_16x16x32_bf16 v[152:155], v[76:79], v[248:251], v[152:155]
    v_mfma_f32_16x16x32_bf16 v[156:159], v[76:79], v[252:255], v[156:159]
    s_cmp_eq_u32 s24, 0
    s_cbranch_scc0 M_G2S_WK1
    s_waitcnt vmcnt(12) lgkmcnt(0)
    v_mfma_f32_16x16x32_bf16 v[160:163], v[80:83], a[0:3], 0
    ds_read_b64_tr_b16 v[64:65], v26 offset:14336
    v_mfma_f32_16x16x32_bf16 v[164:167], v[80:83], a[4:7], 0
    ds_read_b64_tr_b16 v[66:67], v26 offset:15360
    v_cvt_pk_bf16_f32 v192, v96, v97
    v_mfma_f32_16x16x32_bf16 v[168:171], v[80:83], a[8:11], 0
    ds_read_b64_tr_b16 v[68:69], v27 offset:14336
    v_mfma_f32_16x16x32_bf16 v[172:175], v[80:83], a[12:15], 0
    ds_read_b64_tr_b16 v[70:71], v27 offset:15360
    s_add_u32 m0, s25, 12288
    s_add_u32 s30, s31, s86
    v_cvt_pk_bf16_f32 v193, v98, v99
    v_mfma_f32_16x16x32_bf16 v[176:179], v[84:87], a[0:3], 0
    buffer_load_dwordx4 v20, s[12:15], s30 offen lds
    v_cvt_pk_bf16_f32 v194, v112, v113
    v_mfma_f32_16x16x32_bf16 v[180:183], v[84:87], a[4:7], 0
    buffer_load_dwordx4 v21, s[12:15], s30 offen offset:1024 lds
    v_mfma_f32_16x16x32_bf16 v[184:187], v[84:87], a[8:11], 0
    v_cvt_pk_bf16_f32 v195, v114, v115
    v_mfma_f32_16x16x32_bf16 v[188:191], v[84:87], a[12:15], 0
    v_cvt_pk_bf16_f32 v196, v100, v101
    s_waitcnt vmcnt(12) lgkmcnt(0)
    v_mfma_f32_16x16x32_bf16 v[160:163], v[64:67], a[16:19], v[160:163]
    ds_read_b64_tr_b16 v[80:81], v26 offset:0
    v_mfma_f32_16x16x32_bf16 v[164:167], v[64:67], a[20:23], v[164:167]
    ds_read_b64_tr_b16 v[82:83], v26 offset:1024
    v_cvt_pk_bf16_f32 v197, v102, v103
    v_mfma_f32_16x16x32_bf16 v[168:171], v[64:67], a[24:27], v[168:171]
    ds_read_b64_tr_b16 v[84:85], v27 offset:0
    v_mfma_f32_16x16x32_bf16 v[172:175], v[64:67], a[28:31], v[172:175]
    ds_read_b64_tr_b16 v[86:87], v27 offset:1024
    v_cvt_pk_bf16_f32 v198, v116, v117
    v_mfma_f32_16x16x32_bf16 v[176:179], v[68:71], a[16:19], v[176:179]
    v_cvt_pk_bf16_f32 v199, v118, v119
    v_mfma_f32_16x16x32_bf16 v[180:183], v[68:71], a[20:23], v[180:183]
    v_mfma_f32_16x16x32_bf16 v[184:187], v[68:71], a[24:27], v[184:187]
    v_cvt_pk_bf16_f32 v200, v104, v105
    v_mfma_f32_16x16x32_bf16 v[188:191], v[68:71], a[28:31], v[188:191]
    v_cvt_pk_bf16_f32 v201, v106, v107
    s_waitcnt vmcnt(10) lgkmcnt(0)
    v_mfma_f32_16x16x32_bf16 v[160:163], v[80:83], a[32:35], v[160:163]
    ds_read_b64_tr_b16 v[64:65], v26 offset:2048
    v_mfma_f32_16x16x32_bf16 v[164:167], v[80:83], a[36:39], v[164:167]
    ds_read_b64_tr_b16 v[66:67], v26 offset:3072
    v_cvt_pk_bf16_f32 v202, v120, v121
    v_mfma_f32_16x16x32_bf16 v[168:171], v[80:83], a[40:43], v[168:171]
    ds_read_b64_tr_b16 v[68:69], v27 offset:2048
    v_mfma_f32_16x16x32_bf16 v[172:175], v[80:83], a[44:47], v[172:175]
    ds_read_b64_tr_b16 v[70:71], v27 offset:3072
    v_cvt_pk_bf16_f32 v203, v122, v123
    v_mfma_f32_16x16x32_bf16 v[176:179], v[84:87], a[32:35], v[176:179]
    v_cvt_pk_bf16_f32 v204, v108, v109
    v_mfma_f32_16x16x32_bf16 v[180:183], v[84:87], a[36:39], v[180:183]
    v_mfma_f32_16x16x32_bf16 v[184:187], v[84:87], a[40:43], v[184:187]
    v_cvt_pk_bf16_f32 v205, v110, v111
    v_mfma_f32_16x16x32_bf16 v[188:191], v[84:87], a[44:47], v[188:191]
    v_cvt_pk_bf16_f32 v206, v124, v125
    s_waitcnt vmcnt(8) lgkmcnt(0)
    v_mfma_f32_16x16x32_bf16 v[160:163], v[64:67], a[48:51], v[160:163]
    ds_read_b64_tr_b16 v[80:81], v26 offset:4096
    v_mfma_f32_16x16x32_bf16 v[164:167], v[64:67], a[52:55], v[164:167]
    ds_read_b64_tr_b16 v[82:83], v26 offset:5120
    v_cvt_pk_bf16_f32 v207, v126, v127
    v_mfma_f32_16x16x32_bf16 v[168:171], v[64:67], a[56:59], v[168:171]
    ds_read_b64_tr_b16 v[84:85], v27 offset:4096
    v_mfma_f32_16x16x32_bf16 v[172:175], v[64:67], a[60:63], v[172:175]
    ds_read_b64_tr_b16 v[86:87], v27 offset:5120
    s_add_u32 m0, s25, 0
    s_add_u32 s30, s33, s78
    v_cvt_pk_bf16_f32 v208, v128, v129
    v_mfma_f32_16x16x32_bf16 v[176:179], v[68:71], a[48:51], v[176:179]
    buffer_load_dwordx4 v16, s[12:15], s30 offen lds
    v_cvt_pk_bf16_f32 v209, v130, v131
    v_mfma_f32_16x16x32_bf16 v[180:183], v[68:71], a[52:55], v[180:183]
    buffer_load_dwordx4 v17, s[12:15], s30 offen offset:1024 lds
    v_mfma_f32_16x16x32_bf16 v[184:187], v[68:71], a[56:59], v[184:187]
    v_cvt_pk_bf16_f32 v210, v144, v145
    v_mfma_f32_16x16x32_bf16 v[188:191], v[68:71], a[60:63], v[188:191]
    v_cvt_pk_bf16_f32 v211, v146, v147
    s_waitcnt vmcnt(8) lgkmcnt(0)
    v_mfma_f32_16x16x32_bf16 v[160:163], v[80:83], a[64:67], v[160:163]
    ds_read_b64_tr_b16 v[64:65], v26 offset:6144
    v_mfma_f32_16x16x32_bf16 v[164:167], v[80:83], a[68:71], v[164:167]
    ds_read_b64_tr_b16 v[66:67], v26 offset:7168
    v_cvt_pk_bf16_f32 v212, v132, v133
    v_mfma_f32_16x16x32_bf16 v[168:171], v[80:83], a[72:75], v[168:171]
    ds_read_b64_tr_b16 v[68:69], v27 offset:6144
    v_mfma_f32_16x16x32_bf16 v[172:175], v[80:83], a[76:79], v[172:175]
    ds_read_b64_tr_b16 v[70:71], v27 offset:7168
    buffer_load_dwordx4 v18, s[12:15], s30 offen offset:2048 lds
    v_cvt_pk_bf16_f32 v213, v134, v135
    v_mfma_f32_16x16x32_bf16 v[176:179], v[84:87], a[64:67], v[176:179]
    v_mfma_f32_16x16x32_bf16 v[180:183], v[84:87], a[68:71], v[180:183]
    buffer_load_dwordx4 v19, s[12:15], s30 offen offset:3072 lds
    v_cvt_pk_bf16_f32 v214, v148, v149
    v_mfma_f32_16x16x32_bf16 v[184:187], v[84:87], a[72:75], v[184:187]
    v_mfma_f32_16x16x32_bf16 v[188:191], v[84:87], a[76:79], v[188:191]
    v_cvt_pk_bf16_f32 v215, v150, v151
    s_waitcnt vmcnt(8) lgkmcnt(0)
    v_mfma_f32_16x16x32_bf16 v[160:163], v[64:67], a[80:83], v[160:163]
    ds_read_b64_tr_b16 v[80:81], v26 offset:8192
    v_mfma_f32_16x16x32_bf16 v[164:167], v[64:67], a[84:87], v[164:167]
    ds_read_b64_tr_b16 v[82:83], v26 offset:9216
    v_cvt_pk_bf16_f32 v216, v136, v137
    v_mfma_f32_16x16x32_bf16 v[168:171], v[64:67], a[88:91], v[168:171]
    ds_read_b64_tr_b16 v[84:85], v27 offset:8192
    v_mfma_f32_16x16x32_bf16 v[172:175], v[64:67], a[92:95], v[172:175]
    ds_read_b64_tr_b16 v[86:87], v27 offset:9216
    s_add_u32 m0, s25, 4096
    s_add_u32 s30, s33, s79
    v_cvt_pk_bf16_f32 v217, v138, v139
    v_mfma_f32_16x16x32_bf16 v[176:179], v[68:71], a[80:83], v[176:179]
    buffer_load_dwordx4 v16, s[12:15], s30 offen lds
    v_mfma_f32_16x16x32_bf16 v[180:183], v[68:71], a[84:87], v[180:183]
    buffer_load_dwordx4 v17, s[12:15], s30 offen offset:1024 lds
    v_cvt_pk_bf16_f32 v218, v152, v153
    v_mfma_f32_16x16x32_bf16 v[184:187], v[68:71], a[88:91], v[184:187]
    v_mfma_f32_16x16x32_bf16 v[188:191], v[68:71], a[92:95], v[188:191]
    v_cvt_pk_bf16_f32 v219, v154, v155
    s_waitcnt vmcnt(8) lgkmcnt(0)
    v_mfma_f32_16x16x32_bf16 v[160:163], v[80:83], a[96:99], v[160:163]
    ds_read_b64_tr_b16 v[64:65], v26 offset:10240
    v_mfma_f32_16x16x32_bf16 v[164:167], v[80:83], a[100:103], v[164:167]
    ds_read_b64_tr_b16 v[66:67], v26 offset:11264
    v_cvt_pk_bf16_f32 v220, v140, v141
    v_mfma_f32_16x16x32_bf16 v[168:171], v[80:83], a[104:107], v[168:171]
    ds_read_b64_tr_b16 v[68:69], v27 offset:10240
    v_mfma_f32_16x16x32_bf16 v[172:175], v[80:83], a[108:111], v[172:175]
    ds_read_b64_tr_b16 v[70:71], v27 offset:11264
    buffer_load_dwordx4 v18, s[12:15], s30 offen offset:2048 lds
    v_cvt_pk_bf16_f32 v221, v142, v143
    v_mfma_f32_16x16x32_bf16 v[176:179], v[84:87], a[96:99], v[176:179]
    v_mfma_f32_16x16x32_bf16 v[180:183], v[84:87], a[100:103], v[180:183]
    buffer_load_dwordx4 v19, s[12:15], s30 offen offset:3072 lds
    v_cvt_pk_bf16_f32 v222, v156, v157
    v_mfma_f32_16x16x32_bf16 v[184:187], v[84:87], a[104:107], v[184:187]
    v_mfma_f32_16x16x32_bf16 v[188:191], v[84:87], a[108:111], v[188:191]
    v_cvt_pk_bf16_f32 v223, v158, v159
    s_waitcnt vmcnt(8) lgkmcnt(0)
    v_mfma_f32_16x16x32_bf16 v[160:163], v[64:67], a[112:115], v[160:163]
    ds_read_b64_tr_b16 v[80:81], v26 offset:12288
    v_mfma_f32_16x16x32_bf16 v[164:167], v[64:67], a[116:119], v[164:167]
    ds_read_b64_tr_b16 v[82:83], v26 offset:13312
    v_mfma_f32_16x16x32_bf16 v[168:171], v[64:67], a[120:123], v[168:171]
    ds_read_b64_tr_b16 v[84:85], v27 offset:12288
    v_mfma_f32_16x16x32_bf16 v[172:175], v[64:67], a[124:127], v[172:175]
    ds_read_b64_tr_b16 v[86:87], v27 offset:13312
    s_add_u32 m0, s25, 8192
    s_add_u32 s30, s33, s80
    v_mfma_f32_16x16x32_bf16 v[176:179], v[68:71], a[112:115], v[176:179]
    buffer_load_dwordx4 v16, s[12:15], s30 offen lds
    v_mfma_f32_16x16x32_bf16 v[180:183], v[68:71], a[116:119], v[180:183]
    buffer_load_dwordx4 v17, s[12:15], s30 offen offset:1024 lds
    v_mfma_f32_16x16x32_bf16 v[184:187], v[68:71], a[120:123], v[184:187]
    v_mfma_f32_16x16x32_bf16 v[188:191], v[68:71], a[124:127], v[188:191]
    s_waitcnt vmcnt(6) lgkmcnt(0)
    v_mfma_f32_16x16x32_bf16 v[160:163], v[80:83], a[128:131], v[160:163]
    ds_read_b64_tr_b16 v[64:65], v22 offset:0
    v_mfma_f32_16x16x32_bf16 v[164:167], v[80:83], a[132:135], v[164:167]
    ds_read_b64_tr_b16 v[66:67], v22 offset:2048
    v_mfma_f32_16x16x32_bf16 v[168:171], v[80:83], a[136:139], v[168:171]
    ds_read_b64_tr_b16 v[68:69], v23 offset:0
    v_mfma_f32_16x16x32_bf16 v[172:175], v[80:83], a[140:143], v[172:175]
    ds_read_b64_tr_b16 v[70:71], v23 offset:2048
    buffer_load_dwordx4 v18, s[12:15], s30 offen offset:2048 lds
    v_mfma_f32_16x16x32_bf16 v[176:179], v[84:87], a[128:131], v[176:179]
    ds_read_b64_tr_b16 v[72:73], v24 offset:0
    v_mfma_f32_16x16x32_bf16 v[180:183], v[84:87], a[132:135], v[180:183]
    ds_read_b64_tr_b16 v[74:75], v24 offset:2048
    buffer_load_dwordx4 v19, s[12:15], s30 offen offset:3072 lds
    v_mfma_f32_16x16x32_bf16 v[184:187], v[84:87], a[136:139], v[184:187]
    ds_read_b64_tr_b16 v[76:77], v25 offset:0
    v_mfma_f32_16x16x32_bf16 v[188:191], v[84:87], a[140:143], v[188:191]
    ds_read_b64_tr_b16 v[78:79], v25 offset:2048
    s_branch M_G2S_JOIN
M_G2S_WK1:
    s_waitcnt vmcnt(12) lgkmcnt(0)
    v_mfma_f32_16x16x32_bf16 v[168:171], v[80:83], a[144:147], 0
    ds_read_b64_tr_b16 v[64:65], v26 offset:14336
    v_mfma_f32_16x16x32_bf16 v[172:175], v[80:83], a[148:151], 0
    ds_read_b64_tr_b16 v[66:67], v26 offset:15360
    v_cvt_pk_bf16_f32 v192, v96, v97
    v_mfma_f32_16x16x32_bf16 v[160:163], v[80:83], a[152:155], 0
    ds_read_b64_tr_b16 v[68:69], v27 offset:14336
    v_mfma_f32_16x16x32_bf16 v[164:167], v[80:83], a[156:159], 0
    ds_read_b64_tr_b16 v[70:71], v27 offset:15360
    s_add_u32 m0, s25, 12288
    s_add_u32 s30, s31, s95
    v_cvt_pk_bf16_f32 v193, v98, v99
    v_mfma_f32_16x16x32_bf16 v[184:187], v[84:87], a[144:147], 0
    buffer_load_dwordx4 v20, s[12:15], s30 offen lds
    v_cvt_pk_bf16_f32 v194, v112, v113
    v_mfma_f32_16x16x32_bf16 v[188:191], v[84:87], a[148:151], 0
    buffer_load_dwordx4 v21, s[12:15], s30 offen offset:1024 lds
    v_mfma_f32_16x16x32_bf16 v[176:179], v[84:87], a[152:155], 0
    v_cvt_pk_bf16_f32 v195, v114, v115
    v_mfma_f32_16x16x32_bf16 v[180:183], v[84:87], a[156:159], 0
    v_cvt_pk_bf16_f32 v196, v100, v101
    s_waitcnt vmcnt(12) lgkmcnt(0)
    v_mfma_f32_16x16x32_bf16 v[168:171], v[64:67], a[160:163], v[168:171]
    ds_read_b64_tr_b16 v[80:81], v26 offset:0
    v_mfma_f32_16x16x32_bf16 v[172:175], v[64:67], a[164:167], v[172:175]
    ds_read_b64_tr_b16 v[82:83], v26 offset:1024
    v_cvt_pk_bf16_f32 v197, v102, v103
    v_mfma_f32_16x16x32_bf16 v[160:163], v[64:67], a[168:171], v[160:163]
    ds_read_b64_tr_b16 v[84:85], v27 offset:0
    v_mfma_f32_16x16x32_bf16 v[164:167], v[64:67], a[172:175], v[164:167]
    ds_read_b64_tr_b16 v[86:87], v27 offset:1024
    v_cvt_pk_bf16_f32 v198, v116, v117
    v_mfma_f32_16x16x32_bf16 v[184:187], v[68:71], a[160:163], v[184:187]
    v_cvt_pk_bf16_f32 v199, v118, v119
    v_mfma_f32_16x16x32_bf16 v[188:191], v[68:71], a[164:167], v[188:191]
    v_mfma_f32_16x16x32_bf16 v[176:179], v[68:71], a[168:171], v[176:179]
    v_cvt_pk_bf16_f32 v200, v104, v105
    v_mfma_f32_16x16x32_bf16 v[180:183], v[68:71], a[172:175], v[180:183]
    v_cvt_pk_bf16_f32 v201, v106, v107
    s_waitcnt vmcnt(10) lgkmcnt(0)
    v_mfma_f32_16x16x32_bf16 v[168:171], v[80:83], a[176:179], v[168:171]
    ds_read_b64_tr_b16 v[64:65], v26 offset:2048
    v_mfma_f32_16x16x32_bf16 v[172:175], v[80:83], a[180:183], v[172:175]
    ds_read_b64_tr_b16 v[66:67], v26 offset:3072
    v_cvt_pk_bf16_f32 v202, v120, v121
    v_mfma_f32_16x16x32_bf16 v[160:163], v[80:83], a[184:187], v[160:163]
    ds_read_b64_tr_b16 v[68:69], v27 offset:2048
    v_mfma_f32_16x16x32_bf16 v[164:167], v[80:83], a[188:191], v[164:167]
    ds_read_b64_tr_b16 v[70:71], v27 offset:3072
    v_cvt_pk_bf16_f32 v203, v122, v123
    v_mfma_f32_16x16x32_bf16 v[184:187], v[84:87], a[176:179], v[184:187]
    v_cvt_pk_bf16_f32 v204, v108, v109
    v_mfma_f32_16x16x32_bf16 v[188:191], v[84:87], a[180:183], v[188:191]
    v_mfma_f32_16x16x32_bf16 v[176:179], v[84:87], a[184:187], v[176:179]
    v_cvt_pk_bf16_f32 v205, v110, v111
    v_mfma_f32_16x16x32_bf16 v[180:183], v[84:87], a[188:191], v[180:183]
    v_cvt_pk_bf16_f32 v206, v124, v125
    s_waitcnt vmcnt(8) lgkmcnt(0)
    v_mfma_f32_16x16x32_bf16 v[168:171], v[64:67], a[192:195], v[168:171]
    ds_read_b64_tr_b16 v[80:81], v26 offset:4096
    v_mfma_f32_16x16x32_bf16 v[172:175], v[64:67], a[196:199], v[172:175]
    ds_read_b64_tr_b16 v[82:83], v26 offset:5120
    v_cvt_pk_bf16_f32 v207, v126, v127
    v_mfma_f32_16x16x32_bf16 v[160:163], v[64:67], a[200:203], v[160:163]
    ds_read_b64_tr_b16 v[84:85], v27 offset:4096
    v_mfma_f32_16x16x32_bf16 v[164:167], v[64:67], a[204:207], v[164:167]
    ds_read_b64_tr_b16 v[86:87], v27 offset:5120
    s_add_u32 m0, s25, 0
    s_add_u32 s30, s33, s78
    v_cvt_pk_bf16_f32 v208, v128, v129
    v_mfma_f32_16x16x32_bf16 v[184:187], v[68:71], a[192:195], v[184:187]
    buffer_load_dwordx4 v16, s[12:15], s30 offen lds
    v_cvt_pk_bf16_f32 v209, v130, v131
    v_mfma_f32_16x16x32_bf16 v[188:191], v[68:71], a[196:199], v[188:191]
    buffer_load_dwordx4 v17, s[12:15], s30 offen offset:1024 lds
    v_mfma_f32_16x16x32_bf16 v[176:179], v[68:71], a[200:203], v[176:179]
    v_cvt_pk_bf16_f32 v210, v144, v145
    v_mfma_f32_16x16x32_bf16 v[180:183], v[68:71], a[204:207], v[180:183]
    v_cvt_pk_bf16_f32 v211, v146, v147
    s_waitcnt vmcnt(8) lgkmcnt(0)
    v_mfma_f32_16x16x32_bf16 v[168:171], v[80:83], a[208:211], v[168:171]
    ds_read_b64_tr_b16 v[64:65], v26 offset:6144
    v_mfma_f32_16x16x32_bf16 v[172:175], v[80:83], a[212:215], v[172:175]
    ds_read_b64_tr_b16 v[66:67], v26 offset:7168
    v_cvt_pk_bf16_f32 v212, v132, v133
    v_mfma_f32_16x16x32_bf16 v[160:163], v[80:83], a[216:219], v[160:163]
    ds_read_b64_tr_b16 v[68:69], v27 offset:6144
    v_mfma_f32_16x16x32_bf16 v[164:167], v[80:83], a[220:223], v[164:167]
    ds_read_b64_tr_b16 v[70:71], v27 offset:7168
    buffer_load_dwordx4 v18, s[12:15], s30 offen offset:2048 lds
    v_cvt_pk_bf16_f32 v213, v134, v135
    v_mfma_f32_16x16x32_bf16 v[184:187], v[84:87], a[208:211], v[184:187]
    v_mfma_f32_16x16x32_bf16 v[188:191], v[84:87], a[212:215], v[188:191]
    buffer_load_dwordx4 v19, s[12:15], s30 offen offset:3072 lds
    v_cvt_pk_bf16_f32 v214, v148, v149
    v_mfma_f32_16x16x32_bf16 v[176:179], v[84:87], a[216:219], v[176:179]
    v_mfma_f32_16x16x32_bf16 v[180:183], v[84:87], a[220:223], v[180:183]
    v_cvt_pk_bf16_f32 v215, v150, v151
    s_waitcnt vmcnt(8) lgkmcnt(0)
    v_mfma_f32_16x16x32_bf16 v[168:171], v[64:67], a[224:227], v[168:171]
    ds_read_b64_tr_b16 v[80:81], v26 offset:8192
    v_mfma_f32_16x16x32_bf16 v[172:175], v[64:67], a[228:231], v[172:175]
    ds_read_b64_tr_b16 v[82:83], v26 offset:9216
    v_cvt_pk_bf16_f32 v216, v136, v137
    v_mfma_f32_16x16x32_bf16 v[160:163], v[64:67], a[232:235], v[160:163]
    ds_read_b64_tr_b16 v[84:85], v27 offset:8192
    v_mfma_f32_16x16x32_bf16 v[164:167], v[64:67], a[236:239], v[164:167]
    ds_read_b64_tr_b16 v[86:87], v27 offset:9216
    s_add_u32 m0, s25, 4096
    s_add_u32 s30, s33, s79
    v_cvt_pk_bf16_f32 v217, v138, v139
    v_mfma_f32_16x16x32_bf16 v[184:187], v[68:71], a[224:227], v[184:187]
    buffer_load_dwordx4 v16, s[12:15], s30 offen lds
    v_mfma_f32_16x16x32_bf16 v[188:191], v[68:71], a[228:231], v[188:191]
    buffer_load_dwordx4 v17, s[12:15], s30 offen offset:1024 lds
    v_cvt_pk_bf16_f32 v218, v152, v153
    v_mfma_f32_16x16x32_bf16 v[176:179], v[68:71], a[232:235], v[176:179]
    v_mfma_f32_16x16x32_bf16 v[180:183], v[68:71], a[236:239], v[180:183]
    v_cvt_pk_bf16_f32 v219, v154, v155
    s_waitcnt vmcnt(8) lgkmcnt(0)
    v_mfma_f32_16x16x32_bf16 v[168:171], v[80:83], a[240:243], v[168:171]
    ds_read_b64_tr_b16 v[64:65], v26 offset:10240
    v_mfma_f32_16x16x32_bf16 v[172:175], v[80:83], a[244:247], v[172:175]
    ds_read_b64_tr_b16 v[66:67], v26 offset:11264
    v_cvt_pk_bf16_f32 v220, v140, v141
    v_mfma_f32_16x16x32_bf16 v[160:163], v[80:83], a[248:251], v[160:163]
    ds_read_b64_tr_b16 v[68:69], v27 offset:10240
    v_mfma_f32_16x16x32_bf16 v[164:167], v[80:83], a[252:255], v[164:167]
    ds_read_b64_tr_b16 v[70:71], v27 offset:11264
    buffer_load_dwordx4 v18, s[12:15], s30 offen offset:2048 lds
    v_cvt_pk_bf16_f32 v221, v142, v143
    v_mfma_f32_16x16x32_bf16 v[184:187], v[84:87], a[240:243], v[184:187]
    v_mfma_f32_16x16x32_bf16 v[188:191], v[84:87], a[244:247], v[188:191]
    buffer_load_dwordx4 v19, s[12:15], s30 offen offset:3072 lds
    v_cvt_pk_bf16_f32 v222, v156, v157
    v_mfma_f32_16x16x32_bf16 v[176:179], v[84:87], a[248:251], v[176:179]
    v_mfma_f32_16x16x32_bf16 v[180:183], v[84:87], a[252:255], v[180:183]
    v_cvt_pk_bf16_f32 v223, v158, v159
    s_waitcnt vmcnt(8) lgkmcnt(0)
    v_mfma_f32_16x16x32_bf16 v[168:171], v[64:67], v[224:227], v[168:171]
    ds_read_b64_tr_b16 v[80:81], v26 offset:12288
    v_mfma_f32_16x16x32_bf16 v[172:175], v[64:67], v[228:231], v[172:175]
    ds_read_b64_tr_b16 v[82:83], v26 offset:13312
    v_mfma_f32_16x16x32_bf16 v[160:163], v[64:67], v[232:235], v[160:163]
    ds_read_b64_tr_b16 v[84:85], v27 offset:12288
    v_mfma_f32_16x16x32_bf16 v[164:167], v[64:67], v[236:239], v[164:167]
    ds_read_b64_tr_b16 v[86:87], v27 offset:13312
    s_add_u32 m0, s25, 8192
    s_add_u32 s30, s33, s80
    v_mfma_f32_16x16x32_bf16 v[184:187], v[68:71], v[224:227], v[184:187]
    buffer_load_dwordx4 v16, s[12:15], s30 offen lds
    v_mfma_f32_16x16x32_bf16 v[188:191], v[68:71], v[228:231], v[188:191]
    buffer_load_dwordx4 v17, s[12:15], s30 offen offset:1024 lds
    v_mfma_f32_16x16x32_bf16 v[176:179], v[68:71], v[232:235], v[176:179]
    v_mfma_f32_16x16x32_bf16 v[180:183], v[68:71], v[236:239], v[180:183]
    s_waitcnt vmcnt(6) lgkmcnt(0)
    v_mfma_f32_16x16x32_bf16 v[168:171], v[80:83], v[240:243], v[168:171]
    ds_read_b64_tr_b16 v[64:65], v22 offset:0
    v_mfma_f32_16x16x32_bf16 v[172:175], v[80:83], v[244:247], v[172:175]
    ds_read_b64_tr_b16 v[66:67], v22 offset:2048
    v_mfma_f32_16x16x32_bf16 v[160:163], v[80:83], v[248:251], v[160:163]
    ds_read_b64_tr_b16 v[68:69], v23 offset:0
    v_mfma_f32_16x16x32_bf16 v[164:167], v[80:83], v[252:255], v[164:167]
    ds_read_b64_tr_b16 v[70:71], v23 offset:2048
    buffer_load_dwordx4 v18, s[12:15], s30 offen offset:2048 lds
    v_mfma_f32_16x16x32_bf16 v[184:187], v[84:87], v[240:243], v[184:187]
    ds_read_b64_tr_b16 v[72:73], v24 offset:0
    v_mfma_f32_16x16x32_bf16 v[188:191], v[84:87], v[244:247], v[188:191]
    ds_read_b64_tr_b16 v[74:75], v24 offset:2048
    buffer_load_dwordx4 v19, s[12:15], s30 offen offset:3072 lds
    v_mfma_f32_16x16x32_bf16 v[176:179], v[84:87], v[248:251], v[176:179]
    ds_read_b64_tr_b16 v[76:77], v25 offset:0
    v_mfma_f32_16x16x32_bf16 v[180:183], v[84:87], v[252:255], v[180:183]
    ds_read_b64_tr_b16 v[78:79], v25 offset:2048
M_G2S_JOIN:
    s_mul_i32 s55, s20, 10368
    s_mul_i32 s66, s20, 4608
    s_add_u32 s66, s66, 45056
    s_waitcnt vmcnt(4) lgkmcnt(0)
    v_mfma_f32_16x16x32_bf16 v[96:99], v[64:67], a[0:3], 0
    ds_read_b64_tr_b16 v[80:81], v22 offset:4096
    v_mfma_f32_16x16x32_bf16 v[100:103], v[64:67], a[4:7], 0
    ds_read_b64_tr_b16 v[82:83], v22 offset:6144
    v_mfma_f32_16x16x32_bf16 v[104:107], v[64:67], a[8:11], 0
    ds_read_b64_tr_b16 v[84:85], v23 offset:4096
    v_mfma_f32_16x16x32_bf16 v[108:111], v[64:67], a[12:15], 0
    ds_read_b64_tr_b16 v[86:87], v23 offset:6144
    v_mfma_f32_16x16x32_bf16 v[112:115], v[68:71], a[0:3], 0
    ds_read_b64_tr_b16 v[88:89], v24 offset:4096
    ds_write_b128 v31, v[168:171] offset:0
    v_mfma_f32_16x16x32_bf16 v[116:119], v[68:71], a[4:7], 0
    ds_read_b64_tr_b16 v[90:91], v24 offset:6144
    v_mfma_f32_16x16x32_bf16 v[120:123], v[68:71], a[8:11], 0
    ds_read_b64_tr_b16 v[92:93], v25 offset:4096
    ds_write_b128 v31, v[172:175] offset:1024
    v_mfma_f32_16x16x32_bf16 v[124:127], v[68:71], a[12:15], 0
    ds_read_b64_tr_b16 v[94:95], v25 offset:6144
    s_add_u32 m0, s25, 12288
    s_add_u32 s30, s33, s81
    buffer_load_dwordx4 v16, s[12:15], s30 offen lds
    ds_write_b128 v31, v[184:187] offset:2048
    v_mfma_f32_16x16x32_bf16 v[128:131], v[72:75], a[0:3], 0
    buffer_load_dwordx4 v17, s[12:15], s30 offen offset:1024 lds
    v_mfma_f32_16x16x32_bf16 v[132:135], v[72:75], a[4:7], 0
    buffer_load_dwordx4 v18, s[12:15], s30 offen offset:2048 lds
    ds_write_b128 v31, v[188:191] offset:3072
    v_mfma_f32_16x16x32_bf16 v[136:139], v[72:75], a[8:11], 0
    buffer_load_dwordx4 v19, s[12:15], s30 offen offset:3072 lds
    v_mfma_f32_16x16x32_bf16 v[140:143], v[72:75], a[12:15], 0
    s_add_u32 m0, s25, 0
    s_add_u32 s30, s33, s82
    buffer_load_dwordx4 v16, s[12:15], s30 offen lds
    v_mfma_f32_16x16x32_bf16 v[144:147], v[76:79], a[0:3], 0
    buffer_load_dwordx4 v17, s[12:15], s30 offen offset:1024 lds
    v_mfma_f32_16x16x32_bf16 v[148:151], v[76:79], a[4:7], 0
    buffer_load_dwordx4 v18, s[12:15], s30 offen offset:2048 lds
    v_mfma_f32_16x16x32_bf16 v[152:155], v[76:79], a[8:11], 0
    buffer_load_dwordx4 v19, s[12:15], s30 offen offset:3072 lds
    v_mfma_f32_16x16x32_bf16 v[156:159], v[76:79], a[12:15], 0
    s_add_u32 s36, s40, 0
    buffer_store_dwordx4 v[192:195], v33, s[16:19], s36 offen sc1
    s_waitcnt vmcnt(9) lgkmcnt(0)
    s_barrier
    v_mfma_f32_16x16x32_bf16 v[96:99], v[80:83], a[16:19], v[96:99]
    ds_read_b64_tr_b16 v[64:65], v22 offset:8192
    v_mfma_f32_16x16x32_bf16 v[100:103], v[80:83], a[20:23], v[100:103]
    ds_read_b64_tr_b16 v[66:67], v22 offset:10240
    ds_read_b128 v[50:53], v32 offset:0
    v_mfma_f32_16x16x32_bf16 v[104:107], v[80:83], a[24:27], v[104:107]
    ds_read_b64_tr_b16 v[68:69], v23 offset:8192
    v_mfma_f32_16x16x32_bf16 v[108:111], v[80:83], a[28:31], v[108:111]
    ds_read_b64_tr_b16 v[70:71], v23 offset:10240
    ds_read_b128 v[54:57], v32 offset:1024
    v_mfma_f32_16x16x32_bf16 v[112:115], v[84:87], a[16:19], v[112:115]
    ds_read_b64_tr_b16 v[72:73], v24 offset:8192
    v_mfma_f32_16x16x32_bf16 v[116:119], v[84:87], a[20:23], v[116:119]
    ds_read_b64_tr_b16 v[74:75], v24 offset:10240
    v_mfma_f32_16x16x32_bf16 v[120:123], v[84:87], a[24:27], v[120:123]
    ds_read_b64_tr_b16 v[76:77], v25 offset:8192
    v_mfma_f32_16x16x32_bf16 v[124:127], v[84:87], a[28:31], v[124:127]
    ds_read_b64_tr_b16 v[78:79], v25 offset:10240
    s_add_u32 m0, s25, 4096
    s_add_u32 s30, s33, s83
    v_mfma_f32_16x16x32_bf16 v[128:131], v[88:91], a[16:19], v[128:131]
    buffer_load_dwordx4 v16, s[12:15], s30 offen lds
    v_mfma_f32_16x16x32_bf16 v[132:135], v[88:91], a[20:23], v[132:135]
    v_mfma_f32_16x16x32_bf16 v[136:139], v[88:91], a[24:27], v[136:139]
    buffer_load_dwordx4 v17, s[12:15], s30 offen offset:1024 lds
    v_mfma_f32_16x16x32_bf16 v[140:143], v[88:91], a[28:31], v[140:143]
    buffer_load_dwordx4 v18, s[12:15], s30 offen offset:2048 lds
    v_mfma_f32_16x16x32_bf16 v[144:147], v[92:95], a[16:19], v[144:147]
    v_mfma_f32_16x16x32_bf16 v[148:151], v[92:95], a[20:23], v[148:151]
    buffer_load_dwordx4 v19, s[12:15], s30 offen offset:3072 lds
    v_mfma_f32_16x16x32_bf16 v[152:155], v[92:95], a[24:27], v[152:155]
    v_mfma_f32_16x16x32_bf16 v[156:159], v[92:95], a[28:31], v[156:159]
    s_waitcnt vmcnt(9) lgkmcnt(0)
    v_mfma_f32_16x16x32_bf16 v[96:99], v[64:67], a[32:35], v[96:99]
    ds_read_b64_tr_b16 v[80:81], v22 offset:12288
    v_mfma_f32_16x16x32_bf16 v[100:103], v[64:67], a[36:39], v[100:103]
    ds_read_b64_tr_b16 v[82:83], v22 offset:14336
    v_add_f32 v160, v160, v50
    v_mfma_f32_16x16x32_bf16 v[104:107], v[64:67], a[40:43], v[104:107]
    ds_read_b64_tr_b16 v[84:85], v23 offset:12288
    v_mfma_f32_16x16x32_bf16 v[108:111], v[64:67], a[44:47], v[108:111]
    ds_read_b64_tr_b16 v[86:87], v23 offset:14336
    v_add_f32 v161, v161, v51
    v_mfma_f32_16x16x32_bf16 v[112:115], v[68:71], a[32:35], v[112:115]
    ds_read_b64_tr_b16 v[88:89], v24 offset:12288
    v_add_f32 v162, v162, v52
    v_mfma_f32_16x16x32_bf16 v[116:119], v[68:71], a[36:39], v[116:119]
    ds_read_b64_tr_b16 v[90:91], v24 offset:14336
    v_mfma_f32_16x16x32_bf16 v[120:123], v[68:71], a[40:43], v[120:123]
    ds_read_b64_tr_b16 v[92:93], v25 offset:12288
    v_add_f32 v163, v163, v53
    v_mfma_f32_16x16x32_bf16 v[124:127], v[68:71], a[44:47], v[124:127]
    ds_read_b64_tr_b16 v[94:95], v25 offset:14336
    s_add_u32 m0, s25, 8192
    s_add_u32 s30, s33, s84
    v_add_f32 v164, v164, v54
    v_mfma_f32_16x16x32_bf16 v[128:131], v[72:75], a[32:35], v[128:131]
    buffer_load_dwordx4 v16, s[12:15], s30 offen lds
    v_mfma_f32_16x16x32_bf16 v[132:135], v[72:75], a[36:39], v[132:135]
    v_add_f32 v165, v165, v55
    v_mfma_f32_16x16x32_bf16 v[136:139], v[72:75], a[40:43], v[136:139]
    buffer_load_dwordx4 v17, s[12:15], s30 offen offset:1024 lds
    v_mfma_f32_16x16x32_bf16 v[140:143], v[72:75], a[44:47], v[140:143]
    buffer_load_dwordx4 v18, s[12:15], s30 offen offset:2048 lds
    v_add_f32 v166, v166, v56
    v_mfma_f32_16x16x32_bf16 v[144:147], v[76:79], a[32:35], v[144:147]
    v_add_f32 v167, v167, v57
    v_mfma_f32_16x16x32_bf16 v[148:151], v[76:79], a[36:39], v[148:151]
    buffer_load_dwordx4 v19, s[12:15], s30 offen offset:3072 lds
    v_mfma_f32_16x16x32_bf16 v[152:155], v[76:79], a[40:43], v[152:155]
    v_mfma_f32_16x16x32_bf16 v[156:159], v[76:79], a[44:47], v[156:159]
    s_add_u32 s36, s40, 8192
    buffer_store_dwordx4 v[196:199], v33, s[16:19], s36 offen sc1
    s_mov_b32 s8, s98
    s_mov_b32 s9, s99
    s_mov_b32 s10, 2359296
    s_mov_b32 s11, 0x20000
    s_waitcnt vmcnt(10) lgkmcnt(0)
    v_mfma_f32_16x16x32_bf16 v[96:99], v[80:83], a[48:51], v[96:99]
    ds_read_b64_tr_b16 v[64:65], v22 offset:0
    v_mfma_f32_16x16x32_bf16 v[100:103], v[80:83], a[52:55], v[100:103]
    ds_read_b64_tr_b16 v[66:67], v22 offset:2048
    ds_read_b128 v[50:53], v32 offset:2048
    v_mfma_f32_16x16x32_bf16 v[104:107], v[80:83], a[56:59], v[104:107]
    ds_read_b64_tr_b16 v[68:69], v23 offset:0
    v_mfma_f32_16x16x32_bf16 v[108:111], v[80:83], a[60:63], v[108:111]
    ds_read_b64_tr_b16 v[70:71], v23 offset:2048
    ds_read_b128 v[54:57], v32 offset:3072
    v_mfma_f32_16x16x32_bf16 v[112:115], v[84:87], a[48:51], v[112:115]
    ds_read_b64_tr_b16 v[72:73], v24 offset:0
    v_mfma_f32_16x16x32_bf16 v[116:119], v[84:87], a[52:55], v[116:119]
    ds_read_b64_tr_b16 v[74:75], v24 offset:2048
    v_mfma_f32_16x16x32_bf16 v[120:123], v[84:87], a[56:59], v[120:123]
    ds_read_b64_tr_b16 v[76:77], v25 offset:0
    v_mfma_f32_16x16x32_bf16 v[124:127], v[84:87], a[60:63], v[124:127]
    ds_read_b64_tr_b16 v[78:79], v25 offset:2048
    s_add_u32 m0, s25, 12288
    s_add_u32 s30, s33, s85
    v_mfma_f32_16x16x32_bf16 v[128:131], v[88:91], a[48:51], v[128:131]
    buffer_load_dwordx4 v16, s[12:15], s30 offen lds
    v_mfma_f32_16x16x32_bf16 v[132:135], v[88:91], a[52:55], v[132:135]
    v_mfma_f32_16x16x32_bf16 v[136:139], v[88:91], a[56:59], v[136:139]
    buffer_load_dwordx4 v17, s[12:15], s30 offen offset:1024 lds
    v_mfma_f32_16x16x32_bf16 v[140:143], v[88:91], a[60:63], v[140:143]
    buffer_load_dwordx4 v18, s[12:15], s30 offen offset:2048 lds
    v_mfma_f32_16x16x32_bf16 v[144:147], v[92:95], a[48:51], v[144:147]
    v_mfma_f32_16x16x32_bf16 v[148:151], v[92:95], a[52:55], v[148:151]
    buffer_load_dwordx4 v19, s[12:15], s30 offen offset:3072 lds
    v_mfma_f32_16x16x32_bf16 v[152:155], v[92:95], a[56:59], v[152:155]
    v_mfma_f32_16x16x32_bf16 v[156:159], v[92:95], a[60:63], v[156:159]
    s_waitcnt vmcnt(9) lgkmcnt(0)
    v_mfma_f32_16x16x32_bf16 v[96:99], v[64:67], a[64:67], v[96:99]
    ds_read_b64_tr_b16 v[80:81], v22 offset:4096
    v_mfma_f32_16x16x32_bf16 v[100:103], v[64:67], a[68:71], v[100:103]
    ds_read_b64_tr_b16 v[82:83], v22 offset:6144
    v_add_f32 v176, v176, v50
    v_mfma_f32_16x16x32_bf16 v[104:107], v[64:67], a[72:75], v[104:107]
    ds_read_b64_tr_b16 v[84:85], v23 offset:4096
    v_mfma_f32_16x16x32_bf16 v[108:111], v[64:67], a[76:79], v[108:111]
    ds_read_b64_tr_b16 v[86:87], v23 offset:6144
    v_add_f32 v177, v177, v51
    v_mfma_f32_16x16x32_bf16 v[112:115], v[68:71], a[64:67], v[112:115]
    ds_read_b64_tr_b16 v[88:89], v24 offset:4096
    v_add_f32 v178, v178, v52
    v_mfma_f32_16x16x32_bf16 v[116:119], v[68:71], a[68:71], v[116:119]
    ds_read_b64_tr_b16 v[90:91], v24 offset:6144
    v_mfma_f32_16x16x32_bf16 v[120:123], v[68:71], a[72:75], v[120:123]
    ds_read_b64_tr_b16 v[92:93], v25 offset:4096
    v_add_f32 v179, v179, v53
    v_mfma_f32_16x16x32_bf16 v[124:127], v[68:71], a[76:79], v[124:127]
    ds_read_b64_tr_b16 v[94:95], v25 offset:6144
    s_add_u32 m0, s25, 0
    s_add_u32 s30, s33, s86
    v_add_f32 v180, v180, v54
    v_mfma_f32_16x16x32_bf16 v[128:131], v[72:75], a[64:67], v[128:131]
    buffer_load_dwordx4 v16, s[12:15], s30 offen lds
    v_mfma_f32_16x16x32_bf16 v[132:135], v[72:75], a[68:71], v[132:135]
    v_add_f32 v181, v181, v55
    v_mfma_f32_16x16x32_bf16 v[136:139], v[72:75], a[72:75], v[136:139]
    buffer_load_dwordx4 v17, s[12:15], s30 offen offset:1024 lds
    v_mfma_f32_16x16x32_bf16 v[140:143], v[72:75], a[76:79], v[140:143]
    buffer_load_dwordx4 v18, s[12:15], s30 offen offset:2048 lds
    v_add_f32 v182, v182, v56
    v_mfma_f32_16x16x32_bf16 v[144:147], v[76:79], a[64:67], v[144:147]
    v_add_f32 v183, v183, v57
    v_mfma_f32_16x16x32_bf16 v[148:151], v[76:79], a[68:71], v[148:151]
    buffer_load_dwordx4 v19, s[12:15], s30 offen offset:3072 lds
    v_mfma_f32_16x16x32_bf16 v[152:155], v[76:79], a[72:75], v[152:155]
    v_mfma_f32_16x16x32_bf16 v[156:159], v[76:79], a[76:79], v[156:159]
    s_add_u32 s36, s40, 16384
    buffer_store_dwordx4 v[200:203], v33, s[16:19], s36 offen sc1
    s_waitcnt vmcnt(10) lgkmcnt(0)
    v_mfma_f32_16x16x32_bf16 v[96:99], v[80:83], a[80:83], v[96:99]
    ds_read_b64_tr_b16 v[64:65], v22 offset:8192
    v_mfma_f32_16x16x32_bf16 v[100:103], v[80:83], a[84:87], v[100:103]
    ds_read_b64_tr_b16 v[66:67], v22 offset:10240
    v_cvt_pk_bf16_f32 v42, v160, v161
    v_mfma_f32_16x16x32_bf16 v[104:107], v[80:83], a[88:91], v[104:107]
    ds_read_b64_tr_b16 v[68:69], v23 offset:8192
    v_mfma_f32_16x16x32_bf16 v[108:111], v[80:83], a[92:95], v[108:111]
    ds_read_b64_tr_b16 v[70:71], v23 offset:10240
    v_cvt_pk_bf16_f32 v43, v162, v163
    v_mfma_f32_16x16x32_bf16 v[112:115], v[84:87], a[80:83], v[112:115]
    ds_read_b64_tr_b16 v[72:73], v24 offset:8192
    v_cvt_pk_bf16_f32 v44, v176, v177
    v_mfma_f32_16x16x32_bf16 v[116:119], v[84:87], a[84:87], v[116:119]
    ds_read_b64_tr_b16 v[74:75], v24 offset:10240
    v_mfma_f32_16x16x32_bf16 v[120:123], v[84:87], a[88:91], v[120:123]
    ds_read_b64_tr_b16 v[76:77], v25 offset:8192
    v_cvt_pk_bf16_f32 v45, v178, v179
    v_mfma_f32_16x16x32_bf16 v[124:127], v[84:87], a[92:95], v[124:127]
    ds_read_b64_tr_b16 v[78:79], v25 offset:10240
    s_add_u32 m0, s25, 4096
    s_add_u32 s30, s33, s87
    v_mfma_f32_16x16x32_bf16 v[128:131], v[88:91], a[80:83], v[128:131]
    buffer_load_dwordx4 v16, s[12:15], s30 offen lds
    v_mfma_f32_16x16x32_bf16 v[132:135], v[88:91], a[84:87], v[132:135]
    v_mfma_f32_16x16x32_bf16 v[136:139], v[88:91], a[88:91], v[136:139]
    buffer_load_dwordx4 v17, s[12:15], s30 offen offset:1024 lds
    v_mfma_f32_16x16x32_bf16 v[140:143], v[88:91], a[92:95], v[140:143]
    buffer_load_dwordx4 v18, s[12:15], s30 offen offset:2048 lds
    v_mfma_f32_16x16x32_bf16 v[144:147], v[92:95], a[80:83], v[144:147]
    v_mfma_f32_16x16x32_bf16 v[148:151], v[92:95], a[84:87], v[148:151]
    buffer_load_dwordx4 v19, s[12:15], s30 offen offset:3072 lds
    v_mfma_f32_16x16x32_bf16 v[152:155], v[92:95], a[88:91], v[152:155]
    v_mfma_f32_16x16x32_bf16 v[156:159], v[92:95], a[92:95], v[156:159]
    s_add_u32 s36, s42, 0
    buffer_store_dwordx4 v[42:45], v33, s[16:19], s36 offen sc1
    s_waitcnt vmcnt(10) lgkmcnt(0)
    v_mfma_f32_16x16x32_bf16 v[96:99], v[64:67], a[96:99], v[96:99]
    ds_read_b64_tr_b16 v[80:81], v22 offset:12288
    v_mfma_f32_16x16x32_bf16 v[100:103], v[64:67], a[100:103], v[100:103]
    ds_read_b64_tr_b16 v[82:83], v22 offset:14336
    v_cvt_pk_bf16_f32 v46, v164, v165
    v_mfma_f32_16x16x32_bf16 v[104:107], v[64:67], a[104:107], v[104:107]
    ds_read_b64_tr_b16 v[84:85], v23 offset:12288
    v_mfma_f32_16x16x32_bf16 v[108:111], v[64:67], a[108:111], v[108:111]
    ds_read_b64_tr_b16 v[86:87], v23 offset:14336
    v_cvt_pk_bf16_f32 v47, v166, v167
    v_mfma_f32_16x16x32_bf16 v[112:115], v[68:71], a[96:99], v[112:115]
    ds_read_b64_tr_b16 v[88:89], v24 offset:12288
    v_cvt_pk_bf16_f32 v48, v180, v181
    v_mfma_f32_16x16x32_bf16 v[116:119], v[68:71], a[100:103], v[116:119]
    ds_read_b64_tr_b16 v[90:91], v24 offset:14336
    v_mfma_f32_16x16x32_bf16 v[120:123], v[68:71], a[104:107], v[120:123]
    ds_read_b64_tr_b16 v[92:93], v25 offset:12288
    v_cvt_pk_bf16_f32 v49, v182, v183
    v_mfma_f32_16x16x32_bf16 v[124:127], v[68:71], a[108:111], v[124:127]
    ds_read_b64_tr_b16 v[94:95], v25 offset:14336
    s_add_u32 m0, s25, 8192
    s_add_u32 s30, s33, s88
    v_mfma_f32_16x16x32_bf16 v[128:131], v[72:75], a[96:99], v[128:131]
    buffer_load_dwordx4 v16, s[12:15], s30 offen lds
    v_mfma_f32_16x16x32_bf16 v[132:135], v[72:75], a[100:103], v[132:135]
    v_mfma_f32_16x16x32_bf16 v[136:139], v[72:75], a[104:107], v[136:139]
    buffer_load_dwordx4 v17, s[12:15], s30 offen offset:1024 lds
    v_mfma_f32_16x16x32_bf16 v[140:143], v[72:75], a[108:111], v[140:143]
    buffer_load_dwordx4 v18, s[12:15], s30 offen offset:2048 lds
    v_mfma_f32_16x16x32_bf16 v[144:147], v[76:79], a[96:99], v[144:147]
    v_mfma_f32_16x16x32_bf16 v[148:151], v[76:79], a[100:103], v[148:151]
    buffer_load_dwordx4 v19, s[12:15], s30 offen offset:3072 lds
    v_mfma_f32_16x16x32_bf16 v[152:155], v[76:79], a[104:107], v[152:155]
    v_mfma_f32_16x16x32_bf16 v[156:159], v[76:79], a[108:111], v[156:159]
    s_add_u32 s36, s40, 24576
    buffer_store_dwordx4 v[204:207], v33, s[16:19], s36 offen sc1
    s_add_u32 s36, s42, 8192
    buffer_store_dwordx4 v[46:49], v33, s[16:19], s36 offen sc1
    s_waitcnt vmcnt(12) lgkmcnt(0)
    v_mfma_f32_16x16x32_bf16 v[96:99], v[80:83], a[112:115], v[96:99]
    ds_read_b64_tr_b16 v[64:65], v22 offset:0
    v_mfma_f32_16x16x32_bf16 v[100:103], v[80:83], a[116:119], v[100:103]
    ds_read_b64_tr_b16 v[66:67], v22 offset:2048
    v_mfma_f32_16x16x32_bf16 v[104:107], v[80:83], a[120:123], v[104:107]
    ds_read_b64_tr_b16 v[68:69], v23 offset:0
    v_mfma_f32_16x16x32_bf16 v[108:111], v[80:83], a[124:127], v[108:111]
    ds_read_b64_tr_b16 v[70:71], v23 offset:2048
    v_mfma_f32_16x16x32_bf16 v[112:115], v[84:87], a[112:115], v[112:115]
    ds_read_b64_tr_b16 v[72:73], v24 offset:0
    v_mfma_f32_16x16x32_bf16 v[116:119], v[84:87], a[116:119], v[116:119]
    ds_read_b64_tr_b16 v[74:75], v24 offset:2048
    v_mfma_f32_16x16x32_bf16 v[120:123], v[84:87], a[120:123], v[120:123]
    ds_read_b64_tr_b16 v[76:77], v25 offset:0
    v_mfma_f32_16x16x32_bf16 v[124:127], v[84:87], a[124:127], v[124:127]
    ds_read_b64_tr_b16 v[78:79], v25 offset:2048
    s_add_u32 m0, s25, 12288
    s_add_u32 s30, s33, s89
    v_mfma_f32_16x16x32_bf16 v[128:131], v[88:91], a[112:115], v[128:131]
    buffer_load_dwordx4 v16, s[12:15], s30 offen lds
    v_mfma_f32_16x16x32_bf16 v[132:135], v[88:91], a[116:119], v[132:135]
    v_mfma_f32_16x16x32_bf16 v[136:139], v[88:91], a[120:123], v[136:139]
    buffer_load_dwordx4 v17, s[12:15], s30 offen offset:1024 lds
    v_mfma_f32_16x16x32_bf16 v[140:143], v[88:91], a[124:127], v[140:143]
    buffer_load_dwordx4 v18, s[12:15], s30 offen offset:2048 lds
    v_mfma_f32_16x16x32_bf16 v[144:147], v[92:95], a[112:115], v[144:147]
    v_mfma_f32_16x16x32_bf16 v[148:151], v[92:95], a[116:119], v[148:151]
    buffer_load_dwordx4 v19, s[12:15], s30 offen offset:3072 lds
    v_mfma_f32_16x16x32_bf16 v[152:155], v[92:95], a[120:123], v[152:155]
    v_mfma_f32_16x16x32_bf16 v[156:159], v[92:95], a[124:127], v[156:159]
    s_waitcnt vmcnt(11) lgkmcnt(0)
    v_mfma_f32_16x16x32_bf16 v[96:99], v[64:67], a[128:131], v[96:99]
    ds_read_b64_tr_b16 v[80:81], v22 offset:4096
    v_mfma_f32_16x16x32_bf16 v[100:103], v[64:67], a[132:135], v[100:103]
    ds_read_b64_tr_b16 v[82:83], v22 offset:6144
    v_mfma_f32_16x16x32_bf16 v[104:107], v[64:67], a[136:139], v[104:107]
    ds_read_b64_tr_b16 v[84:85], v23 offset:4096
    v_mfma_f32_16x16x32_bf16 v[108:111], v[64:67], a[140:143], v[108:111]
    ds_read_b64_tr_b16 v[86:87], v23 offset:6144
    v_mfma_f32_16x16x32_bf16 v[112:115], v[68:71], a[128:131], v[112:115]
    ds_read_b64_tr_b16 v[88:89], v24 offset:4096
    v_mfma_f32_16x16x32_bf16 v[116:119], v[68:71], a[132:135], v[116:119]
    ds_read_b64_tr_b16 v[90:91], v24 offset:6144
    v_mfma_f32_16x16x32_bf16 v[120:123], v[68:71], a[136:139], v[120:123]
    ds_read_b64_tr_b16 v[92:93], v25 offset:4096
    v_mfma_f32_16x16x32_bf16 v[124:127], v[68:71], a[140:143], v[124:127]
    ds_read_b64_tr_b16 v[94:95], v25 offset:6144
    s_add_u32 m0, s25, 0
    s_add_u32 s30, s33, s90
    v_mfma_f32_16x16x32_bf16 v[128:131], v[72:75], a[128:131], v[128:131]
    buffer_load_dwordx4 v16, s[12:15], s30 offen lds
    v_mfma_f32_16x16x32_bf16 v[132:135], v[72:75], a[132:135], v[132:135]
    v_mfma_f32_16x16x32_bf16 v[136:139], v[72:75], a[136:139], v[136:139]
    buffer_load_dwordx4 v17, s[12:15], s30 offen offset:1024 lds
    v_mfma_f32_16x16x32_bf16 v[140:143], v[72:75], a[140:143], v[140:143]
    buffer_load_dwordx4 v18, s[12:15], s30 offen offset:2048 lds
    v_mfma_f32_16x16x32_bf16 v[144:147], v[76:79], a[128:131], v[144:147]
    v_mfma_f32_16x16x32_bf16 v[148:151], v[76:79], a[132:135], v[148:151]
    buffer_load_dwordx4 v19, s[12:15], s30 offen offset:3072 lds
    v_mfma_f32_16x16x32_bf16 v[152:155], v[76:79], a[136:139], v[152:155]
    v_mfma_f32_16x16x32_bf16 v[156:159], v[76:79], a[140:143], v[156:159]
    s_add_u32 s36, s40, 32768
    buffer_store_dwordx4 v[208:211], v33, s[16:19], s36 offen sc1
    s_waitcnt vmcnt(11) lgkmcnt(0)
    v_mfma_f32_16x16x32_bf16 v[96:99], v[80:83], a[144:147], v[96:99]
    ds_read_b64_tr_b16 v[64:65], v22 offset:8192
    s_mov_b32 s60, 0x01000302
    v_mfma_f32_16x16x32_bf16 v[100:103], v[80:83], a[148:151], v[100:103]
    ds_read_b64_tr_b16 v[66:67], v22 offset:10240
    s_mov_b32 s61, 0x01000100
    s_mov_b32 s62, 0x03020302
    v_mfma_f32_16x16x32_bf16 v[104:107], v[80:83], a[152:155], v[104:107]
    ds_read_b64_tr_b16 v[68:69], v23 offset:8192
    s_mov_b32 s63, 0x03020504
    v_mfma_f32_16x16x32_bf16 v[108:111], v[80:83], a[156:159], v[108:111]
    ds_read_b64_tr_b16 v[70:71], v23 offset:10240
    v_mov_b32 v188, 0
    v_mov_b32 v189, 0
    v_mfma_f32_16x16x32_bf16 v[112:115], v[84:87], a[144:147], v[112:115]
    ds_read_b64_tr_b16 v[72:73], v24 offset:8192
    v_mov_b32 v190, 0
    v_mov_b32 v191, 0
    v_mfma_f32_16x16x32_bf16 v[116:119], v[84:87], a[148:151], v[116:119]
    ds_read_b64_tr_b16 v[74:75], v24 offset:10240
    v_lshlrev_b32 v4, 4, v1
    v_mfma_f32_16x16x32_bf16 v[120:123], v[84:87], a[152:155], v[120:123]
    ds_read_b64_tr_b16 v[76:77], v25 offset:8192
    v_add_u32 v10, s66, v4
    ds_write_b128 v10, v[188:191] offset:0
    v_mfma_f32_16x16x32_bf16 v[124:127], v[84:87], a[156:159], v[124:127]
    ds_read_b64_tr_b16 v[78:79], v25 offset:10240
    s_add_u32 m0, s25, 4096
    s_add_u32 s30, s33, s91
    v_add_u32 v4, s55, v4
    v_lshlrev_b32 v10, 1, v1
    v_mfma_f32_16x16x32_bf16 v[128:131], v[88:91], a[144:147], v[128:131]
    buffer_load_dwordx4 v16, s[12:15], s30 offen lds
    v_sub_u32 v5, 1150, v10
    v_mfma_f32_16x16x32_bf16 v[132:135], v[88:91], a[148:151], v[132:135]
    v_lshlrev_b32 v10, 2, v1
    v_sub_u32 v6, 1020, v10
    v_mfma_f32_16x16x32_bf16 v[136:139], v[88:91], a[152:155], v[136:139]
    buffer_load_dwordx4 v17, s[12:15], s30 offen offset:1024 lds
    v_lshlrev_b32 v10, 3, v1
    v_mfma_f32_16x16x32_bf16 v[140:143], v[88:91], a[156:159], v[140:143]
    buffer_load_dwordx4 v18, s[12:15], s30 offen offset:2048 lds
    v_sub_u32 v7, 760, v10
    v_lshlrev_b32 v10, 4, v1
    v_mfma_f32_16x16x32_bf16 v[144:147], v[92:95], a[144:147], v[144:147]
    v_sub_u32 v8, 1008, v10
    v_max_i32 v7, 0, v7
    v_mfma_f32_16x16x32_bf16 v[148:151], v[92:95], a[148:151], v[148:151]
    buffer_load_dwordx4 v19, s[12:15], s30 offen offset:3072 lds
    v_min_i32 v8, 496, v8
    v_mfma_f32_16x16x32_bf16 v[152:155], v[92:95], a[152:155], v[152:155]
    v_add_u32 v5, s53, v5
    v_add_u32 v6, s53, v6
    v_mfma_f32_16x16x32_bf16 v[156:159], v[92:95], a[156:159], v[156:159]
    v_add_u32 v7, s53, v7
    v_add_u32 v8, s53, v8
    s_waitcnt vmcnt(9) lgkmcnt(0)
    v_mfma_f32_16x16x32_bf16 v[96:99], v[64:67], a[160:163], v[96:99]
    ds_read_b64_tr_b16 v[80:81], v22 offset:12288
    v_and_b32 v10, 1, v1
    v_mfma_f32_16x16x32_bf16 v[100:103], v[64:67], a[164:167], v[100:103]
    ds_read_b64_tr_b16 v[82:83], v22 offset:14336
    v_cmp_eq_u32 vcc, 1, v10
    v_mov_b32 v11, s61
    v_mfma_f32_16x16x32_bf16 v[104:107], v[64:67], a[168:171], v[104:107]
    ds_read_b64_tr_b16 v[84:85], v23 offset:12288
    v_mov_b32 v12, 0x05040100
    v_mfma_f32_16x16x32_bf16 v[108:111], v[64:67], a[172:175], v[108:111]
    ds_read_b64_tr_b16 v[86:87], v23 offset:14336
    v_cndmask_b32 v9, v11, v12, vcc
    ds_read_u16 v160, v5 offset:128
    v_mfma_f32_16x16x32_bf16 v[112:115], v[68:71], a[160:163], v[112:115]
    ds_read_b64_tr_b16 v[88:89], v24 offset:12288
    ds_read_u16 v34, v5 offset:130
    ds_read_u16 v161, v5
    v_mfma_f32_16x16x32_bf16 v[116:119], v[68:71], a[164:167], v[116:119]
    ds_read_b64_tr_b16 v[90:91], v24 offset:14336
    ds_read_u16 v35, v5 offset:2
    v_mfma_f32_16x16x32_bf16 v[120:123], v[68:71], a[168:171], v[120:123]
    ds_read_b64_tr_b16 v[92:93], v25 offset:12288
    ds_read_b32 v162, v6
    ds_read_u16 v163, v6 offset:4
    v_mfma_f32_16x16x32_bf16 v[124:127], v[68:71], a[172:175], v[124:127]
    ds_read_b64_tr_b16 v[94:95], v25 offset:14336
    s_add_u32 m0, s25, 8192
    s_add_u32 s30, s33, s92
    ds_read_b64 v[164:165], v7
    ds_read_u16 v166, v7 offset:8
    v_mfma_f32_16x16x32_bf16 v[128:131], v[72:75], a[160:163], v[128:131]
    buffer_load_dwordx4 v16, s[12:15], s30 offen lds
    ds_read_b128 v[168:171], v8
    v_mfma_f32_16x16x32_bf16 v[132:135], v[72:75], a[164:167], v[132:135]
    v_mfma_f32_16x16x32_bf16 v[136:139], v[72:75], a[168:171], v[136:139]
    buffer_load_dwordx4 v17, s[12:15], s30 offen offset:1024 lds
    v_mfma_f32_16x16x32_bf16 v[140:143], v[72:75], a[172:175], v[140:143]
    buffer_load_dwordx4 v18, s[12:15], s30 offen offset:2048 lds
    v_mfma_f32_16x16x32_bf16 v[144:147], v[76:79], a[160:163], v[144:147]
    v_mfma_f32_16x16x32_bf16 v[148:151], v[76:79], a[164:167], v[148:151]
    buffer_load_dwordx4 v19, s[12:15], s30 offen offset:3072 lds
    v_mfma_f32_16x16x32_bf16 v[152:155], v[76:79], a[168:171], v[152:155]
    v_mfma_f32_16x16x32_bf16 v[156:159], v[76:79], a[172:175], v[156:159]
    s_add_u32 s36, s40, 40960
    buffer_store_dwordx4 v[212:215], v33, s[16:19], s36 offen sc1
    s_waitcnt vmcnt(10) lgkmcnt(0)
    v_mfma_f32_16x16x32_bf16 v[96:99], v[80:83], a[176:179], v[96:99]
    ds_read_b64_tr_b16 v[64:65], v22 offset:0
    v_perm_b32 v172, v34, v34, s61
    v_mfma_f32_16x16x32_bf16 v[100:103], v[80:83], a[180:183], v[100:103]
    ds_read_b64_tr_b16 v[66:67], v22 offset:2048
    v_perm_b32 v173, v160, v34, v9
    v_perm_b32 v174, v160, v160, s61
    v_mfma_f32_16x16x32_bf16 v[104:107], v[80:83], a[184:187], v[104:107]
    ds_read_b64_tr_b16 v[68:69], v23 offset:0
    v_perm_b32 v175, v160, v160, s61
    v_mfma_f32_16x16x32_bf16 v[108:111], v[80:83], a[188:191], v[108:111]
    ds_read_b64_tr_b16 v[70:71], v23 offset:2048
    v_perm_b32 v176, v35, v35, s61
    v_perm_b32 v177, v161, v35, v9
    v_mfma_f32_16x16x32_bf16 v[112:115], v[84:87], a[176:179], v[112:115]
    ds_read_b64_tr_b16 v[72:73], v24 offset:0
    v_perm_b32 v178, v161, v161, s61
    v_perm_b32 v179, v161, v161, s61
    v_mfma_f32_16x16x32_bf16 v[116:119], v[84:87], a[180:183], v[116:119]
    ds_read_b64_tr_b16 v[74:75], v24 offset:2048
    v_perm_b32 v180, v163, v163, s61
    v_mfma_f32_16x16x32_bf16 v[120:123], v[84:87], a[184:187], v[120:123]
    ds_read_b64_tr_b16 v[76:77], v25 offset:0
    v_perm_b32 v181, v162, v162, s62
    v_perm_b32 v182, v162, v162, s60
    v_mfma_f32_16x16x32_bf16 v[124:127], v[84:87], a[188:191], v[124:127]
    ds_read_b64_tr_b16 v[78:79], v25 offset:2048
    s_add_u32 m0, s25, 12288
    s_add_u32 s30, s33, s93
    v_perm_b32 v183, v162, v162, s61
    v_perm_b32 v184, v166, v165, s63
    v_mfma_f32_16x16x32_bf16 v[128:131], v[88:91], a[176:179], v[128:131]
    buffer_load_dwordx4 v16, s[12:15], s30 offen lds
    v_perm_b32 v185, v165, v165, s61
    v_mfma_f32_16x16x32_bf16 v[132:135], v[88:91], a[180:183], v[132:135]
    v_perm_b32 v186, v165, v164, s63
    v_perm_b32 v187, v164, v164, s61
    v_mfma_f32_16x16x32_bf16 v[136:139], v[88:91], a[184:187], v[136:139]
    buffer_load_dwordx4 v17, s[12:15], s30 offen offset:1024 lds
    v_cmp_gt_u32 vcc, 32, v1
    v_mfma_f32_16x16x32_bf16 v[140:143], v[88:91], a[188:191], v[140:143]
    buffer_load_dwordx4 v18, s[12:15], s30 offen offset:2048 lds
    v_perm_b32 v160, v171, v171, s60
    v_perm_b32 v161, v170, v170, s60
    v_mfma_f32_16x16x32_bf16 v[144:147], v[92:95], a[176:179], v[144:147]
    v_perm_b32 v162, v169, v169, s60
    v_perm_b32 v163, v168, v168, s60
    v_mfma_f32_16x16x32_bf16 v[148:151], v[92:95], a[180:183], v[148:151]
    buffer_load_dwordx4 v19, s[12:15], s30 offen offset:3072 lds
    v_cndmask_b32 v184, v160, v184, vcc
    v_mfma_f32_16x16x32_bf16 v[152:155], v[92:95], a[184:187], v[152:155]
    v_cndmask_b32 v185, v161, v185, vcc
    v_cndmask_b32 v186, v162, v186, vcc
    v_mfma_f32_16x16x32_bf16 v[156:159], v[92:95], a[188:191], v[156:159]
    v_cndmask_b32 v187, v163, v187, vcc
    ds_write_b128 v4, v[172:175] offset:16
    s_waitcnt vmcnt(9) lgkmcnt(1)
    v_mfma_f32_16x16x32_bf16 v[96:99], v[64:67], a[192:195], v[96:99]
    ds_read_b64_tr_b16 v[80:81], v22 offset:4096
    ds_write_b128 v4, v[176:179] offset:1040
    v_mfma_f32_16x16x32_bf16 v[100:103], v[64:67], a[196:199], v[100:103]
    ds_read_b64_tr_b16 v[82:83], v22 offset:6144
    ds_write_b128 v4, v[180:183] offset:2064
    ds_write_b128 v4, v[184:187] offset:3088
    v_mfma_f32_16x16x32_bf16 v[104:107], v[64:67], a[200:203], v[104:107]
    ds_read_b64_tr_b16 v[84:85], v23 offset:4096
    ds_write_b128 v4, v[188:191] offset:4112
    v_mfma_f32_16x16x32_bf16 v[108:111], v[64:67], a[204:207], v[108:111]
    ds_read_b64_tr_b16 v[86:87], v23 offset:6144
    v_mfma_f32_16x16x32_bf16 v[112:115], v[68:71], a[192:195], v[112:115]
    ds_read_b64_tr_b16 v[88:89], v24 offset:4096
    v_mfma_f32_16x16x32_bf16 v[116:119], v[68:71], a[196:199], v[116:119]
    ds_read_b64_tr_b16 v[90:91], v24 offset:6144
    v_mfma_f32_16x16x32_bf16 v[120:123], v[68:71], a[200:203], v[120:123]
    ds_read_b64_tr_b16 v[92:93], v25 offset:4096
    v_mfma_f32_16x16x32_bf16 v[124:127], v[68:71], a[204:207], v[124:127]
    ds_read_b64_tr_b16 v[94:95], v25 offset:6144
    s_add_u32 m0, s25, 0
    s_add_u32 s30, s33, s94
    v_mfma_f32_16x16x32_bf16 v[128:131], v[72:75], a[192:195], v[128:131]
    buffer_load_dwordx4 v16, s[12:15], s30 offen lds
    v_mfma_f32_16x16x32_bf16 v[132:135], v[72:75], a[196:199], v[132:135]
    v_mfma_f32_16x16x32_bf16 v[136:139], v[72:75], a[200:203], v[136:139]
    buffer_load_dwordx4 v17, s[12:15], s30 offen offset:1024 lds
    v_mfma_f32_16x16x32_bf16 v[140:143], v[72:75], a[204:207], v[140:143]
    buffer_load_dwordx4 v18, s[12:15], s30 offen offset:2048 lds
    v_mfma_f32_16x16x32_bf16 v[144:147], v[76:79], a[192:195], v[144:147]
    v_mfma_f32_16x16x32_bf16 v[148:151], v[76:79], a[196:199], v[148:151]
    buffer_load_dwordx4 v19, s[12:15], s30 offen offset:3072 lds
    v_mfma_f32_16x16x32_bf16 v[152:155], v[76:79], a[200:203], v[152:155]
    v_mfma_f32_16x16x32_bf16 v[156:159], v[76:79], a[204:207], v[156:159]
    s_add_u32 s36, s40, 49152
    buffer_store_dwordx4 v[216:219], v33, s[16:19], s36 offen sc1
    s_waitcnt vmcnt(10) lgkmcnt(0)
    v_mfma_f32_16x16x32_bf16 v[96:99], v[80:83], a[208:211], v[96:99]
    ds_read_b64_tr_b16 v[64:65], v22 offset:8192
    ds_read_b32 v160, v4 offset:12
    v_mfma_f32_16x16x32_bf16 v[100:103], v[80:83], a[212:215], v[100:103]
    ds_read_b64_tr_b16 v[66:67], v22 offset:10240
    ds_read_b32 v161, v4 offset:1036
    ds_read_b32 v162, v4 offset:2060
    v_mfma_f32_16x16x32_bf16 v[104:107], v[80:83], a[216:219], v[104:107]
    ds_read_b64_tr_b16 v[68:69], v23 offset:8192
    ds_read_b32 v163, v4 offset:3084
    v_mfma_f32_16x16x32_bf16 v[108:111], v[80:83], a[220:223], v[108:111]
    ds_read_b64_tr_b16 v[70:71], v23 offset:10240
    ds_read_b32 v164, v4 offset:4108
    v_mfma_f32_16x16x32_bf16 v[112:115], v[84:87], a[208:211], v[112:115]
    ds_read_b64_tr_b16 v[72:73], v24 offset:8192
    v_mfma_f32_16x16x32_bf16 v[116:119], v[84:87], a[212:215], v[116:119]
    ds_read_b64_tr_b16 v[74:75], v24 offset:10240
    v_mfma_f32_16x16x32_bf16 v[120:123], v[84:87], a[216:219], v[120:123]
    ds_read_b64_tr_b16 v[76:77], v25 offset:8192
    v_mfma_f32_16x16x32_bf16 v[124:127], v[84:87], a[220:223], v[124:127]
    ds_read_b64_tr_b16 v[78:79], v25 offset:10240
    s_add_u32 m0, s25, 4096
    s_add_u32 s30, s33, s95
    v_mfma_f32_16x16x32_bf16 v[128:131], v[88:91], a[208:211], v[128:131]
    buffer_load_dwordx4 v16, s[12:15], s30 offen lds
    v_mfma_f32_16x16x32_bf16 v[132:135], v[88:91], a[212:215], v[132:135]
    v_mfma_f32_16x16x32_bf16 v[136:139], v[88:91], a[216:219], v[136:139]
    buffer_load_dwordx4 v17, s[12:15], s30 offen offset:1024 lds
    v_mfma_f32_16x16x32_bf16 v[140:143], v[88:91], a[220:223], v[140:143]
    buffer_load_dwordx4 v18, s[12:15], s30 offen offset:2048 lds
    v_mfma_f32_16x16x32_bf16 v[144:147], v[92:95], a[208:211], v[144:147]
    v_mfma_f32_16x16x32_bf16 v[148:151], v[92:95], a[212:215], v[148:151]
    buffer_load_dwordx4 v19, s[12:15], s30 offen offset:3072 lds
    v_mfma_f32_16x16x32_bf16 v[152:155], v[92:95], a[216:219], v[152:155]
    v_mfma_f32_16x16x32_bf16 v[156:159], v[92:95], a[220:223], v[156:159]
    s_waitcnt vmcnt(9) lgkmcnt(0)
    v_mfma_f32_16x16x32_bf16 v[96:99], v[64:67], a[224:227], v[96:99]
    ds_read_b64_tr_b16 v[80:81], v22 offset:12288
    v_alignbit_b32 v165, v172, v160, 16
    v_mfma_f32_16x16x32_bf16 v[100:103], v[64:67], a[228:231], v[100:103]
    ds_read_b64_tr_b16 v[82:83], v22 offset:14336
    v_alignbit_b32 v166, v173, v172, 16
    v_alignbit_b32 v167, v174, v173, 16
    v_mfma_f32_16x16x32_bf16 v[104:107], v[64:67], a[232:235], v[104:107]
    ds_read_b64_tr_b16 v[84:85], v23 offset:12288
    v_alignbit_b32 v168, v175, v174, 16
    v_mfma_f32_16x16x32_bf16 v[108:111], v[64:67], a[236:239], v[108:111]
    ds_read_b64_tr_b16 v[86:87], v23 offset:14336
    v_mov_b32 v172, v165
    v_mov_b32 v173, v166
    v_mfma_f32_16x16x32_bf16 v[112:115], v[68:71], a[224:227], v[112:115]
    ds_read_b64_tr_b16 v[88:89], v24 offset:12288
    v_mov_b32 v174, v167
    v_mov_b32 v175, v168
    v_mfma_f32_16x16x32_bf16 v[116:119], v[68:71], a[228:231], v[116:119]
    ds_read_b64_tr_b16 v[90:91], v24 offset:14336
    ds_write_b128 v4, v[172:175] offset:5200
    v_mfma_f32_16x16x32_bf16 v[120:123], v[68:71], a[232:235], v[120:123]
    ds_read_b64_tr_b16 v[92:93], v25 offset:12288
    v_alignbit_b32 v165, v176, v161, 16
    v_alignbit_b32 v166, v177, v176, 16
    v_mfma_f32_16x16x32_bf16 v[124:127], v[68:71], a[236:239], v[124:127]
    ds_read_b64_tr_b16 v[94:95], v25 offset:14336
    v_alignbit_b32 v167, v178, v177, 16
    v_alignbit_b32 v168, v179, v178, 16
    v_mfma_f32_16x16x32_bf16 v[128:131], v[72:75], a[224:227], v[128:131]
    v_mov_b32 v176, v165
    v_mfma_f32_16x16x32_bf16 v[132:135], v[72:75], a[228:231], v[132:135]
    v_mov_b32 v177, v166
    v_mov_b32 v178, v167
    v_mfma_f32_16x16x32_bf16 v[136:139], v[72:75], a[232:235], v[136:139]
    v_mov_b32 v179, v168
    v_mfma_f32_16x16x32_bf16 v[140:143], v[72:75], a[236:239], v[140:143]
    ds_write_b128 v4, v[176:179] offset:6224
    v_alignbit_b32 v165, v180, v162, 16
    v_mfma_f32_16x16x32_bf16 v[144:147], v[76:79], a[224:227], v[144:147]
    v_alignbit_b32 v166, v181, v180, 16
    v_alignbit_b32 v167, v182, v181, 16
    v_mfma_f32_16x16x32_bf16 v[148:151], v[76:79], a[228:231], v[148:151]
    v_alignbit_b32 v168, v183, v182, 16
    v_mfma_f32_16x16x32_bf16 v[152:155], v[76:79], a[232:235], v[152:155]
    v_mov_b32 v180, v165
    v_mov_b32 v181, v166
    v_mfma_f32_16x16x32_bf16 v[156:159], v[76:79], a[236:239], v[156:159]
    v_mov_b32 v182, v167
    v_mov_b32 v183, v168
    s_add_u32 s36, s40, 57344
    buffer_store_dwordx4 v[220:223], v33, s[16:19], s36 offen sc1
    s_waitcnt vmcnt(6) lgkmcnt(0)
    v_mfma_f32_16x16x32_bf16 v[96:99], v[80:83], a[240:243], v[96:99]
    ds_read_b64_tr_b16 v[64:65], v22 offset:0
    ds_write_b128 v4, v[180:183] offset:7248
    v_mfma_f32_16x16x32_bf16 v[100:103], v[80:83], a[244:247], v[100:103]
    ds_read_b64_tr_b16 v[66:67], v22 offset:2048
    v_alignbit_b32 v165, v184, v163, 16
    v_alignbit_b32 v166, v185, v184, 16
    v_mfma_f32_16x16x32_bf16 v[104:107], v[80:83], a[248:251], v[104:107]
    ds_read_b64_tr_b16 v[68:69], v23 offset:0
    v_alignbit_b32 v167, v186, v185, 16
    v_mfma_f32_16x16x32_bf16 v[108:111], v[80:83], a[252:255], v[108:111]
    ds_read_b64_tr_b16 v[70:71], v23 offset:2048
    v_alignbit_b32 v168, v187, v186, 16
    v_mov_b32 v184, v165
    v_mfma_f32_16x16x32_bf16 v[112:115], v[84:87], a[240:243], v[112:115]
    ds_read_b64_tr_b16 v[72:73], v24 offset:0
    v_mov_b32 v185, v166
    v_mov_b32 v186, v167
    v_mfma_f32_16x16x32_bf16 v[116:119], v[84:87], a[244:247], v[116:119]
    ds_read_b64_tr_b16 v[74:75], v24 offset:2048
    v_mov_b32 v187, v168
    v_mfma_f32_16x16x32_bf16 v[120:123], v[84:87], a[248:251], v[120:123]
    ds_read_b64_tr_b16 v[76:77], v25 offset:0
    ds_write_b128 v4, v[184:187] offset:8272
    v_alignbit_b32 v165, v188, v164, 16
    v_mfma_f32_16x16x32_bf16 v[124:127], v[84:87], a[252:255], v[124:127]
    ds_read_b64_tr_b16 v[78:79], v25 offset:2048
    v_alignbit_b32 v166, v189, v188, 16
    v_alignbit_b32 v167, v190, v189, 16
    v_mfma_f32_16x16x32_bf16 v[128:131], v[88:91], a[240:243], v[128:131]
    v_alignbit_b32 v168, v191, v190, 16
    v_mfma_f32_16x16x32_bf16 v[132:135], v[88:91], a[244:247], v[132:135]
    v_mov_b32 v188, v165
    v_mov_b32 v189, v166
    v_mfma_f32_16x16x32_bf16 v[136:139], v[88:91], a[248:251], v[136:139]
    v_mov_b32 v190, v167
    v_mfma_f32_16x16x32_bf16 v[140:143], v[88:91], a[252:255], v[140:143]
    v_mov_b32 v191, v168
    ds_write_b128 v4, v[188:191] offset:9296
    v_mfma_f32_16x16x32_bf16 v[144:147], v[92:95], a[240:243], v[144:147]
    v_mfma_f32_16x16x32_bf16 v[148:151], v[92:95], a[244:247], v[148:151]
    v_mfma_f32_16x16x32_bf16 v[152:155], v[92:95], a[248:251], v[152:155]
    v_mfma_f32_16x16x32_bf16 v[156:159], v[92:95], a[252:255], v[156:159]
    v_cmp_gt_u32 vcc, 64, v62
    s_mov_b32 s37, 0
    s_nop 3
    s_cbranch_vccz M_UT_READY
M_SPIN1:
    buffer_load_dword v62, v61, s[56:59], 0 offen sc1
    s_waitcnt vmcnt(0)
    v_cmp_gt_u32 vcc, 64, v62
    s_add_u32 s37, s37, 1
    s_cmp_ge_u32 s37, 50000
    s_cbranch_scc1 M_UT_READY
    s_cbranch_vccz M_UT_READY
    s_sleep 2
    s_branch M_SPIN1
M_UT_READY:
    s_min_u32 s37, s52, 575
    s_lshl_b32 s37, s37, 12
    buffer_load_dwordx4 v[176:179], v28, s[16:19], s37 offen offset:0 sc1
    buffer_load_dwordx4 v[180:183], v28, s[16:19], s37 offen offset:1024 sc1
    buffer_load_dwordx4 v[184:187], v28, s[16:19], s37 offen offset:2048 sc1
    buffer_load_dwordx4 v[188:191], v28, s[16:19], s37 offen offset:3072 sc1
    s_waitcnt vmcnt(5) lgkmcnt(0)
    v_mfma_f32_16x16x32_bf16 v[96:99], v[64:67], v[224:227], v[96:99]
    ds_read_b64_tr_b16 v[80:81], v22 offset:4096
    v_mfma_f32_16x16x32_bf16 v[100:103], v[64:67], v[228:231], v[100:103]
    ds_read_b64_tr_b16 v[82:83], v22 offset:6144
    v_mfma_f32_16x16x32_bf16 v[104:107], v[64:67], v[232:235], v[104:107]
    ds_read_b64_tr_b16 v[84:85], v23 offset:4096
    v_mfma_f32_16x16x32_bf16 v[108:111], v[64:67], v[236:239], v[108:111]
    ds_read_b64_tr_b16 v[86:87], v23 offset:6144
    v_mfma_f32_16x16x32_bf16 v[112:115], v[68:71], v[224:227], v[112:115]
    ds_read_b64_tr_b16 v[88:89], v24 offset:4096
    v_mfma_f32_16x16x32_bf16 v[116:119], v[68:71], v[228:231], v[116:119]
    ds_read_b64_tr_b16 v[90:91], v24 offset:6144
    v_mfma_f32_16x16x32_bf16 v[120:123], v[68:71], v[232:235], v[120:123]
    ds_read_b64_tr_b16 v[92:93], v25 offset:4096
    v_mfma_f32_16x16x32_bf16 v[124:127], v[68:71], v[236:239], v[124:127]
    ds_read_b64_tr_b16 v[94:95], v25 offset:6144
    v_mfma_f32_16x16x32_bf16 v[128:131], v[72:75], v[224:227], v[128:131]
    v_mfma_f32_16x16x32_bf16 v[132:135], v[72:75], v[228:231], v[132:135]
    v_mfma_f32_16x16x32_bf16 v[136:139], v[72:75], v[232:235], v[136:139]
    v_mfma_f32_16x16x32_bf16 v[140:143], v[72:75], v[236:239], v[140:143]
    v_mfma_f32_16x16x32_bf16 v[144:147], v[76:79], v[224:227], v[144:147]
    v_mfma_f32_16x16x32_bf16 v[148:151], v[76:79], v[228:231], v[148:151]
    v_mfma_f32_16x16x32_bf16 v[152:155], v[76:79], v[232:235], v[152:155]
    v_mfma_f32_16x16x32_bf16 v[156:159], v[76:79], v[236:239], v[156:159]
    s_waitcnt lgkmcnt(0)
    v_mfma_f32_16x16x32_bf16 v[96:99], v[80:83], v[240:243], v[96:99]
    v_mfma_f32_16x16x32_bf16 v[100:103], v[80:83], v[244:247], v[100:103]
    v_mfma_f32_16x16x32_bf16 v[104:107], v[80:83], v[248:251], v[104:107]
    v_mfma_f32_16x16x32_bf16 v[108:111], v[80:83], v[252:255], v[108:111]
    v_mfma_f32_16x16x32_bf16 v[112:115], v[84:87], v[240:243], v[112:115]
    v_mfma_f32_16x16x32_bf16 v[116:119], v[84:87], v[244:247], v[116:119]
    v_mfma_f32_16x16x32_bf16 v[120:123], v[84:87], v[248:251], v[120:123]
    v_mfma_f32_16x16x32_bf16 v[124:127], v[84:87], v[252:255], v[124:127]
    v_mfma_f32_16x16x32_bf16 v[128:131], v[88:91], v[240:243], v[128:131]
    v_mfma_f32_16x16x32_bf16 v[132:135], v[88:91], v[244:247], v[132:135]
    v_mfma_f32_16x16x32_bf16 v[136:139], v[88:91], v[248:251], v[136:139]
    v_mfma_f32_16x16x32_bf16 v[140:143], v[88:91], v[252:255], v[140:143]
    v_mfma_f32_16x16x32_bf16 v[144:147], v[92:95], v[240:243], v[144:147]
    v_mfma_f32_16x16x32_bf16 v[148:151], v[92:95], v[244:247], v[148:151]
    v_mfma_f32_16x16x32_bf16 v[152:155], v[92:95], v[248:251], v[152:155]
    v_mfma_f32_16x16x32_bf16 v[156:159], v[92:95], v[252:255], v[156:159]
    s_waitcnt vmcnt(4)
    v_mov_b32 v58, 1
    v_mov_b32 v59, 0
    s_mov_b64 exec, 1
    buffer_store_dword v58, v59, s[16:19], s3 offen sc1
    s_mov_b64 exec, -1
    v_mov_b32 v58, 1
    v_mov_b32 v59, 0
    s_mov_b64 exec, 1
    buffer_store_dword v58, v59, s[16:19], s101 offen sc1
    s_mov_b64 exec, -1
    s_nop 7
    v_cvt_pk_bf16_f32 v42, v96, v97
    v_cvt_pk_bf16_f32 v43, v98, v99
    v_cvt_pk_bf16_f32 v44, v112, v113
    v_cvt_pk_bf16_f32 v45, v114, v115
    s_add_u32 s36, s41, 0
    buffer_store_dwordx4 v[42:45], v33, s[16:19], s36 offen sc1
    v_cvt_pk_bf16_f32 v46, v100, v101
    v_cvt_pk_bf16_f32 v47, v102, v103
    v_cvt_pk_bf16_f32 v48, v116, v117
    v_cvt_pk_bf16_f32 v49, v118, v119
    s_add_u32 s36, s41, 8192
    buffer_store_dwordx4 v[46:49], v33, s[16:19], s36 offen sc1
    v_cvt_pk_bf16_f32 v42, v104, v105
    v_cvt_pk_bf16_f32 v43, v106, v107
    v_cvt_pk_bf16_f32 v44, v120, v121
    v_cvt_pk_bf16_f32 v45, v122, v123
    s_add_u32 s36, s41, 16384
    buffer_store_dwordx4 v[42:45], v33, s[16:19], s36 offen sc1
    v_cvt_pk_bf16_f32 v46, v108, v109
    v_cvt_pk_bf16_f32 v47, v110, v111
    v_cvt_pk_bf16_f32 v48, v124, v125
    v_cvt_pk_bf16_f32 v49, v126, v127
    s_add_u32 s36, s41, 24576
    buffer_store_dwordx4 v[46:49], v33, s[16:19], s36 offen sc1
    v_cvt_pk_bf16_f32 v42, v128, v129
    v_cvt_pk_bf16_f32 v43, v130, v131
    v_cvt_pk_bf16_f32 v44, v144, v145
    v_cvt_pk_bf16_f32 v45, v146, v147
    s_add_u32 s36, s41, 32768
    buffer_store_dwordx4 v[42:45], v33, s[16:19], s36 offen sc1
    v_cvt_pk_bf16_f32 v46, v132, v133
    v_cvt_pk_bf16_f32 v47, v134, v135
    v_cvt_pk_bf16_f32 v48, v148, v149
    v_cvt_pk_bf16_f32 v49, v150, v151
    s_add_u32 s36, s41, 40960
    buffer_store_dwordx4 v[46:49], v33, s[16:19], s36 offen sc1
    v_cvt_pk_bf16_f32 v42, v136, v137
    v_cvt_pk_bf16_f32 v43, v138, v139
    v_cvt_pk_bf16_f32 v44, v152, v153
    v_cvt_pk_bf16_f32 v45, v154, v155
    s_add_u32 s36, s41, 49152
    buffer_store_dwordx4 v[42:45], v33, s[16:19], s36 offen sc1
    v_cvt_pk_bf16_f32 v46, v140, v141
    v_cvt_pk_bf16_f32 v47, v142, v143
    v_cvt_pk_bf16_f32 v48, v156, v157
    v_cvt_pk_bf16_f32 v49, v158, v159
    s_add_u32 s36, s41, 57344
    buffer_store_dwordx4 v[46:49], v33, s[16:19], s36 offen sc1
    s_cmp_eq_u32 s54, 0
    s_cbranch_scc1 M_REDUCE
    s_mov_b32 s75, 0
    v_lshlrev_b32 v8, 4, v1
    v_add_u32 v8, s66, v8
    v_and_b32 v2, 15, v1
    v_lshrrev_b32 v3, 4, v1
    s_waitcnt vmcnt(10)
    ds_write_b128 v8, v[176:179] offset:480
    ds_write_b128 v8, v[180:183] offset:1504
    ds_write_b128 v8, v[184:187] offset:2528
    ds_write_b128 v8, v[188:191] offset:3552
    v_lshlrev_b32 v160, 5, v2
    v_lshl_add_u32 v160, v3, 4, v160
    v_add_u32 v160, s66, v160
    v_lshlrev_b32 v4, 3, v3
    v_sub_u32 v4, v4, v2
    v_lshlrev_b32 v4, 1, v4
    v_and_b32 v5, 1, v2
    v_cmp_eq_u32 vcc, 1, v5
    v_mov_b32 v6, 9264
    v_mov_b32 v7, 4078
    v_cndmask_b32 v6, v6, v7, vcc
    v_add_u32 v4, v4, v6
    v_add_u32 v4, s55, v4
    v_subrev_u32 v161, 960, v4
    v_subrev_u32 v162, 1984, v4
    v_subrev_u32 v163, 3008, v4
    v_subrev_u32 v164, 4032, v4
    v_lshlrev_b32 v4, 5, v2
    v_and_b32 v5, 1, v3
    v_lshl_add_u32 v4, v5, 9, v4
    v_lshrrev_b32 v5, 1, v3
    v_lshl_add_u32 v4, v5, 4, v4
    s_lshl_b32 s80, s52, 12
    s_add_u32 s80, s80, 2424832
    s_waitcnt lgkmcnt(0)
    ds_read_b128 a[28:31], v160 offset:448
    ds_read_b128 a[60:63], v160 offset:960
    ds_read_b128 a[92:95], v160 offset:1472
    ds_read_b128 a[124:127], v160 offset:1984
    ds_read_b128 a[156:159], v160 offset:2496
    ds_read_b128 a[188:191], v160 offset:3008
    ds_read_b128 a[220:223], v160 offset:3520
    ds_read_b128 a[252:255], v160 offset:4032
    ds_read2_b32 v[128:129], v161 offset0:240 offset1:241
    ds_read2_b32 v[130:131], v161 offset0:242 offset1:243
    ds_read2_b32 v[132:133], v161 offset0:224 offset1:225
    ds_read2_b32 v[134:135], v161 offset0:226 offset1:227
    ds_read2_b32 v[136:137], v161 offset0:208 offset1:209
    ds_read2_b32 v[138:139], v161 offset0:210 offset1:211
    s_waitcnt lgkmcnt(4)
    v_mfma_f32_16x16x32_bf16 v[96:99], v[128:131], a[28:31], 0
    ds_read2_b32 v[140:141], v161 offset0:192 offset1:193
    ds_read2_b32 v[142:143], v161 offset0:194 offset1:195
    v_mfma_f32_16x16x32_bf16 v[100:103], v[128:131], a[60:63], 0
    ds_read_b128 a[24:27], v160 offset:384
    ds_read_b128 a[56:59], v160 offset:896
    v_mfma_f32_16x16x32_bf16 v[104:107], v[128:131], a[92:95], 0
    ds_read_b128 a[88:91], v160 offset:1408
    v_mfma_f32_16x16x32_bf16 v[108:111], v[128:131], a[124:127], 0
    ds_read_b128 a[120:123], v160 offset:1920
    v_mfma_f32_16x16x32_bf16 v[112:115], v[128:131], a[156:159], 0
    ds_read_b128 a[152:155], v160 offset:2432
    v_mfma_f32_16x16x32_bf16 v[116:119], v[128:131], a[188:191], 0
    ds_read_b128 a[184:187], v160 offset:2944
    v_mfma_f32_16x16x32_bf16 v[120:123], v[128:131], a[220:223], 0
    ds_read_b128 a[216:219], v160 offset:3456
    v_mfma_f32_16x16x32_bf16 v[124:127], v[128:131], a[252:255], 0
    ds_read_b128 a[248:251], v160 offset:3968
    s_waitcnt lgkmcnt(0)
    v_mfma_f32_16x16x32_bf16 v[96:99], v[132:135], a[24:27], v[96:99]
    ds_read2_b32 v[144:145], v161 offset0:176 offset1:177
    ds_read2_b32 v[146:147], v161 offset0:178 offset1:179
    v_mfma_f32_16x16x32_bf16 v[100:103], v[132:135], a[56:59], v[100:103]
    ds_read_b128 a[20:23], v160 offset:320
    ds_read_b128 a[52:55], v160 offset:832
    v_mfma_f32_16x16x32_bf16 v[104:107], v[132:135], a[88:91], v[104:107]
    ds_read_b128 a[84:87], v160 offset:1344
    v_mfma_f32_16x16x32_bf16 v[108:111], v[132:135], a[120:123], v[108:111]
    ds_read_b128 a[116:119], v160 offset:1856
    v_mfma_f32_16x16x32_bf16 v[112:115], v[132:135], a[152:155], v[112:115]
    ds_read_b128 a[148:151], v160 offset:2368
    v_mfma_f32_16x16x32_bf16 v[116:119], v[132:135], a[184:187], v[116:119]
    ds_read_b128 a[180:183], v160 offset:2880
    v_mfma_f32_16x16x32_bf16 v[120:123], v[132:135], a[216:219], v[120:123]
    ds_read_b128 a[212:215], v160 offset:3392
    v_mfma_f32_16x16x32_bf16 v[124:127], v[132:135], a[248:251], v[124:127]
    ds_read_b128 a[244:247], v160 offset:3904
    s_waitcnt lgkmcnt(0)
    v_mfma_f32_16x16x32_bf16 v[96:99], v[136:139], a[20:23], v[96:99]
    ds_read2_b32 v[148:149], v161 offset0:160 offset1:161
    ds_read2_b32 v[150:151], v161 offset0:162 offset1:163
    v_mfma_f32_16x16x32_bf16 v[100:103], v[136:139], a[52:55], v[100:103]
    ds_read_b128 a[16:19], v160 offset:256
    ds_read_b128 a[48:51], v160 offset:768
    v_mfma_f32_16x16x32_bf16 v[104:107], v[136:139], a[84:87], v[104:107]
    ds_read_b128 a[80:83], v160 offset:1280
    v_mfma_f32_16x16x32_bf16 v[108:111], v[136:139], a[116:119], v[108:111]
    ds_read_b128 a[112:115], v160 offset:1792
    v_mfma_f32_16x16x32_bf16 v[112:115], v[136:139], a[148:151], v[112:115]
    ds_read_b128 a[144:147], v160 offset:2304
    v_mfma_f32_16x16x32_bf16 v[116:119], v[136:139], a[180:183], v[116:119]
    ds_read_b128 a[176:179], v160 offset:2816
    v_mfma_f32_16x16x32_bf16 v[120:123], v[136:139], a[212:215], v[120:123]
    ds_read_b128 a[208:211], v160 offset:3328
    v_mfma_f32_16x16x32_bf16 v[124:127], v[136:139], a[244:247], v[124:127]
    ds_read_b128 a[240:243], v160 offset:3840
    s_waitcnt lgkmcnt(0)
    v_mfma_f32_16x16x32_bf16 v[96:99], v[140:143], a[16:19], v[96:99]
    ds_read2_b32 v[152:153], v161 offset0:144 offset1:145
    ds_read2_b32 v[154:155], v161 offset0:146 offset1:147
    v_mfma_f32_16x16x32_bf16 v[100:103], v[140:143], a[48:51], v[100:103]
    ds_read_b128 a[12:15], v160 offset:192
    ds_read_b128 a[44:47], v160 offset:704
    v_mfma_f32_16x16x32_bf16 v[104:107], v[140:143], a[80:83], v[104:107]
    ds_read_b128 a[76:79], v160 offset:1216
    v_mfma_f32_16x16x32_bf16 v[108:111], v[140:143], a[112:115], v[108:111]
    ds_read_b128 a[108:111], v160 offset:1728
    v_mfma_f32_16x16x32_bf16 v[112:115], v[140:143], a[144:147], v[112:115]
    ds_read_b128 a[140:143], v160 offset:2240
    v_mfma_f32_16x16x32_bf16 v[116:119], v[140:143], a[176:179], v[116:119]
    ds_read_b128 a[172:175], v160 offset:2752
    v_mfma_f32_16x16x32_bf16 v[120:123], v[140:143], a[208:211], v[120:123]
    ds_read_b128 a[204:207], v160 offset:3264
    v_mfma_f32_16x16x32_bf16 v[124:127], v[140:143], a[240:243], v[124:127]
    ds_read_b128 a[236:239], v160 offset:3776
    s_waitcnt lgkmcnt(0)
    v_mfma_f32_16x16x32_bf16 v[96:99], v[144:147], a[12:15], v[96:99]
    ds_read2_b32 v[156:157], v161 offset0:128 offset1:129
    ds_read2_b32 v[158:159], v161 offset0:130 offset1:131
    v_mfma_f32_16x16x32_bf16 v[100:103], v[144:147], a[44:47], v[100:103]
    ds_read_b128 a[8:11], v160 offset:128
    ds_read_b128 a[40:43], v160 offset:640
    v_mfma_f32_16x16x32_bf16 v[104:107], v[144:147], a[76:79], v[104:107]
    ds_read_b128 a[72:75], v160 offset:1152
    v_mfma_f32_16x16x32_bf16 v[108:111], v[144:147], a[108:111], v[108:111]
    ds_read_b128 a[104:107], v160 offset:1664
    v_mfma_f32_16x16x32_bf16 v[112:115], v[144:147], a[140:143], v[112:115]
    ds_read_b128 a[136:139], v160 offset:2176
    v_mfma_f32_16x16x32_bf16 v[116:119], v[144:147], a[172:175], v[116:119]
    ds_read_b128 a[168:171], v160 offset:2688
    v_mfma_f32_16x16x32_bf16 v[120:123], v[144:147], a[204:207], v[120:123]
    ds_read_b128 a[200:203], v160 offset:3200
    v_mfma_f32_16x16x32_bf16 v[124:127], v[144:147], a[236:239], v[124:127]
    ds_read_b128 a[232:235], v160 offset:3712
    s_waitcnt lgkmcnt(0)
    v_mfma_f32_16x16x32_bf16 v[96:99], v[148:151], a[8:11], v[96:99]
    ds_read2_b32 v[128:129], v161 offset0:112 offset1:113
    ds_read2_b32 v[130:131], v161 offset0:114 offset1:115
    v_mfma_f32_16x16x32_bf16 v[100:103], v[148:151], a[40:43], v[100:103]
    ds_read_b128 a[4:7], v160 offset:64
    ds_read_b128 a[36:39], v160 offset:576
    v_mfma_f32_16x16x32_bf16 v[104:107], v[148:151], a[72:75], v[104:107]
    ds_read_b128 a[68:71], v160 offset:1088
    v_mfma_f32_16x16x32_bf16 v[108:111], v[148:151], a[104:107], v[108:111]
    ds_read_b128 a[100:103], v160 offset:1600
    v_mfma_f32_16x16x32_bf16 v[112:115], v[148:151], a[136:139], v[112:115]
    ds_read_b128 a[132:135], v160 offset:2112
    v_mfma_f32_16x16x32_bf16 v[116:119], v[148:151], a[168:171], v[116:119]
    ds_read_b128 a[164:167], v160 offset:2624
    v_mfma_f32_16x16x32_bf16 v[120:123], v[148:151], a[200:203], v[120:123]
    ds_read_b128 a[196:199], v160 offset:3136
    v_mfma_f32_16x16x32_bf16 v[124:127], v[148:151], a[232:235], v[124:127]
    ds_read_b128 a[228:231], v160 offset:3648
    s_waitcnt lgkmcnt(0)
    v_mfma_f32_16x16x32_bf16 v[96:99], v[152:155], a[4:7], v[96:99]
    ds_read2_b32 v[132:133], v161 offset0:96 offset1:97
    ds_read2_b32 v[134:135], v161 offset0:98 offset1:99
    v_mfma_f32_16x16x32_bf16 v[100:103], v[152:155], a[36:39], v[100:103]
    ds_read_b128 a[0:3], v160 offset:0
    ds_read_b128 a[32:35], v160 offset:512
    v_mfma_f32_16x16x32_bf16 v[104:107], v[152:155], a[68:71], v[104:107]
    ds_read_b128 a[64:67], v160 offset:1024
    v_mfma_f32_16x16x32_bf16 v[108:111], v[152:155], a[100:103], v[108:111]
    ds_read_b128 a[96:99], v160 offset:1536
    v_mfma_f32_16x16x32_bf16 v[112:115], v[152:155], a[132:135], v[112:115]
    ds_read_b128 a[128:131], v160 offset:2048
    v_mfma_f32_16x16x32_bf16 v[116:119], v[152:155], a[164:167], v[116:119]
    ds_read_b128 a[160:163], v160 offset:2560
    v_mfma_f32_16x16x32_bf16 v[120:123], v[152:155], a[196:199], v[120:123]
    ds_read_b128 a[192:195], v160 offset:3072
    v_mfma_f32_16x16x32_bf16 v[124:127], v[152:155], a[228:231], v[124:127]
    ds_read_b128 a[224:227], v160 offset:3584
    s_waitcnt lgkmcnt(0)
    v_mfma_f32_16x16x32_bf16 v[96:99], v[156:159], a[0:3], v[96:99]
    ds_read2_b32 v[136:137], v161 offset0:80 offset1:81
    v_mfma_f32_16x16x32_bf16 v[100:103], v[156:159], a[32:35], v[100:103]
    ds_read2_b32 v[138:139], v161 offset0:82 offset1:83
    v_mfma_f32_16x16x32_bf16 v[104:107], v[156:159], a[64:67], v[104:107]
    v_mfma_f32_16x16x32_bf16 v[108:111], v[156:159], a[96:99], v[108:111]
    v_mfma_f32_16x16x32_bf16 v[112:115], v[156:159], a[128:131], v[112:115]
    v_mfma_f32_16x16x32_bf16 v[116:119], v[156:159], a[160:163], v[116:119]
    v_mfma_f32_16x16x32_bf16 v[120:123], v[156:159], a[192:195], v[120:123]
    v_mfma_f32_16x16x32_bf16 v[124:127], v[156:159], a[224:227], v[124:127]
    v_mfma_f32_16x16x32_bf16 v[100:103], v[128:131], a[28:31], v[100:103]
    ds_read2_b32 v[140:141], v161 offset0:64 offset1:65
    v_mfma_f32_16x16x32_bf16 v[104:107], v[128:131], a[60:63], v[104:107]
    ds_read2_b32 v[142:143], v161 offset0:66 offset1:67
    v_mfma_f32_16x16x32_bf16 v[108:111], v[128:131], a[92:95], v[108:111]
    v_mfma_f32_16x16x32_bf16 v[112:115], v[128:131], a[124:127], v[112:115]
    v_mfma_f32_16x16x32_bf16 v[116:119], v[128:131], a[156:159], v[116:119]
    v_mfma_f32_16x16x32_bf16 v[120:123], v[128:131], a[188:191], v[120:123]
    v_mfma_f32_16x16x32_bf16 v[124:127], v[128:131], a[220:223], v[124:127]
    v_mfma_f32_16x16x32_bf16 v[100:103], v[132:135], a[24:27], v[100:103]
    ds_read2_b32 v[144:145], v161 offset0:48 offset1:49
    v_mfma_f32_16x16x32_bf16 v[104:107], v[132:135], a[56:59], v[104:107]
    ds_read2_b32 v[146:147], v161 offset0:50 offset1:51
    v_mfma_f32_16x16x32_bf16 v[108:111], v[132:135], a[88:91], v[108:111]
    v_mfma_f32_16x16x32_bf16 v[112:115], v[132:135], a[120:123], v[112:115]
    v_mfma_f32_16x16x32_bf16 v[116:119], v[132:135], a[152:155], v[116:119]
    v_mfma_f32_16x16x32_bf16 v[120:123], v[132:135], a[184:187], v[120:123]
    v_mfma_f32_16x16x32_bf16 v[124:127], v[132:135], a[216:219], v[124:127]
    s_waitcnt lgkmcnt(4)
    v_mfma_f32_16x16x32_bf16 v[100:103], v[136:139], a[20:23], v[100:103]
    ds_read2_b32 v[148:149], v161 offset0:32 offset1:33
    v_mfma_f32_16x16x32_bf16 v[104:107], v[136:139], a[52:55], v[104:107]
    ds_read2_b32 v[150:151], v161 offset0:34 offset1:35
    v_mfma_f32_16x16x32_bf16 v[108:111], v[136:139], a[84:87], v[108:111]
    v_mfma_f32_16x16x32_bf16 v[112:115], v[136:139], a[116:119], v[112:115]
    v_mfma_f32_16x16x32_bf16 v[116:119], v[136:139], a[148:151], v[116:119]
    v_mfma_f32_16x16x32_bf16 v[120:123], v[136:139], a[180:183], v[120:123]
    v_mfma_f32_16x16x32_bf16 v[124:127], v[136:139], a[212:215], v[124:127]
    s_waitcnt lgkmcnt(4)
    v_mfma_f32_16x16x32_bf16 v[100:103], v[140:143], a[16:19], v[100:103]
    ds_read2_b32 v[152:153], v161 offset0:16 offset1:17
    v_mfma_f32_16x16x32_bf16 v[104:107], v[140:143], a[48:51], v[104:107]
    ds_read2_b32 v[154:155], v161 offset0:18 offset1:19
    v_mfma_f32_16x16x32_bf16 v[108:111], v[140:143], a[80:83], v[108:111]
    v_mfma_f32_16x16x32_bf16 v[112:115], v[140:143], a[112:115], v[112:115]
    v_mfma_f32_16x16x32_bf16 v[116:119], v[140:143], a[144:147], v[116:119]
    v_mfma_f32_16x16x32_bf16 v[120:123], v[140:143], a[176:179], v[120:123]
    v_mfma_f32_16x16x32_bf16 v[124:127], v[140:143], a[208:211], v[124:127]
    s_waitcnt lgkmcnt(4)
    v_mfma_f32_16x16x32_bf16 v[100:103], v[144:147], a[12:15], v[100:103]
    ds_read2_b32 v[156:157], v161 offset0:0 offset1:1
    v_mfma_f32_16x16x32_bf16 v[104:107], v[144:147], a[44:47], v[104:107]
    ds_read2_b32 v[158:159], v161 offset0:2 offset1:3
    v_mfma_f32_16x16x32_bf16 v[108:111], v[144:147], a[76:79], v[108:111]
    v_mfma_f32_16x16x32_bf16 v[112:115], v[144:147], a[108:111], v[112:115]
    v_mfma_f32_16x16x32_bf16 v[116:119], v[144:147], a[140:143], v[116:119]
    v_mfma_f32_16x16x32_bf16 v[120:123], v[144:147], a[172:175], v[120:123]
    v_mfma_f32_16x16x32_bf16 v[124:127], v[144:147], a[204:207], v[124:127]
    s_waitcnt lgkmcnt(4)
    v_mfma_f32_16x16x32_bf16 v[100:103], v[148:151], a[8:11], v[100:103]
    ds_read2_b32 v[128:129], v162 offset0:240 offset1:241
    v_mfma_f32_16x16x32_bf16 v[104:107], v[148:151], a[40:43], v[104:107]
    ds_read2_b32 v[130:131], v162 offset0:242 offset1:243
    v_mfma_f32_16x16x32_bf16 v[108:111], v[148:151], a[72:75], v[108:111]
    v_mfma_f32_16x16x32_bf16 v[112:115], v[148:151], a[104:107], v[112:115]
    v_mfma_f32_16x16x32_bf16 v[116:119], v[148:151], a[136:139], v[116:119]
    v_mfma_f32_16x16x32_bf16 v[120:123], v[148:151], a[168:171], v[120:123]
    v_mfma_f32_16x16x32_bf16 v[124:127], v[148:151], a[200:203], v[124:127]
    s_waitcnt lgkmcnt(4)
    v_mfma_f32_16x16x32_bf16 v[100:103], v[152:155], a[4:7], v[100:103]
    ds_read2_b32 v[132:133], v162 offset0:224 offset1:225
    v_mfma_f32_16x16x32_bf16 v[104:107], v[152:155], a[36:39], v[104:107]
    ds_read2_b32 v[134:135], v162 offset0:226 offset1:227
    v_mfma_f32_16x16x32_bf16 v[108:111], v[152:155], a[68:71], v[108:111]
    v_mfma_f32_16x16x32_bf16 v[112:115], v[152:155], a[100:103], v[112:115]
    v_mfma_f32_16x16x32_bf16 v[116:119], v[152:155], a[132:135], v[116:119]
    v_mfma_f32_16x16x32_bf16 v[120:123], v[152:155], a[164:167], v[120:123]
    v_mfma_f32_16x16x32_bf16 v[124:127], v[152:155], a[196:199], v[124:127]
    s_waitcnt lgkmcnt(4)
    v_mfma_f32_16x16x32_bf16 v[100:103], v[156:159], a[0:3], v[100:103]
    ds_read2_b32 v[136:137], v162 offset0:208 offset1:209
    v_mfma_f32_16x16x32_bf16 v[104:107], v[156:159], a[32:35], v[104:107]
    ds_read2_b32 v[138:139], v162 offset0:210 offset1:211
    v_mfma_f32_16x16x32_bf16 v[108:111], v[156:159], a[64:67], v[108:111]
    v_mfma_f32_16x16x32_bf16 v[112:115], v[156:159], a[96:99], v[112:115]
    v_mfma_f32_16x16x32_bf16 v[116:119], v[156:159], a[128:131], v[116:119]
    v_mfma_f32_16x16x32_bf16 v[120:123], v[156:159], a[160:163], v[120:123]
    v_mfma_f32_16x16x32_bf16 v[124:127], v[156:159], a[192:195], v[124:127]
    s_waitcnt lgkmcnt(4)
    v_mfma_f32_16x16x32_bf16 v[104:107], v[128:131], a[28:31], v[104:107]
    ds_read2_b32 v[140:141], v162 offset0:192 offset1:193
    v_mfma_f32_16x16x32_bf16 v[108:111], v[128:131], a[60:63], v[108:111]
    ds_read2_b32 v[142:143], v162 offset0:194 offset1:195
    v_mfma_f32_16x16x32_bf16 v[112:115], v[128:131], a[92:95], v[112:115]
    v_mfma_f32_16x16x32_bf16 v[116:119], v[128:131], a[124:127], v[116:119]
    v_mfma_f32_16x16x32_bf16 v[120:123], v[128:131], a[156:159], v[120:123]
    v_mfma_f32_16x16x32_bf16 v[124:127], v[128:131], a[188:191], v[124:127]
    s_waitcnt vmcnt(0)
    v_mov_b32 v58, 1
    v_mov_b32 v59, 0
    s_mov_b64 exec, 1
    buffer_store_dword v58, v59, s[16:19], s100 offen sc1
    s_mov_b64 exec, -1
    s_waitcnt lgkmcnt(4)
    v_mfma_f32_16x16x32_bf16 v[104:107], v[132:135], a[24:27], v[104:107]
    ds_read2_b32 v[144:145], v162 offset0:176 offset1:177
    v_mfma_f32_16x16x32_bf16 v[108:111], v[132:135], a[56:59], v[108:111]
    ds_read2_b32 v[146:147], v162 offset0:178 offset1:179
    v_mfma_f32_16x16x32_bf16 v[112:115], v[132:135], a[88:91], v[112:115]
    v_mfma_f32_16x16x32_bf16 v[116:119], v[132:135], a[120:123], v[116:119]
    v_mfma_f32_16x16x32_bf16 v[120:123], v[132:135], a[152:155], v[120:123]
    v_mfma_f32_16x16x32_bf16 v[124:127], v[132:135], a[184:187], v[124:127]
    v_cvt_pk_bf16_f32 v44, v96, v97
    v_cvt_pk_bf16_f32 v45, v98, v99
    v_cvt_pk_bf16_f32 v46, v100, v101
    v_cvt_pk_bf16_f32 v47, v102, v103
    s_nop 1
    v_permlane16_swap_b32 v44, v46
    v_permlane16_swap_b32 v45, v47
    buffer_store_dwordx4 v[44:47], v4, s[16:19], s80 offen offset:0 sc1
    s_waitcnt lgkmcnt(4)
    v_mfma_f32_16x16x32_bf16 v[104:107], v[136:139], a[20:23], v[104:107]
    ds_read2_b32 v[148:149], v162 offset0:160 offset1:161
    v_mfma_f32_16x16x32_bf16 v[108:111], v[136:139], a[52:55], v[108:111]
    ds_read2_b32 v[150:151], v162 offset0:162 offset1:163
    v_mfma_f32_16x16x32_bf16 v[112:115], v[136:139], a[84:87], v[112:115]
    v_mfma_f32_16x16x32_bf16 v[116:119], v[136:139], a[116:119], v[116:119]
    v_mfma_f32_16x16x32_bf16 v[120:123], v[136:139], a[148:151], v[120:123]
    v_mfma_f32_16x16x32_bf16 v[124:127], v[136:139], a[180:183], v[124:127]
    s_waitcnt lgkmcnt(4)
    v_mfma_f32_16x16x32_bf16 v[104:107], v[140:143], a[16:19], v[104:107]
    ds_read2_b32 v[152:153], v162 offset0:144 offset1:145
    v_mfma_f32_16x16x32_bf16 v[108:111], v[140:143], a[48:51], v[108:111]
    ds_read2_b32 v[154:155], v162 offset0:146 offset1:147
    v_mfma_f32_16x16x32_bf16 v[112:115], v[140:143], a[80:83], v[112:115]
    v_mfma_f32_16x16x32_bf16 v[116:119], v[140:143], a[112:115], v[116:119]
    v_mfma_f32_16x16x32_bf16 v[120:123], v[140:143], a[144:147], v[120:123]
    v_mfma_f32_16x16x32_bf16 v[124:127], v[140:143], a[176:179], v[124:127]
    s_waitcnt lgkmcnt(4)
    v_mfma_f32_16x16x32_bf16 v[104:107], v[144:147], a[12:15], v[104:107]
    ds_read2_b32 v[156:157], v162 offset0:128 offset1:129
    v_mfma_f32_16x16x32_bf16 v[108:111], v[144:147], a[44:47], v[108:111]
    ds_read2_b32 v[158:159], v162 offset0:130 offset1:131
    v_mfma_f32_16x16x32_bf16 v[112:115], v[144:147], a[76:79], v[112:115]
    v_mfma_f32_16x16x32_bf16 v[116:119], v[144:147], a[108:111], v[116:119]
    v_mfma_f32_16x16x32_bf16 v[120:123], v[144:147], a[140:143], v[120:123]
    v_mfma_f32_16x16x32_bf16 v[124:127], v[144:147], a[172:175], v[124:127]
    s_waitcnt lgkmcnt(4)
    v_mfma_f32_16x16x32_bf16 v[104:107], v[148:151], a[8:11], v[104:107]
    ds_read2_b32 v[128:129], v162 offset0:112 offset1:113
    v_mfma_f32_16x16x32_bf16 v[108:111], v[148:151], a[40:43], v[108:111]
    ds_read2_b32 v[130:131], v162 offset0:114 offset1:115
    v_mfma_f32_16x16x32_bf16 v[112:115], v[148:151], a[72:75], v[112:115]
    v_mfma_f32_16x16x32_bf16 v[116:119], v[148:151], a[104:107], v[116:119]
    v_mfma_f32_16x16x32_bf16 v[120:123], v[148:151], a[136:139], v[120:123]
    v_mfma_f32_16x16x32_bf16 v[124:127], v[148:151], a[168:171], v[124:127]
    s_waitcnt lgkmcnt(4)
    v_mfma_f32_16x16x32_bf16 v[104:107], v[152:155], a[4:7], v[104:107]
    ds_read2_b32 v[132:133], v162 offset0:96 offset1:97
    v_mfma_f32_16x16x32_bf16 v[108:111], v[152:155], a[36:39], v[108:111]
    ds_read2_b32 v[134:135], v162 offset0:98 offset1:99
    v_mfma_f32_16x16x32_bf16 v[112:115], v[152:155], a[68:71], v[112:115]
    v_mfma_f32_16x16x32_bf16 v[116:119], v[152:155], a[100:103], v[116:119]
    v_mfma_f32_16x16x32_bf16 v[120:123], v[152:155], a[132:135], v[120:123]
    v_mfma_f32_16x16x32_bf16 v[124:127], v[152:155], a[164:167], v[124:127]
    s_waitcnt lgkmcnt(4)
    v_mfma_f32_16x16x32_bf16 v[104:107], v[156:159], a[0:3], v[104:107]
    ds_read2_b32 v[136:137], v162 offset0:80 offset1:81
    v_mfma_f32_16x16x32_bf16 v[108:111], v[156:159], a[32:35], v[108:111]
    ds_read2_b32 v[138:139], v162 offset0:82 offset1:83
    v_mfma_f32_16x16x32_bf16 v[112:115], v[156:159], a[64:67], v[112:115]
    v_mfma_f32_16x16x32_bf16 v[116:119], v[156:159], a[96:99], v[116:119]
    v_mfma_f32_16x16x32_bf16 v[120:123], v[156:159], a[128:131], v[120:123]
    v_mfma_f32_16x16x32_bf16 v[124:127], v[156:159], a[160:163], v[124:127]
    s_waitcnt lgkmcnt(4)
    v_mfma_f32_16x16x32_bf16 v[108:111], v[128:131], a[28:31], v[108:111]
    ds_read2_b32 v[140:141], v162 offset0:64 offset1:65
    v_mfma_f32_16x16x32_bf16 v[112:115], v[128:131], a[60:63], v[112:115]
    ds_read2_b32 v[142:143], v162 offset0:66 offset1:67
    v_mfma_f32_16x16x32_bf16 v[116:119], v[128:131], a[92:95], v[116:119]
    v_mfma_f32_16x16x32_bf16 v[120:123], v[128:131], a[124:127], v[120:123]
    v_mfma_f32_16x16x32_bf16 v[124:127], v[128:131], a[156:159], v[124:127]
    v_and_b32 v2, 15, v1
    v_lshrrev_b32 v3, 4, v1
    v_and_b32 v7, 1, v3
    v_lshlrev_b32 v7, 4, v7
    v_lshrrev_b32 v3, 1, v3
    v_lshl_add_u32 v3, v3, 3, v7
    s_lshl_b32 s36, s20, 4
    v_add_u32 v5, s36, v2
    s_lshr_b32 s37, s21, 1
    s_lshl_b32 s37, s37, 4
    v_add_u32 v6, s37, v2
    s_lshl_b32 s38, s22, 6
    v_add_u32 v10, s38, v5
    v_mul_u32_u24 v10, 1152, v10
    s_lshl_b32 s36, s21, 6
    v_add_u32 v12, s36, v3
    v_lshlrev_b32 v12, 1, v12
    v_add_u32 v10, v12, v10
    v_add_u32 v11, s38, v6
    v_mul_u32_u24 v11, 1152, v11
    s_and_b32 s36, s21, 1
    s_lshl_b32 s36, s36, 5
    s_add_u32 s36, s36, 512
    v_add_u32 v13, s36, v3
    v_lshlrev_b32 v13, 1, v13
    v_add_u32 v11, v13, v11
    buffer_load_dwordx4 v[192:195], v10, s[4:7], 0 offen offset:0
    buffer_load_dwordx4 v[204:207], v12, s[48:51], 0 offen offset:0
    buffer_load_dwordx4 v[196:199], v10, s[4:7], 0 offen offset:64
    buffer_load_dwordx4 v[208:211], v12, s[48:51], 0 offen offset:64
    buffer_load_dwordx4 v[200:203], v11, s[4:7], 0 offen offset:0
    buffer_load_dwordx4 v[212:215], v13, s[48:51], 0 offen offset:0
    v_lshlrev_b32 v5, 3, v5
    v_lshlrev_b32 v6, 3, v6
    v_add_u32 v5, 155648, v5
    v_add_u32 v6, 155648, v6
    ds_read_b64 v[216:217], v5
    ds_read_b64 v[218:219], v6
    s_waitcnt lgkmcnt(4)
    v_mfma_f32_16x16x32_bf16 v[108:111], v[132:135], a[24:27], v[108:111]
    ds_read2_b32 v[144:145], v162 offset0:48 offset1:49
    v_mfma_f32_16x16x32_bf16 v[112:115], v[132:135], a[56:59], v[112:115]
    ds_read2_b32 v[146:147], v162 offset0:50 offset1:51
    v_mfma_f32_16x16x32_bf16 v[116:119], v[132:135], a[88:91], v[116:119]
    v_mfma_f32_16x16x32_bf16 v[120:123], v[132:135], a[120:123], v[120:123]
    v_mfma_f32_16x16x32_bf16 v[124:127], v[132:135], a[152:155], v[124:127]
    s_waitcnt lgkmcnt(4)
    v_mfma_f32_16x16x32_bf16 v[108:111], v[136:139], a[20:23], v[108:111]
    ds_read2_b32 v[148:149], v162 offset0:32 offset1:33
    v_mfma_f32_16x16x32_bf16 v[112:115], v[136:139], a[52:55], v[112:115]
    ds_read2_b32 v[150:151], v162 offset0:34 offset1:35
    v_mfma_f32_16x16x32_bf16 v[116:119], v[136:139], a[84:87], v[116:119]
    v_mfma_f32_16x16x32_bf16 v[120:123], v[136:139], a[116:119], v[120:123]
    v_mfma_f32_16x16x32_bf16 v[124:127], v[136:139], a[148:151], v[124:127]
    s_waitcnt lgkmcnt(4)
    v_mfma_f32_16x16x32_bf16 v[108:111], v[140:143], a[16:19], v[108:111]
    ds_read2_b32 v[152:153], v162 offset0:16 offset1:17
    v_mfma_f32_16x16x32_bf16 v[112:115], v[140:143], a[48:51], v[112:115]
    ds_read2_b32 v[154:155], v162 offset0:18 offset1:19
    v_mfma_f32_16x16x32_bf16 v[116:119], v[140:143], a[80:83], v[116:119]
    v_mfma_f32_16x16x32_bf16 v[120:123], v[140:143], a[112:115], v[120:123]
    v_mfma_f32_16x16x32_bf16 v[124:127], v[140:143], a[144:147], v[124:127]
    s_waitcnt lgkmcnt(4)
    v_mfma_f32_16x16x32_bf16 v[108:111], v[144:147], a[12:15], v[108:111]
    ds_read2_b32 v[156:157], v162 offset0:0 offset1:1
    v_mfma_f32_16x16x32_bf16 v[112:115], v[144:147], a[44:47], v[112:115]
    ds_read2_b32 v[158:159], v162 offset0:2 offset1:3
    v_mfma_f32_16x16x32_bf16 v[116:119], v[144:147], a[76:79], v[116:119]
    v_mfma_f32_16x16x32_bf16 v[120:123], v[144:147], a[108:111], v[120:123]
    v_mfma_f32_16x16x32_bf16 v[124:127], v[144:147], a[140:143], v[124:127]
    s_waitcnt lgkmcnt(4)
    v_mfma_f32_16x16x32_bf16 v[108:111], v[148:151], a[8:11], v[108:111]
    ds_read2_b32 v[128:129], v163 offset0:240 offset1:241
    v_mfma_f32_16x16x32_bf16 v[112:115], v[148:151], a[40:43], v[112:115]
    ds_read2_b32 v[130:131], v163 offset0:242 offset1:243
    v_mfma_f32_16x16x32_bf16 v[116:119], v[148:151], a[72:75], v[116:119]
    v_mfma_f32_16x16x32_bf16 v[120:123], v[148:151], a[104:107], v[120:123]
    v_mfma_f32_16x16x32_bf16 v[124:127], v[148:151], a[136:139], v[124:127]
    s_waitcnt lgkmcnt(4)
    v_mfma_f32_16x16x32_bf16 v[108:111], v[152:155], a[4:7], v[108:111]
    ds_read2_b32 v[132:133], v163 offset0:224 offset1:225
    v_mfma_f32_16x16x32_bf16 v[112:115], v[152:155], a[36:39], v[112:115]
    ds_read2_b32 v[134:135], v163 offset0:226 offset1:227
    v_mfma_f32_16x16x32_bf16 v[116:119], v[152:155], a[68:71], v[116:119]
    v_mfma_f32_16x16x32_bf16 v[120:123], v[152:155], a[100:103], v[120:123]
    v_mfma_f32_16x16x32_bf16 v[124:127], v[152:155], a[132:135], v[124:127]
    s_waitcnt lgkmcnt(4)
    v_mfma_f32_16x16x32_bf16 v[108:111], v[156:159], a[0:3], v[108:111]
    ds_read2_b32 v[136:137], v163 offset0:208 offset1:209
    v_mfma_f32_16x16x32_bf16 v[112:115], v[156:159], a[32:35], v[112:115]
    ds_read2_b32 v[138:139], v163 offset0:210 offset1:211
    v_mfma_f32_16x16x32_bf16 v[116:119], v[156:159], a[64:67], v[116:119]
    v_mfma_f32_16x16x32_bf16 v[120:123], v[156:159], a[96:99], v[120:123]
    v_mfma_f32_16x16x32_bf16 v[124:127], v[156:159], a[128:131], v[124:127]
    s_waitcnt lgkmcnt(4)
    v_mfma_f32_16x16x32_bf16 v[112:115], v[128:131], a[28:31], v[112:115]
    ds_read2_b32 v[140:141], v163 offset0:192 offset1:193
    v_mfma_f32_16x16x32_bf16 v[116:119], v[128:131], a[60:63], v[116:119]
    ds_read2_b32 v[142:143], v163 offset0:194 offset1:195
    v_mfma_f32_16x16x32_bf16 v[120:123], v[128:131], a[92:95], v[120:123]
    v_mfma_f32_16x16x32_bf16 v[124:127], v[128:131], a[124:127], v[124:127]
    s_waitcnt lgkmcnt(4)
    v_mfma_f32_16x16x32_bf16 v[112:115], v[132:135], a[24:27], v[112:115]
    ds_read2_b32 v[144:145], v163 offset0:176 offset1:177
    v_mfma_f32_16x16x32_bf16 v[116:119], v[132:135], a[56:59], v[116:119]
    ds_read2_b32 v[146:147], v163 offset0:178 offset1:179
    v_mfma_f32_16x16x32_bf16 v[120:123], v[132:135], a[88:91], v[120:123]
    v_mfma_f32_16x16x32_bf16 v[124:127], v[132:135], a[120:123], v[124:127]
    v_cvt_pk_bf16_f32 v48, v104, v105
    v_cvt_pk_bf16_f32 v49, v106, v107
    v_cvt_pk_bf16_f32 v50, v108, v109
    v_cvt_pk_bf16_f32 v51, v110, v111
    s_nop 1
    v_permlane16_swap_b32 v48, v50
    v_permlane16_swap_b32 v49, v51
    buffer_store_dwordx4 v[48:51], v4, s[16:19], s80 offen offset:1024 sc1
    s_waitcnt lgkmcnt(4)
    v_mfma_f32_16x16x32_bf16 v[112:115], v[136:139], a[20:23], v[112:115]
    ds_read2_b32 v[148:149], v163 offset0:160 offset1:161
    v_mfma_f32_16x16x32_bf16 v[116:119], v[136:139], a[52:55], v[116:119]
    ds_read2_b32 v[150:151], v163 offset0:162 offset1:163
    v_mfma_f32_16x16x32_bf16 v[120:123], v[136:139], a[84:87], v[120:123]
    v_mfma_f32_16x16x32_bf16 v[124:127], v[136:139], a[116:119], v[124:127]
    s_waitcnt lgkmcnt(4)
    v_mfma_f32_16x16x32_bf16 v[112:115], v[140:143], a[16:19], v[112:115]
    ds_read2_b32 v[152:153], v163 offset0:144 offset1:145
    v_mfma_f32_16x16x32_bf16 v[116:119], v[140:143], a[48:51], v[116:119]
    ds_read2_b32 v[154:155], v163 offset0:146 offset1:147
    v_mfma_f32_16x16x32_bf16 v[120:123], v[140:143], a[80:83], v[120:123]
    v_mfma_f32_16x16x32_bf16 v[124:127], v[140:143], a[112:115], v[124:127]
    s_waitcnt lgkmcnt(4)
    v_mfma_f32_16x16x32_bf16 v[112:115], v[144:147], a[12:15], v[112:115]
    ds_read2_b32 v[156:157], v163 offset0:128 offset1:129
    v_mfma_f32_16x16x32_bf16 v[116:119], v[144:147], a[44:47], v[116:119]
    ds_read2_b32 v[158:159], v163 offset0:130 offset1:131
    v_mfma_f32_16x16x32_bf16 v[120:123], v[144:147], a[76:79], v[120:123]
    v_mfma_f32_16x16x32_bf16 v[124:127], v[144:147], a[108:111], v[124:127]
    s_waitcnt lgkmcnt(4)
    v_mfma_f32_16x16x32_bf16 v[112:115], v[148:151], a[8:11], v[112:115]
    ds_read2_b32 v[128:129], v163 offset0:112 offset1:113
    v_mfma_f32_16x16x32_bf16 v[116:119], v[148:151], a[40:43], v[116:119]
    ds_read2_b32 v[130:131], v163 offset0:114 offset1:115
    v_mfma_f32_16x16x32_bf16 v[120:123], v[148:151], a[72:75], v[120:123]
    v_mfma_f32_16x16x32_bf16 v[124:127], v[148:151], a[104:107], v[124:127]
    s_waitcnt lgkmcnt(4)
    v_mfma_f32_16x16x32_bf16 v[112:115], v[152:155], a[4:7], v[112:115]
    ds_read2_b32 v[132:133], v163 offset0:96 offset1:97
    v_mfma_f32_16x16x32_bf16 v[116:119], v[152:155], a[36:39], v[116:119]
    ds_read2_b32 v[134:135], v163 offset0:98 offset1:99
    v_mfma_f32_16x16x32_bf16 v[120:123], v[152:155], a[68:71], v[120:123]
    v_mfma_f32_16x16x32_bf16 v[124:127], v[152:155], a[100:103], v[124:127]
    s_waitcnt lgkmcnt(4)
    v_mfma_f32_16x16x32_bf16 v[112:115], v[156:159], a[0:3], v[112:115]
    ds_read2_b32 v[136:137], v163 offset0:80 offset1:81
    v_mfma_f32_16x16x32_bf16 v[116:119], v[156:159], a[32:35], v[116:119]
    ds_read2_b32 v[138:139], v163 offset0:82 offset1:83
    v_mfma_f32_16x16x32_bf16 v[120:123], v[156:159], a[64:67], v[120:123]
    v_mfma_f32_16x16x32_bf16 v[124:127], v[156:159], a[96:99], v[124:127]
    s_waitcnt lgkmcnt(4)
    v_mfma_f32_16x16x32_bf16 v[116:119], v[128:131], a[28:31], v[116:119]
    ds_read2_b32 v[140:141], v163 offset0:64 offset1:65
    v_mfma_f32_16x16x32_bf16 v[120:123], v[128:131], a[60:63], v[120:123]
    ds_read2_b32 v[142:143], v163 offset0:66 offset1:67
    v_mfma_f32_16x16x32_bf16 v[124:127], v[128:131], a[92:95], v[124:127]
    s_waitcnt lgkmcnt(4)
    v_mfma_f32_16x16x32_bf16 v[116:119], v[132:135], a[24:27], v[116:119]
    ds_read2_b32 v[144:145], v163 offset0:48 offset1:49
    v_mfma_f32_16x16x32_bf16 v[120:123], v[132:135], a[56:59], v[120:123]
    ds_read2_b32 v[146:147], v163 offset0:50 offset1:51
    v_mfma_f32_16x16x32_bf16 v[124:127], v[132:135], a[88:91], v[124:127]
    s_waitcnt lgkmcnt(4)
    v_mfma_f32_16x16x32_bf16 v[116:119], v[136:139], a[20:23], v[116:119]
    ds_read2_b32 v[148:149], v163 offset0:32 offset1:33
    v_mfma_f32_16x16x32_bf16 v[120:123], v[136:139], a[52:55], v[120:123]
    ds_read2_b32 v[150:151], v163 offset0:34 offset1:35
    v_mfma_f32_16x16x32_bf16 v[124:127], v[136:139], a[84:87], v[124:127]
    s_waitcnt lgkmcnt(4)
    v_mfma_f32_16x16x32_bf16 v[116:119], v[140:143], a[16:19], v[116:119]
    ds_read2_b32 v[152:153], v163 offset0:16 offset1:17
    v_mfma_f32_16x16x32_bf16 v[120:123], v[140:143], a[48:51], v[120:123]
    ds_read2_b32 v[154:155], v163 offset0:18 offset1:19
    v_mfma_f32_16x16x32_bf16 v[124:127], v[140:143], a[80:83], v[124:127]
    s_waitcnt lgkmcnt(4)
    v_mfma_f32_16x16x32_bf16 v[116:119], v[144:147], a[12:15], v[116:119]
    ds_read2_b32 v[156:157], v163 offset0:0 offset1:1
    v_mfma_f32_16x16x32_bf16 v[120:123], v[144:147], a[44:47], v[120:123]
    ds_read2_b32 v[158:159], v163 offset0:2 offset1:3
    v_mfma_f32_16x16x32_bf16 v[124:127], v[144:147], a[76:79], v[124:127]
    s_waitcnt lgkmcnt(4)
    v_mfma_f32_16x16x32_bf16 v[116:119], v[148:151], a[8:11], v[116:119]
    ds_read2_b32 v[128:129], v164 offset0:240 offset1:241
    v_mfma_f32_16x16x32_bf16 v[120:123], v[148:151], a[40:43], v[120:123]
    ds_read2_b32 v[130:131], v164 offset0:242 offset1:243
    v_mfma_f32_16x16x32_bf16 v[124:127], v[148:151], a[72:75], v[124:127]
    s_waitcnt lgkmcnt(4)
    v_mfma_f32_16x16x32_bf16 v[116:119], v[152:155], a[4:7], v[116:119]
    ds_read2_b32 v[132:133], v164 offset0:224 offset1:225
    v_mfma_f32_16x16x32_bf16 v[120:123], v[152:155], a[36:39], v[120:123]
    ds_read2_b32 v[134:135], v164 offset0:226 offset1:227
    v_mfma_f32_16x16x32_bf16 v[124:127], v[152:155], a[68:71], v[124:127]
    s_waitcnt lgkmcnt(4)
    v_mfma_f32_16x16x32_bf16 v[116:119], v[156:159], a[0:3], v[116:119]
    ds_read2_b32 v[136:137], v164 offset0:208 offset1:209
    v_mfma_f32_16x16x32_bf16 v[120:123], v[156:159], a[32:35], v[120:123]
    ds_read2_b32 v[138:139], v164 offset0:210 offset1:211
    v_mfma_f32_16x16x32_bf16 v[124:127], v[156:159], a[64:67], v[124:127]
    s_waitcnt lgkmcnt(4)
    v_mfma_f32_16x16x32_bf16 v[120:123], v[128:131], a[28:31], v[120:123]
    ds_read2_b32 v[140:141], v164 offset0:192 offset1:193
    v_mfma_f32_16x16x32_bf16 v[124:127], v[128:131], a[60:63], v[124:127]
    ds_read2_b32 v[142:143], v164 offset0:194 offset1:195
    s_waitcnt lgkmcnt(4)
    v_mfma_f32_16x16x32_bf16 v[120:123], v[132:135], a[24:27], v[120:123]
    ds_read2_b32 v[144:145], v164 offset0:176 offset1:177
    v_mfma_f32_16x16x32_bf16 v[124:127], v[132:135], a[56:59], v[124:127]
    ds_read2_b32 v[146:147], v164 offset0:178 offset1:179
    v_cvt_pk_bf16_f32 v44, v112, v113
    v_cvt_pk_bf16_f32 v45, v114, v115
    v_cvt_pk_bf16_f32 v46, v116, v117
    v_cvt_pk_bf16_f32 v47, v118, v119
    s_nop 1
    v_permlane16_swap_b32 v44, v46
    v_permlane16_swap_b32 v45, v47
    buffer_store_dwordx4 v[44:47], v4, s[16:19], s80 offen offset:2048 sc1
    s_waitcnt lgkmcnt(4)
    v_mfma_f32_16x16x32_bf16 v[120:123], v[136:139], a[20:23], v[120:123]
    ds_read2_b32 v[148:149], v164 offset0:160 offset1:161
    v_mfma_f32_16x16x32_bf16 v[124:127], v[136:139], a[52:55], v[124:127]
    ds_read2_b32 v[150:151], v164 offset0:162 offset1:163
    s_waitcnt lgkmcnt(4)
    v_mfma_f32_16x16x32_bf16 v[120:123], v[140:143], a[16:19], v[120:123]
    ds_read2_b32 v[152:153], v164 offset0:144 offset1:145
    v_mfma_f32_16x16x32_bf16 v[124:127], v[140:143], a[48:51], v[124:127]
    ds_read2_b32 v[154:155], v164 offset0:146 offset1:147
    s_waitcnt lgkmcnt(4)
    v_mfma_f32_16x16x32_bf16 v[120:123], v[144:147], a[12:15], v[120:123]
    ds_read2_b32 v[156:157], v164 offset0:128 offset1:129
    v_mfma_f32_16x16x32_bf16 v[124:127], v[144:147], a[44:47], v[124:127]
    ds_read2_b32 v[158:159], v164 offset0:130 offset1:131
    s_waitcnt lgkmcnt(4)
    v_mfma_f32_16x16x32_bf16 v[120:123], v[148:151], a[8:11], v[120:123]
    ds_read2_b32 v[128:129], v164 offset0:112 offset1:113
    v_mfma_f32_16x16x32_bf16 v[124:127], v[148:151], a[40:43], v[124:127]
    ds_read2_b32 v[130:131], v164 offset0:114 offset1:115
    s_waitcnt lgkmcnt(4)
    v_mfma_f32_16x16x32_bf16 v[120:123], v[152:155], a[4:7], v[120:123]
    ds_read2_b32 v[132:133], v164 offset0:96 offset1:97
    v_mfma_f32_16x16x32_bf16 v[124:127], v[152:155], a[36:39], v[124:127]
    ds_read2_b32 v[134:135], v164 offset0:98 offset1:99
    s_waitcnt lgkmcnt(4)
    v_mfma_f32_16x16x32_bf16 v[120:123], v[156:159], a[0:3], v[120:123]
    ds_read2_b32 v[136:137], v164 offset0:80 offset1:81
    v_mfma_f32_16x16x32_bf16 v[124:127], v[156:159], a[32:35], v[124:127]
    ds_read2_b32 v[138:139], v164 offset0:82 offset1:83
    s_waitcnt lgkmcnt(4)
    v_mfma_f32_16x16x32_bf16 v[124:127], v[128:131], a[28:31], v[124:127]
    ds_read2_b32 v[140:141], v164 offset0:64 offset1:65
    ds_read2_b32 v[142:143], v164 offset0:66 offset1:67
    s_waitcnt lgkmcnt(4)
    v_mfma_f32_16x16x32_bf16 v[124:127], v[132:135], a[24:27], v[124:127]
    ds_read2_b32 v[144:145], v164 offset0:48 offset1:49
    ds_read2_b32 v[146:147], v164 offset0:50 offset1:51
    s_waitcnt lgkmcnt(4)
    v_mfma_f32_16x16x32_bf16 v[124:127], v[136:139], a[20:23], v[124:127]
    ds_read2_b32 v[148:149], v164 offset0:32 offset1:33
    ds_read2_b32 v[150:151], v164 offset0:34 offset1:35
    s_waitcnt lgkmcnt(4)
    v_mfma_f32_16x16x32_bf16 v[124:127], v[140:143], a[16:19], v[124:127]
    ds_read2_b32 v[152:153], v164 offset0:16 offset1:17
    ds_read2_b32 v[154:155], v164 offset0:18 offset1:19
    s_waitcnt lgkmcnt(4)
    v_mfma_f32_16x16x32_bf16 v[124:127], v[144:147], a[12:15], v[124:127]
    ds_read2_b32 v[156:157], v164 offset0:0 offset1:1
    ds_read2_b32 v[158:159], v164 offset0:2 offset1:3
    s_waitcnt lgkmcnt(4)
    v_mfma_f32_16x16x32_bf16 v[124:127], v[148:151], a[8:11], v[124:127]
    s_waitcnt lgkmcnt(2)
    v_mfma_f32_16x16x32_bf16 v[124:127], v[152:155], a[4:7], v[124:127]
    s_waitcnt lgkmcnt(0)
    v_mfma_f32_16x16x32_bf16 v[124:127], v[156:159], a[0:3], v[124:127]
    s_nop 7
    v_cvt_pk_bf16_f32 v48, v120, v121
    v_cvt_pk_bf16_f32 v49, v122, v123
    v_cvt_pk_bf16_f32 v50, v124, v125
    v_cvt_pk_bf16_f32 v51, v126, v127
    s_nop 1
    v_permlane16_swap_b32 v48, v50
    v_permlane16_swap_b32 v49, v51
    buffer_store_dwordx4 v[48:51], v4, s[16:19], s80 offen offset:3072 sc1
    s_waitcnt vmcnt(3)
    s_branch M_WAIT_WORD
M_REDUCE:
    s_mov_b32 s75, 0
    s_waitcnt vmcnt(0) lgkmcnt(0)
    v_mov_b32 v58, 1
    v_mov_b32 v59, 0
    s_mov_b64 exec, 1
    buffer_store_dword v58, v59, s[16:19], s100 offen sc1
    s_mov_b64 exec, -1
    v_and_b32 v2, 15, v1
    v_lshrrev_b32 v3, 4, v1
    v_and_b32 v7, 1, v3
    v_lshlrev_b32 v7, 4, v7
    v_lshrrev_b32 v3, 1, v3
    v_lshl_add_u32 v3, v3, 3, v7
    s_lshl_b32 s36, s20, 4
    v_add_u32 v5, s36, v2
    s_lshr_b32 s37, s21, 1
    s_lshl_b32 s37, s37, 4
    v_add_u32 v6, s37, v2
    s_lshl_b32 s38, s22, 6
    v_add_u32 v10, s38, v5
    v_mul_u32_u24 v10, 1152, v10
    s_lshl_b32 s36, s21, 6
    v_add_u32 v12, s36, v3
    v_lshlrev_b32 v12, 1, v12
    v_add_u32 v10, v12, v10
    v_add_u32 v11, s38, v6
    v_mul_u32_u24 v11, 1152, v11
    s_and_b32 s36, s21, 1
    s_lshl_b32 s36, s36, 5
    s_add_u32 s36, s36, 512
    v_add_u32 v13, s36, v3
    v_lshlrev_b32 v13, 1, v13
    v_add_u32 v11, v13, v11
    buffer_load_dwordx4 v[192:195], v10, s[4:7], 0 offen offset:0
    buffer_load_dwordx4 v[204:207], v12, s[48:51], 0 offen offset:0
    buffer_load_dwordx4 v[196:199], v10, s[4:7], 0 offen offset:64
    buffer_load_dwordx4 v[208:211], v12, s[48:51], 0 offen offset:64
    buffer_load_dwordx4 v[200:203], v11, s[4:7], 0 offen offset:0
    buffer_load_dwordx4 v[212:215], v13, s[48:51], 0 offen offset:0
    v_lshlrev_b32 v5, 3, v5
    v_lshlrev_b32 v6, 3, v6
    v_add_u32 v5, 155648, v5
    v_add_u32 v6, 155648, v6
    ds_read_b64 v[216:217], v5
    ds_read_b64 v[218:219], v6
    s_waitcnt vmcnt(0)
    s_cmp_lg_u32 s20, 3
    s_cbranch_scc1 M_WAIT_WORD
    s_lshl_b32 s36, s22, 3
    s_add_u32 s36, s36, s21
    s_lshl_b32 s36, s36, 5
    s_add_u32 s36, s36, 2379776
    s_and_b32 s37, s21, 1
    s_lshr_b32 s38, s21, 2
    s_lshl_b32 s38, s38, 1
    s_add_u32 s37, s37, s38
    s_lshl_b32 s38, s22, 2
    s_add_u32 s37, s37, s38
    s_lshl_b32 s37, s37, 5
    s_add_u32 s37, s37, 2392064
    v_and_b32 v2, 7, v1
    v_lshlrev_b32 v2, 2, v2
    v_mov_b32 v3, s36
    v_mov_b32 v4, s37
    v_cmp_gt_u32 vcc, 32, v1
    s_nop 1
    v_cndmask_b32 v3, v4, v3, vcc
    v_add_u32 v2, v2, v3
    s_mov_b32 s36, 0
M_SPIN3:
    buffer_load_dword v3, v2, s[16:19], 0 offen sc1
    s_waitcnt vmcnt(0)
    v_cmp_ne_u32 vcc, 1, v3
    s_add_u32 s36, s36, 1
    s_cmp_ge_u32 s36, 50000
    s_cbranch_scc1 M_SPIN3_DONE
    s_cbranch_vccz M_SPIN3_DONE
    s_sleep 3
    s_branch M_SPIN3
M_SPIN3_DONE:
    v_mov_b32 v2, 1
    v_mov_b32 v3, 156160
    ds_write_b32 v3, v2
    s_branch M_S3_OK
M_WAIT_WORD:
    v_mov_b32 v3, 156160
    s_mov_b32 s36, 0
M_SPIN3W:
    ds_read_b32 v2, v3
    s_waitcnt lgkmcnt(0)
    v_cmp_ne_u32 vcc, 1, v2
    s_add_u32 s36, s36, 1
    s_cmp_ge_u32 s36, 400000
    s_cbranch_scc1 M_S3_OK
    s_cbranch_vccz M_S3_OK
    s_sleep 1
    s_branch M_SPIN3W
M_S3_OK:
    v_lshlrev_b32 v9, 4, v1
    s_mul_i32 s72, s22, 589824
    s_add_u32 s72, s72, 5242880
    s_lshl_b32 s74, s21, 3
    s_add_u32 s74, s74, s20
    s_lshl_b32 s74, s74, 13
    s_add_u32 s74, s74, s72
    s_add_u32 s37, s74, 4096
    buffer_load_dwordx4 a[128:131], v9, s[16:19], s74 offen offset:0 sc1
    buffer_load_dwordx4 a[132:135], v9, s[16:19], s74 offen offset:1024 sc1
    buffer_load_dwordx4 a[136:139], v9, s[16:19], s74 offen offset:2048 sc1
    buffer_load_dwordx4 a[140:143], v9, s[16:19], s74 offen offset:3072 sc1
    buffer_load_dwordx4 a[144:147], v9, s[16:19], s37 offen offset:0 sc1
    buffer_load_dwordx4 a[148:151], v9, s[16:19], s37 offen offset:1024 sc1
    buffer_load_dwordx4 a[152:155], v9, s[16:19], s37 offen offset:2048 sc1
    buffer_load_dwordx4 a[156:159], v9, s[16:19], s37 offen offset:3072 sc1
    s_lshl_b32 s74, s21, 3
    s_add_u32 s74, s74, s20
    s_add_u32 s74, s74, 4
    s_lshl_b32 s74, s74, 13
    s_add_u32 s74, s74, s72
    s_add_u32 s37, s74, 4096
    buffer_load_dwordx4 a[160:163], v9, s[16:19], s74 offen offset:0 sc1
    buffer_load_dwordx4 a[164:167], v9, s[16:19], s74 offen offset:1024 sc1
    buffer_load_dwordx4 a[168:171], v9, s[16:19], s74 offen offset:2048 sc1
    buffer_load_dwordx4 a[172:175], v9, s[16:19], s74 offen offset:3072 sc1
    buffer_load_dwordx4 a[176:179], v9, s[16:19], s37 offen offset:0 sc1
    buffer_load_dwordx4 a[180:183], v9, s[16:19], s37 offen offset:1024 sc1
    buffer_load_dwordx4 a[184:187], v9, s[16:19], s37 offen offset:2048 sc1
    buffer_load_dwordx4 a[188:191], v9, s[16:19], s37 offen offset:3072 sc1
    s_cmp_lg_u32 s20, 3
    s_cbranch_scc1 M_TWO
    s_and_b32 s36, s21, 1
    s_lshl_b32 s36, s36, 2
    s_lshr_b32 s37, s21, 1
    s_add_u32 s74, s36, s37
    s_add_u32 s74, s74, 64
    s_lshl_b32 s74, s74, 13
    s_add_u32 s74, s74, s72
    s_add_u32 s37, s74, 4096
    buffer_load_dwordx4 a[192:195], v9, s[16:19], s74 offen offset:0 sc1
    buffer_load_dwordx4 a[196:199], v9, s[16:19], s74 offen offset:1024 sc1
    buffer_load_dwordx4 a[200:203], v9, s[16:19], s74 offen offset:2048 sc1
    buffer_load_dwordx4 a[204:207], v9, s[16:19], s74 offen offset:3072 sc1
    buffer_load_dwordx4 a[208:211], v9, s[16:19], s37 offen offset:0 sc1
    buffer_load_dwordx4 a[212:215], v9, s[16:19], s37 offen offset:1024 sc1
    buffer_load_dwordx4 a[216:219], v9, s[16:19], s37 offen offset:2048 sc1
    buffer_load_dwordx4 a[220:223], v9, s[16:19], s37 offen offset:3072 sc1
M_TWO:
    v_and_b32 v2, 15, v1
    v_lshrrev_b32 v3, 4, v1
    v_lshrrev_b32 v4, 2, v2
    v_cmp_eq_u32 vcc, v3, v4
    v_and_b32 v5, 1, v2
    v_lshlrev_b32 v5, 4, v5
    v_mov_b32 v6, 0x3f80
    v_lshlrev_b32 v5, v5, v6
    v_cndmask_b32 v5, 0, v5, vcc
    v_and_b32 v6, 2, v2
    v_cmp_eq_u32 vcc, 0, v6
    v_mov_b32 v90, 0
    v_mov_b32 v91, 0
    v_cndmask_b32 v88, 0, v5, vcc
    v_cndmask_b32 v89, v5, 0, vcc
    v_mov_b32 v92, 0
    v_mov_b32 v93, 0
    v_mov_b32 v94, v88
    v_mov_b32 v95, v89
    v_lshrrev_b32 v2, 1, v1
    v_and_b32 v3, 1, v1
    s_lshl_b32 s36, s21, 6
    v_add_u32 v6, s36, v2
    v_lshlrev_b32 v6, 12, v6
    v_lshl_add_u32 v6, v3, 4, v6
    s_and_b32 s36, s21, 1
    s_lshl_b32 s36, s36, 5
    s_add_u32 s36, s36, 512
    v_add_u32 v7, s36, v2
    v_lshlrev_b32 v7, 12, v7
    v_lshl_add_u32 v7, v3, 4, v7
    s_lshl_b32 s38, s22, 7
    s_add_u32 s38, s38, 2424832
    s_lshl_b32 s36, s20, 5
    s_add_u32 s76, s38, s36
    s_add_u32 s77, s76, 131072
    s_lshr_b32 s36, s21, 1
    s_lshl_b32 s36, s36, 5
    s_add_u32 s78, s38, s36
    v_mov_b32 v172, 0
    v_mov_b32 v173, 0
    v_mov_b32 v174, 0
    v_mov_b32 v175, 0
    v_lshlrev_b32 v14, 4, v1
    s_lshl_b32 s36, s20, 11
    s_add_u32 s36, s36, 31104
    v_add_u32 v15, 39296, v14
    v_add_u32 v14, s36, v14
    v_and_b32 v2, 15, v1
    v_lshrrev_b32 v3, 4, v1
    v_lshrrev_b32 v4, 2, v2
    v_and_b32 v5, 3, v2
    v_lshl_add_u32 v4, v3, 2, v4
    v_lshlrev_b32 v4, 5, v4
    v_lshl_add_u32 v4, v5, 3, v4
    v_add_u32 v5, 39296, v4
    v_add_u32 v4, s36, v4
    v_lshlrev_b32 v16, 16, v192
    v_and_b32 v17, 0xffff0000, v192
    v_lshlrev_b32 v18, 16, v193
    v_and_b32 v19, 0xffff0000, v193
    v_lshlrev_b32 v20, 16, v194
    v_and_b32 v21, 0xffff0000, v194
    v_lshlrev_b32 v22, 16, v195
    v_and_b32 v23, 0xffff0000, v195
    v_sub_f32 v24, v16, v216
    v_sub_f32 v25, v17, v216
    v_sub_f32 v26, v18, v216
    v_sub_f32 v27, v19, v216
    v_sub_f32 v28, v20, v216
    v_sub_f32 v29, v21, v216
    v_sub_f32 v30, v22, v216
    v_sub_f32 v31, v23, v216
    v_mul_f32 v24, v24, v217
    v_mul_f32 v25, v25, v217
    v_mul_f32 v26, v26, v217
    v_mul_f32 v27, v27, v217
    v_mul_f32 v28, v28, v217
    v_mul_f32 v29, v29, v217
    v_mul_f32 v30, v30, v217
    v_mul_f32 v31, v31, v217
    v_cvt_pk_bf16_f32 v104, v24, v25
    v_cvt_pk_bf16_f32 v105, v26, v27
    v_lshlrev_b32 v24, 16, v104
    v_and_b32 v25, 0xffff0000, v104
    v_lshlrev_b32 v26, 16, v105
    v_and_b32 v27, 0xffff0000, v105
    v_cvt_pk_bf16_f32 v106, v28, v29
    v_cvt_pk_bf16_f32 v107, v30, v31
    v_lshlrev_b32 v28, 16, v106
    v_and_b32 v29, 0xffff0000, v106
    v_lshlrev_b32 v30, 16, v107
    v_and_b32 v31, 0xffff0000, v107
    v_lshlrev_b32 v96, 16, v204
    v_and_b32 v97, 0xffff0000, v204
    v_lshlrev_b32 v98, 16, v205
    v_and_b32 v99, 0xffff0000, v205
    v_lshlrev_b32 v100, 16, v206
    v_and_b32 v101, 0xffff0000, v206
    v_lshlrev_b32 v102, 16, v207
    v_and_b32 v103, 0xffff0000, v207
    v_pk_mul_f32 v[24:25], v[24:25], v[96:97]
    v_pk_mul_f32 v[26:27], v[26:27], v[98:99]
    v_pk_mul_f32 v[28:29], v[28:29], v[100:101]
    v_pk_mul_f32 v[30:31], v[30:31], v[102:103]
    v_lshlrev_b32 v40, 16, v196
    v_and_b32 v41, 0xffff0000, v196
    v_lshlrev_b32 v42, 16, v197
    v_and_b32 v43, 0xffff0000, v197
    v_lshlrev_b32 v44, 16, v198
    v_and_b32 v45, 0xffff0000, v198
    v_lshlrev_b32 v46, 16, v199
    v_and_b32 v47, 0xffff0000, v199
    v_sub_f32 v48, v40, v216
    v_sub_f32 v49, v41, v216
    v_sub_f32 v50, v42, v216
    v_sub_f32 v51, v43, v216
    v_sub_f32 v52, v44, v216
    v_sub_f32 v53, v45, v216
    v_sub_f32 v54, v46, v216
    v_sub_f32 v55, v47, v216
    v_mul_f32 v48, v48, v217
    v_mul_f32 v49, v49, v217
    v_mul_f32 v50, v50, v217
    v_mul_f32 v51, v51, v217
    v_mul_f32 v52, v52, v217
    v_mul_f32 v53, v53, v217
    v_mul_f32 v54, v54, v217
    v_mul_f32 v55, v55, v217
    v_cvt_pk_bf16_f32 v104, v48, v49
    v_cvt_pk_bf16_f32 v105, v50, v51
    v_lshlrev_b32 v48, 16, v104
    v_and_b32 v49, 0xffff0000, v104
    v_lshlrev_b32 v50, 16, v105
    v_and_b32 v51, 0xffff0000, v105
    v_cvt_pk_bf16_f32 v106, v52, v53
    v_cvt_pk_bf16_f32 v107, v54, v55
    v_lshlrev_b32 v52, 16, v106
    v_and_b32 v53, 0xffff0000, v106
    v_lshlrev_b32 v54, 16, v107
    v_and_b32 v55, 0xffff0000, v107
    v_lshlrev_b32 v96, 16, v208
    v_and_b32 v97, 0xffff0000, v208
    v_lshlrev_b32 v98, 16, v209
    v_and_b32 v99, 0xffff0000, v209
    v_lshlrev_b32 v100, 16, v210
    v_and_b32 v101, 0xffff0000, v210
    v_lshlrev_b32 v102, 16, v211
    v_and_b32 v103, 0xffff0000, v211
    v_pk_mul_f32 v[48:49], v[48:49], v[96:97]
    v_pk_mul_f32 v[50:51], v[50:51], v[98:99]
    v_pk_mul_f32 v[52:53], v[52:53], v[100:101]
    v_pk_mul_f32 v[54:55], v[54:55], v[102:103]
    s_cmp_lg_u32 s20, 3
    s_cbranch_scc1 M_PRE2
    v_lshlrev_b32 v64, 16, v200
    v_and_b32 v65, 0xffff0000, v200
    v_lshlrev_b32 v66, 16, v201
    v_and_b32 v67, 0xffff0000, v201
    v_lshlrev_b32 v68, 16, v202
    v_and_b32 v69, 0xffff0000, v202
    v_lshlrev_b32 v70, 16, v203
    v_and_b32 v71, 0xffff0000, v203
    v_sub_f32 v72, v64, v218
    v_sub_f32 v73, v65, v218
    v_sub_f32 v74, v66, v218
    v_sub_f32 v75, v67, v218
    v_sub_f32 v76, v68, v218
    v_sub_f32 v77, v69, v218
    v_sub_f32 v78, v70, v218
    v_sub_f32 v79, v71, v218
    v_mul_f32 v72, v72, v219
    v_mul_f32 v73, v73, v219
    v_mul_f32 v74, v74, v219
    v_mul_f32 v75, v75, v219
    v_mul_f32 v76, v76, v219
    v_mul_f32 v77, v77, v219
    v_mul_f32 v78, v78, v219
    v_mul_f32 v79, v79, v219
    v_cvt_pk_bf16_f32 v104, v72, v73
    v_cvt_pk_bf16_f32 v105, v74, v75
    v_lshlrev_b32 v72, 16, v104
    v_and_b32 v73, 0xffff0000, v104
    v_lshlrev_b32 v74, 16, v105
    v_and_b32 v75, 0xffff0000, v105
    v_cvt_pk_bf16_f32 v106, v76, v77
    v_cvt_pk_bf16_f32 v107, v78, v79
    v_lshlrev_b32 v76, 16, v106
    v_and_b32 v77, 0xffff0000, v106
    v_lshlrev_b32 v78, 16, v107
    v_and_b32 v79, 0xffff0000, v107
    v_lshlrev_b32 v96, 16, v212
    v_and_b32 v97, 0xffff0000, v212
    v_lshlrev_b32 v98, 16, v213
    v_and_b32 v99, 0xffff0000, v213
    v_lshlrev_b32 v100, 16, v214
    v_and_b32 v101, 0xffff0000, v214
    v_lshlrev_b32 v102, 16, v215
    v_and_b32 v103, 0xffff0000, v215
    v_pk_mul_f32 v[72:73], v[72:73], v[96:97]
    v_pk_mul_f32 v[74:75], v[74:75], v[98:99]
    v_pk_mul_f32 v[76:77], v[76:77], v[100:101]
    v_pk_mul_f32 v[78:79], v[78:79], v[102:103]
M_PRE2:
    s_cmp_eq_u32 s75, 1
    s_cbranch_scc1 M_PW4
    s_waitcnt vmcnt(0)
    s_branch M_PW
M_PW4:
    s_waitcnt vmcnt(1)
M_PW:
    v_mfma_f32_16x16x32_bf16 v[112:115], v[88:91], a[128:131], 0
    v_mfma_f32_16x16x32_bf16 v[116:119], v[92:95], a[128:131], 0
    v_mfma_f32_16x16x32_bf16 v[112:115], v[88:91], a[132:135], v[112:115]
    v_mfma_f32_16x16x32_bf16 v[116:119], v[92:95], a[132:135], v[116:119]
    v_mfma_f32_16x16x32_bf16 v[112:115], v[88:91], a[136:139], v[112:115]
    v_mfma_f32_16x16x32_bf16 v[116:119], v[92:95], a[136:139], v[116:119]
    v_mfma_f32_16x16x32_bf16 v[112:115], v[88:91], a[140:143], v[112:115]
    v_mfma_f32_16x16x32_bf16 v[116:119], v[92:95], a[140:143], v[116:119]
    v_mfma_f32_16x16x32_bf16 v[112:115], v[88:91], a[144:147], v[112:115]
    v_mfma_f32_16x16x32_bf16 v[116:119], v[92:95], a[144:147], v[116:119]
    v_mfma_f32_16x16x32_bf16 v[112:115], v[88:91], a[148:151], v[112:115]
    v_mfma_f32_16x16x32_bf16 v[116:119], v[92:95], a[148:151], v[116:119]
    v_mfma_f32_16x16x32_bf16 v[112:115], v[88:91], a[152:155], v[112:115]
    v_mfma_f32_16x16x32_bf16 v[116:119], v[92:95], a[152:155], v[116:119]
    v_mfma_f32_16x16x32_bf16 v[112:115], v[88:91], a[156:159], v[112:115]
    v_mfma_f32_16x16x32_bf16 v[116:119], v[92:95], a[156:159], v[116:119]
    s_nop 7
    v_mfma_f32_16x16x32_bf16 v[128:131], v[88:91], a[160:163], 0
    v_mul_f32 v112, 0xbf317218, v112
    v_mul_f32 v113, 0xbf317218, v113
    v_mul_f32 v114, 0xbf317218, v114
    v_mul_f32 v115, 0xbf317218, v115
    v_mfma_f32_16x16x32_bf16 v[132:135], v[92:95], a[160:163], 0
    v_mul_f32 v116, 0xbf317218, v116
    v_mul_f32 v117, 0xbf317218, v117
    v_mul_f32 v118, 0xbf317218, v118
    v_mul_f32 v119, 0xbf317218, v119
    v_mfma_f32_16x16x32_bf16 v[128:131], v[88:91], a[164:167], v[128:131]
    v_cvt_pk_bf16_f32 v176, v112, v113
    v_cvt_pk_bf16_f32 v177, v114, v115
    v_lshlrev_b32 v112, 16, v176
    v_and_b32 v113, 0xffff0000, v176
    v_mfma_f32_16x16x32_bf16 v[132:135], v[92:95], a[164:167], v[132:135]
    v_lshlrev_b32 v114, 16, v177
    v_and_b32 v115, 0xffff0000, v177
    v_cvt_pk_bf16_f32 v178, v116, v117
    v_cvt_pk_bf16_f32 v179, v118, v119
    v_mfma_f32_16x16x32_bf16 v[128:131], v[88:91], a[168:171], v[128:131]
    v_lshlrev_b32 v116, 16, v178
    v_and_b32 v117, 0xffff0000, v178
    v_lshlrev_b32 v118, 16, v179
    v_and_b32 v119, 0xffff0000, v179
    v_mfma_f32_16x16x32_bf16 v[132:135], v[92:95], a[168:171], v[132:135]
    v_mul_f32 v120, s39, v112
    v_mul_f32 v121, s39, v113
    v_mul_f32 v122, s39, v114
    v_mul_f32 v123, s39, v115
    v_mfma_f32_16x16x32_bf16 v[128:131], v[88:91], a[172:175], v[128:131]
    v_mul_f32 v124, s39, v116
    v_mul_f32 v125, s39, v117
    v_mul_f32 v126, s39, v118
    v_mul_f32 v127, s39, v119
    v_mfma_f32_16x16x32_bf16 v[132:135], v[92:95], a[172:175], v[132:135]
    v_exp_f32 v120, v120
    v_exp_f32 v121, v121
    v_exp_f32 v122, v122
    v_exp_f32 v123, v123
    v_mfma_f32_16x16x32_bf16 v[128:131], v[88:91], a[176:179], v[128:131]
    v_exp_f32 v124, v124
    v_exp_f32 v125, v125
    v_exp_f32 v126, v126
    v_exp_f32 v127, v127
    v_mfma_f32_16x16x32_bf16 v[132:135], v[92:95], a[176:179], v[132:135]
    v_add_f32 v120, 1.0, v120
    v_add_f32 v121, 1.0, v121
    v_add_f32 v122, 1.0, v122
    v_add_f32 v123, 1.0, v123
    v_mfma_f32_16x16x32_bf16 v[128:131], v[88:91], a[180:183], v[128:131]
    v_add_f32 v124, 1.0, v124
    v_add_f32 v125, 1.0, v125
    v_add_f32 v126, 1.0, v126
    v_add_f32 v127, 1.0, v127
    v_mfma_f32_16x16x32_bf16 v[132:135], v[92:95], a[180:183], v[132:135]
    v_rcp_f32 v120, v120
    v_rcp_f32 v121, v121
    v_rcp_f32 v122, v122
    v_rcp_f32 v123, v123
    v_mfma_f32_16x16x32_bf16 v[128:131], v[88:91], a[184:187], v[128:131]
    v_rcp_f32 v124, v124
    v_rcp_f32 v125, v125
    v_rcp_f32 v126, v126
    v_rcp_f32 v127, v127
    v_mfma_f32_16x16x32_bf16 v[132:135], v[92:95], a[184:187], v[132:135]
    v_mul_f32 v120, v120, v112
    v_mul_f32 v121, v121, v113
    v_mul_f32 v122, v122, v114
    v_mul_f32 v123, v123, v115
    v_mfma_f32_16x16x32_bf16 v[128:131], v[88:91], a[188:191], v[128:131]
    v_mul_f32 v124, v124, v116
    v_mul_f32 v125, v125, v117
    v_mul_f32 v126, v126, v118
    v_mul_f32 v127, v127, v119
    v_mfma_f32_16x16x32_bf16 v[132:135], v[92:95], a[188:191], v[132:135]
    v_cvt_pk_bf16_f32 v232, v120, v121
    v_cvt_pk_bf16_f32 v233, v122, v123
    v_cvt_pk_bf16_f32 v234, v124, v125
    v_cvt_pk_bf16_f32 v235, v126, v127
    s_cmp_lg_u32 s20, 3
    s_cbranch_scc1 M_SUM2
    s_nop 7
    v_mfma_f32_16x16x32_bf16 v[144:147], v[88:91], a[192:195], 0
    v_mul_f32 v128, 0xbf317218, v128
    v_mul_f32 v129, 0xbf317218, v129
    v_mul_f32 v130, 0xbf317218, v130
    v_mul_f32 v131, 0xbf317218, v131
    v_mfma_f32_16x16x32_bf16 v[148:151], v[92:95], a[192:195], 0
    v_mul_f32 v132, 0xbf317218, v132
    v_mul_f32 v133, 0xbf317218, v133
    v_mul_f32 v134, 0xbf317218, v134
    v_mul_f32 v135, 0xbf317218, v135
    v_mfma_f32_16x16x32_bf16 v[144:147], v[88:91], a[196:199], v[144:147]
    v_cvt_pk_bf16_f32 v180, v128, v129
    v_cvt_pk_bf16_f32 v181, v130, v131
    v_lshlrev_b32 v128, 16, v180
    v_and_b32 v129, 0xffff0000, v180
    v_mfma_f32_16x16x32_bf16 v[148:151], v[92:95], a[196:199], v[148:151]
    v_lshlrev_b32 v130, 16, v181
    v_and_b32 v131, 0xffff0000, v181
    v_cvt_pk_bf16_f32 v182, v132, v133
    v_cvt_pk_bf16_f32 v183, v134, v135
    v_mfma_f32_16x16x32_bf16 v[144:147], v[88:91], a[200:203], v[144:147]
    v_lshlrev_b32 v132, 16, v182
    v_and_b32 v133, 0xffff0000, v182
    v_lshlrev_b32 v134, 16, v183
    v_and_b32 v135, 0xffff0000, v183
    v_mfma_f32_16x16x32_bf16 v[148:151], v[92:95], a[200:203], v[148:151]
    v_mul_f32 v136, s39, v128
    v_mul_f32 v137, s39, v129
    v_mul_f32 v138, s39, v130
    v_mul_f32 v139, s39, v131
    v_mfma_f32_16x16x32_bf16 v[144:147], v[88:91], a[204:207], v[144:147]
    v_mul_f32 v140, s39, v132
    v_mul_f32 v141, s39, v133
    v_mul_f32 v142, s39, v134
    v_mul_f32 v143, s39, v135
    v_mfma_f32_16x16x32_bf16 v[148:151], v[92:95], a[204:207], v[148:151]
    v_exp_f32 v136, v136
    v_exp_f32 v137, v137
    v_exp_f32 v138, v138
    v_exp_f32 v139, v139
    v_mfma_f32_16x16x32_bf16 v[144:147], v[88:91], a[208:211], v[144:147]
    v_exp_f32 v140, v140
    v_exp_f32 v141, v141
    v_exp_f32 v142, v142
    v_exp_f32 v143, v143
    v_mfma_f32_16x16x32_bf16 v[148:151], v[92:95], a[208:211], v[148:151]
    v_add_f32 v136, 1.0, v136
    v_add_f32 v137, 1.0, v137
    v_add_f32 v138, 1.0, v138
    v_add_f32 v139, 1.0, v139
    v_mfma_f32_16x16x32_bf16 v[144:147], v[88:91], a[212:215], v[144:147]
    v_add_f32 v140, 1.0, v140
    v_add_f32 v141, 1.0, v141
    v_add_f32 v142, 1.0, v142
    v_add_f32 v143, 1.0, v143
    v_mfma_f32_16x16x32_bf16 v[148:151], v[92:95], a[212:215], v[148:151]
    v_rcp_f32 v136, v136
    v_rcp_f32 v137, v137
    v_rcp_f32 v138, v138
    v_rcp_f32 v139, v139
    v_mfma_f32_16x16x32_bf16 v[144:147], v[88:91], a[216:219], v[144:147]
    v_rcp_f32 v140, v140
    v_rcp_f32 v141, v141
    v_rcp_f32 v142, v142
    v_rcp_f32 v143, v143
    v_mfma_f32_16x16x32_bf16 v[148:151], v[92:95], a[216:219], v[148:151]
    v_mul_f32 v136, v136, v128
    v_mul_f32 v137, v137, v129
    v_mul_f32 v138, v138, v130
    v_mul_f32 v139, v139, v131
    v_mfma_f32_16x16x32_bf16 v[144:147], v[88:91], a[220:223], v[144:147]
    v_mul_f32 v140, v140, v132
    v_mul_f32 v141, v141, v133
    v_mul_f32 v142, v142, v134
    v_mul_f32 v143, v143, v135
    v_mfma_f32_16x16x32_bf16 v[148:151], v[92:95], a[220:223], v[148:151]
    v_cvt_pk_bf16_f32 v236, v136, v137
    v_cvt_pk_bf16_f32 v237, v138, v139
    v_cvt_pk_bf16_f32 v238, v140, v141
    v_cvt_pk_bf16_f32 v239, v142, v143
    buffer_load_dwordx4 v[164:167], v6, s[16:19], s76 offen sc1
    buffer_load_dwordx4 v[168:171], v6, s[16:19], s77 offen sc1
    s_cmp_lg_u32 s20, 3
    s_cbranch_scc1 M_YL1
    buffer_load_dwordx4 v[172:175], v7, s[16:19], s78 offen sc1
M_YL1:
    s_nop 3
    v_mul_f32 v144, 0xbf317218, v144
    v_mul_f32 v145, 0xbf317218, v145
    v_mul_f32 v146, 0xbf317218, v146
    v_mul_f32 v147, 0xbf317218, v147
    v_mul_f32 v148, 0xbf317218, v148
    v_mul_f32 v149, 0xbf317218, v149
    v_mul_f32 v150, 0xbf317218, v150
    v_mul_f32 v151, 0xbf317218, v151
    v_cvt_pk_bf16_f32 v184, v144, v145
    v_cvt_pk_bf16_f32 v185, v146, v147
    v_lshlrev_b32 v144, 16, v184
    v_and_b32 v145, 0xffff0000, v184
    v_lshlrev_b32 v146, 16, v185
    v_and_b32 v147, 0xffff0000, v185
    v_cvt_pk_bf16_f32 v186, v148, v149
    v_cvt_pk_bf16_f32 v187, v150, v151
    v_lshlrev_b32 v148, 16, v186
    v_and_b32 v149, 0xffff0000, v186
    v_lshlrev_b32 v150, 16, v187
    v_and_b32 v151, 0xffff0000, v187
    v_mul_f32 v152, s39, v144
    v_mul_f32 v153, s39, v145
    v_mul_f32 v154, s39, v146
    v_mul_f32 v155, s39, v147
    v_mul_f32 v156, s39, v148
    v_mul_f32 v157, s39, v149
    v_mul_f32 v158, s39, v150
    v_mul_f32 v159, s39, v151
    v_exp_f32 v152, v152
    v_exp_f32 v153, v153
    v_exp_f32 v154, v154
    v_exp_f32 v155, v155
    v_exp_f32 v156, v156
    v_exp_f32 v157, v157
    v_exp_f32 v158, v158
    v_exp_f32 v159, v159
    v_add_f32 v152, 1.0, v152
    v_add_f32 v153, 1.0, v153
    v_add_f32 v154, 1.0, v154
    v_add_f32 v155, 1.0, v155
    v_add_f32 v156, 1.0, v156
    v_add_f32 v157, 1.0, v157
    v_add_f32 v158, 1.0, v158
    v_add_f32 v159, 1.0, v159
    v_rcp_f32 v152, v152
    v_rcp_f32 v153, v153
    v_rcp_f32 v154, v154
    v_rcp_f32 v155, v155
    v_rcp_f32 v156, v156
    v_rcp_f32 v157, v157
    v_rcp_f32 v158, v158
    v_rcp_f32 v159, v159
    v_mul_f32 v152, v152, v144
    v_mul_f32 v153, v153, v145
    v_mul_f32 v154, v154, v146
    v_mul_f32 v155, v155, v147
    v_mul_f32 v156, v156, v148
    v_mul_f32 v157, v157, v149
    v_mul_f32 v158, v158, v150
    v_mul_f32 v159, v159, v151
    v_cvt_pk_bf16_f32 v240, v152, v153
    v_cvt_pk_bf16_f32 v241, v154, v155
    v_cvt_pk_bf16_f32 v242, v156, v157
    v_cvt_pk_bf16_f32 v243, v158, v159
    s_branch M_ACT2
M_SUM2:
    buffer_load_dwordx4 v[164:167], v6, s[16:19], s76 offen sc1
    buffer_load_dwordx4 v[168:171], v6, s[16:19], s77 offen sc1
    s_cmp_lg_u32 s20, 3
    s_cbranch_scc1 M_YL2
    buffer_load_dwordx4 v[172:175], v7, s[16:19], s78 offen sc1
M_YL2:
    s_nop 3
    v_mul_f32 v128, 0xbf317218, v128
    v_mul_f32 v129, 0xbf317218, v129
    v_mul_f32 v130, 0xbf317218, v130
    v_mul_f32 v131, 0xbf317218, v131
    v_mul_f32 v132, 0xbf317218, v132
    v_mul_f32 v133, 0xbf317218, v133
    v_mul_f32 v134, 0xbf317218, v134
    v_mul_f32 v135, 0xbf317218, v135
    v_cvt_pk_bf16_f32 v180, v128, v129
    v_cvt_pk_bf16_f32 v181, v130, v131
    v_lshlrev_b32 v128, 16, v180
    v_and_b32 v129, 0xffff0000, v180
    v_lshlrev_b32 v130, 16, v181
    v_and_b32 v131, 0xffff0000, v181
    v_cvt_pk_bf16_f32 v182, v132, v133
    v_cvt_pk_bf16_f32 v183, v134, v135
    v_lshlrev_b32 v132, 16, v182
    v_and_b32 v133, 0xffff0000, v182
    v_lshlrev_b32 v134, 16, v183
    v_and_b32 v135, 0xffff0000, v183
    v_mul_f32 v136, s39, v128
    v_mul_f32 v137, s39, v129
    v_mul_f32 v138, s39, v130
    v_mul_f32 v139, s39, v131
    v_mul_f32 v140, s39, v132
    v_mul_f32 v141, s39, v133
    v_mul_f32 v142, s39, v134
    v_mul_f32 v143, s39, v135
    v_exp_f32 v136, v136
    v_exp_f32 v137, v137
    v_exp_f32 v138, v138
    v_exp_f32 v139, v139
    v_exp_f32 v140, v140
    v_exp_f32 v141, v141
    v_exp_f32 v142, v142
    v_exp_f32 v143, v143
    v_add_f32 v136, 1.0, v136
    v_add_f32 v137, 1.0, v137
    v_add_f32 v138, 1.0, v138
    v_add_f32 v139, 1.0, v139
    v_add_f32 v140, 1.0, v140
    v_add_f32 v141, 1.0, v141
    v_add_f32 v142, 1.0, v142
    v_add_f32 v143, 1.0, v143
    v_rcp_f32 v136, v136
    v_rcp_f32 v137, v137
    v_rcp_f32 v138, v138
    v_rcp_f32 v139, v139
    v_rcp_f32 v140, v140
    v_rcp_f32 v141, v141
    v_rcp_f32 v142, v142
    v_rcp_f32 v143, v143
    v_mul_f32 v136, v136, v128
    v_mul_f32 v137, v137, v129
    v_mul_f32 v138, v138, v130
    v_mul_f32 v139, v139, v131
    v_mul_f32 v140, v140, v132
    v_mul_f32 v141, v141, v133
    v_mul_f32 v142, v142, v134
    v_mul_f32 v143, v143, v135
    v_cvt_pk_bf16_f32 v236, v136, v137
    v_cvt_pk_bf16_f32 v237, v138, v139
    v_cvt_pk_bf16_f32 v238, v140, v141
    v_cvt_pk_bf16_f32 v239, v142, v143
M_ACT2:
    s_nop 1
    v_permlane16_swap_b32 v232, v234
    v_permlane16_swap_b32 v233, v235
    v_permlane16_swap_b32 v236, v238
    v_permlane16_swap_b32 v237, v239
    v_permlane16_swap_b32 v240, v242
    v_permlane16_swap_b32 v241, v243
    v_lshlrev_b32 v32, 16, v232
    v_and_b32 v33, 0xffff0000, v232
    v_lshlrev_b32 v34, 16, v233
    v_and_b32 v35, 0xffff0000, v233
    v_lshlrev_b32 v36, 16, v234
    v_and_b32 v37, 0xffff0000, v234
    v_lshlrev_b32 v38, 16, v235
    v_and_b32 v39, 0xffff0000, v235
    v_lshlrev_b32 v56, 16, v236
    v_and_b32 v57, 0xffff0000, v236
    v_lshlrev_b32 v58, 16, v237
    v_and_b32 v59, 0xffff0000, v237
    v_lshlrev_b32 v60, 16, v238
    v_and_b32 v61, 0xffff0000, v238
    v_lshlrev_b32 v62, 16, v239
    v_and_b32 v63, 0xffff0000, v239
    v_lshlrev_b32 v80, 16, v240
    v_and_b32 v81, 0xffff0000, v240
    v_lshlrev_b32 v82, 16, v241
    v_and_b32 v83, 0xffff0000, v241
    v_lshlrev_b32 v84, 16, v242
    v_and_b32 v85, 0xffff0000, v242
    v_lshlrev_b32 v86, 16, v243
    v_and_b32 v87, 0xffff0000, v243
M_Y_POLL:
    s_mov_b32 s36, 0
M_Y_CHECK:
    s_waitcnt vmcnt(0)
    v_max3_u32 v2, v164, v165, v166
    v_max3_u32 v3, v167, v168, v169
    v_max3_u32 v2, v2, v170, v171
    v_max3_u32 v3, v3, v172, v173
    v_max3_u32 v2, v2, v174, v175
    v_max_u32 v2, v2, v3
    v_cmp_eq_u32 vcc, -1, v2
    s_add_u32 s36, s36, 1
    s_cmp_ge_u32 s36, 50000
    s_cbranch_scc1 M_Y_OK
    s_cbranch_vccz M_Y_OK
    s_sleep 2
    buffer_load_dwordx4 v[164:167], v6, s[16:19], s76 offen sc1
    buffer_load_dwordx4 v[168:171], v6, s[16:19], s77 offen sc1
    s_cmp_lg_u32 s20, 3
    s_cbranch_scc1 M_YL3
    buffer_load_dwordx4 v[172:175], v7, s[16:19], s78 offen sc1
M_YL3:
    s_branch M_Y_CHECK
M_Y_OK:
    ds_write_b128 v14, v[164:167]
    ds_write_b128 v14, v[168:171] offset:1024
    s_cmp_lg_u32 s20, 3
    s_cbranch_scc1 M_Y_NOX2
    ds_write_b128 v15, v[172:175]
M_Y_NOX2:
    s_waitcnt lgkmcnt(0)
    ds_read_b64_tr_b16 v[244:245], v4 offset:0
    ds_read_b64_tr_b16 v[246:247], v4 offset:512
    ds_read_b64_tr_b16 v[248:249], v4 offset:1024
    ds_read_b64_tr_b16 v[250:251], v4 offset:1536
    ds_read_b64_tr_b16 v[252:253], v5 offset:0
    ds_read_b64_tr_b16 v[254:255], v5 offset:512
    s_waitcnt lgkmcnt(0)
    v_permlane16_swap_b32 v244, v246
    v_permlane16_swap_b32 v245, v247
    v_permlane16_swap_b32 v248, v250
    v_permlane16_swap_b32 v249, v251
    v_permlane16_swap_b32 v252, v254
    v_permlane16_swap_b32 v253, v255
    v_lshlrev_b32 v96, 16, v244
    v_and_b32 v97, 0xffff0000, v244
    v_lshlrev_b32 v98, 16, v245
    v_and_b32 v99, 0xffff0000, v245
    v_lshlrev_b32 v100, 16, v246
    v_and_b32 v101, 0xffff0000, v246
    v_lshlrev_b32 v102, 16, v247
    v_and_b32 v103, 0xffff0000, v247
    v_pk_add_f32 v[24:25], v[24:25], v[96:97]
    v_pk_add_f32 v[26:27], v[26:27], v[98:99]
    v_pk_add_f32 v[28:29], v[28:29], v[100:101]
    v_pk_add_f32 v[30:31], v[30:31], v[102:103]
    v_pk_fma_f32 v[24:25], v[24:25], v[32:33], v[16:17]
    v_pk_fma_f32 v[26:27], v[26:27], v[34:35], v[18:19]
    v_pk_fma_f32 v[28:29], v[28:29], v[36:37], v[20:21]
    v_pk_fma_f32 v[30:31], v[30:31], v[38:39], v[22:23]
    v_cvt_pk_bf16_f32 v124, v24, v25
    v_cvt_pk_bf16_f32 v125, v26, v27
    v_cvt_pk_bf16_f32 v126, v28, v29
    v_cvt_pk_bf16_f32 v127, v30, v31
    buffer_store_dwordx4 v[124:127], v10, s[8:11], 0 offen offset:0 sc1
    v_lshlrev_b32 v104, 16, v248
    v_and_b32 v105, 0xffff0000, v248
    v_lshlrev_b32 v106, 16, v249
    v_and_b32 v107, 0xffff0000, v249
    v_lshlrev_b32 v108, 16, v250
    v_and_b32 v109, 0xffff0000, v250
    v_lshlrev_b32 v110, 16, v251
    v_and_b32 v111, 0xffff0000, v251
    v_pk_add_f32 v[48:49], v[48:49], v[104:105]
    v_pk_add_f32 v[50:51], v[50:51], v[106:107]
    v_pk_add_f32 v[52:53], v[52:53], v[108:109]
    v_pk_add_f32 v[54:55], v[54:55], v[110:111]
    v_pk_fma_f32 v[48:49], v[48:49], v[56:57], v[40:41]
    v_pk_fma_f32 v[50:51], v[50:51], v[58:59], v[42:43]
    v_pk_fma_f32 v[52:53], v[52:53], v[60:61], v[44:45]
    v_pk_fma_f32 v[54:55], v[54:55], v[62:63], v[46:47]
    v_cvt_pk_bf16_f32 v128, v48, v49
    v_cvt_pk_bf16_f32 v129, v50, v51
    v_cvt_pk_bf16_f32 v130, v52, v53
    v_cvt_pk_bf16_f32 v131, v54, v55
    buffer_store_dwordx4 v[128:131], v10, s[8:11], 0 offen offset:64 sc1
    s_cmp_lg_u32 s20, 3
    s_cbranch_scc1 M_NOX
    v_lshlrev_b32 v96, 16, v252
    v_and_b32 v97, 0xffff0000, v252
    v_lshlrev_b32 v98, 16, v253
    v_and_b32 v99, 0xffff0000, v253
    v_lshlrev_b32 v100, 16, v254
    v_and_b32 v101, 0xffff0000, v254
    v_lshlrev_b32 v102, 16, v255
    v_and_b32 v103, 0xffff0000, v255
    v_pk_add_f32 v[72:73], v[72:73], v[96:97]
    v_pk_add_f32 v[74:75], v[74:75], v[98:99]
    v_pk_add_f32 v[76:77], v[76:77], v[100:101]
    v_pk_add_f32 v[78:79], v[78:79], v[102:103]
    v_pk_fma_f32 v[72:73], v[72:73], v[80:81], v[64:65]
    v_pk_fma_f32 v[74:75], v[74:75], v[82:83], v[66:67]
    v_pk_fma_f32 v[76:77], v[76:77], v[84:85], v[68:69]
    v_pk_fma_f32 v[78:79], v[78:79], v[86:87], v[70:71]
    v_cvt_pk_bf16_f32 v124, v72, v73
    v_cvt_pk_bf16_f32 v125, v74, v75
    v_cvt_pk_bf16_f32 v126, v76, v77
    v_cvt_pk_bf16_f32 v127, v78, v79
    buffer_store_dwordx4 v[124:127], v11, s[8:11], 0 offen offset:0 sc1
M_NOX:
M_END:
    s_endpgm
.section .rodata,"a"
.p2align 6
.amdhsa_kernel recurrent_scan__ssm_conv_s4d__dense_activation_silu__prompt_kernel
  .amdhsa_next_free_vgpr 512
  .amdhsa_next_free_sgpr 102
  .amdhsa_accum_offset 256
  .amdhsa_group_segment_fixed_size 0
  .amdhsa_kernarg_size 104
  .amdhsa_user_sgpr_count 2
  .amdhsa_user_sgpr_kernarg_segment_ptr 1
  .amdhsa_system_sgpr_workgroup_id_x 1
  .amdhsa_float_denorm_mode_32 3
.end_amdhsa_kernel
.text
```
